```python
import torch

def _softmax(x, axis=-1):
    return torch.softmax(x, dim=axis)
def _gelu(x):
    return torch.nn.functional.gelu(x, approximate="tanh")
def _silu(x):
    return torch.nn.functional.silu(x)
def _sigmoid(x):
    return torch.sigmoid(x)
def _layernorm(x, axis=-1, eps=1e-5):
    m = x.mean(dim=axis, keepdim=True)
    v = x.var(dim=axis, keepdim=True, unbiased=False)
    return (x - m) / torch.sqrt(v + eps)
def _scatter_add(tgt, idx, src, axis=0):
    return tgt.clone().index_add_(axis, idx, src)
def _segment_sum(src, seg, n):
    out = torch.zeros((n,) + src.shape[1:], dtype=src.dtype)
    return out.index_add_(0, seg, src)
def _pad(x, pw):
    flat = tuple(v for pair in reversed(pw) for v in pair)
    return torch.nn.functional.pad(x, flat)

kernel_name = 'sequential_preLN__mha_block__glu_gated_swiglu__prompt'

def setup_inputs():

    _w = (lambda a: (lambda t: t.to(torch.bfloat16) if t.is_floating_point() else t)(torch.as_tensor(a)))
    def _A_setup():
        B, S, D, H = 1, 2048, 640, 32
        return {
            "x": _w((lambda *s: torch.randn(*s, dtype=torch.bfloat16) * 0.05)(B, S, D)),
            "wqkv": _w((lambda *s: torch.randn(*s, dtype=torch.bfloat16) * 0.05)(D, 3 * D)),
            "wo": _w((lambda *s: torch.randn(*s, dtype=torch.bfloat16) * 0.05)(D, D)),
        }
    _A_in = _A_setup()

    def _B_setup():
        B, S, D, F = 1, 2048, 640, 1536
        return {
            "x": _w((lambda *s: torch.randn(*s, dtype=torch.bfloat16) * 0.05)(B, S, D)),
            "w1": _w((lambda *s: torch.randn(*s, dtype=torch.bfloat16) * 0.4)(D, F) * (2.0 / D) ** 0.5),
            "w3": _w((lambda *s: torch.randn(*s, dtype=torch.bfloat16) * 0.4)(D, F) * (2.0 / D) ** 0.5),
            "w2": _w((lambda *s: torch.randn(*s, dtype=torch.bfloat16) * 0.4)(F, D) * (2.0 / F) ** 0.5),
        }
    _B_in = _B_setup()

    return {
        "A_x": _A_in["x"],
        "A_wqkv": _A_in["wqkv"],
        "A_wo": _A_in["wo"],
        "B_x": _B_in["x"],
        "B_w1": _B_in["w1"],
        "B_w3": _B_in["w3"],
        "B_w2": _B_in["w2"],
    }

def reference(A_x, A_wqkv, A_wo, B_x, B_w1, B_w3, B_w2):
    def _A_ref(x, wqkv, wo):
        B, S, D = x.shape
        H = 32
        Dh = D // H
        qkv = (lambda x, *d: x.permute(*d))((x @ wqkv).reshape(B, S, 3, H, Dh), 2, 0, 3, 1, 4)
        q, k, v = qkv[0], qkv[1], qkv[2]
        scores = torch.einsum("bhqd,bhkd->bhqk", q, k) * (Dh ** -0.5)
        p = _softmax(scores, axis=-1)
        o = torch.einsum("bhqk,bhkd->bhqd", p, v)
        return (lambda x, *d: x.permute(*d))(o, 0, 2, 1, 3).reshape(B, S, D) @ wo

    def _B_ref(x, w1, w3, w2):
        gate = torch.einsum("bsd,df->bsf", x, w1)
        up = torch.einsum("bsd,df->bsf", x, w3)
        h = _silu(gate) * up
        out = torch.einsum("bsf,fd->bsd", h, w2)
        return out

    x = A_x
    h = x + _A_ref(_layernorm(x, axis=-1), A_wqkv, A_wo)
    h2 = h + _B_ref(_layernorm(h, axis=-1), B_w1, B_w3, B_w2)
    return h2
```

```asm
; @launch kernel=kx_fused_kernel grid=(256,1,1) block=(512,1,1) lds=163840
.amdgcn_target "amdgcn-amd-amdhsa--gfx950"
.text
.p2align 12
.fill 576, 4, 0xbf810000
.globl kx_fused_kernel
.p2align 8
.type kx_fused_kernel,@function
kx_fused_kernel:
    s_load_dwordx4 s[8:11], s[0:1], 0
    s_load_dwordx4 s[4:7], s[0:1], 64
    s_cmp_ge_u32 s2, 256
    s_cbranch_scc1 kx_fused_kernel_end1
    v_lshrrev_b32 v2, 6, v0
    v_and_b32 v1, 63, v0
    s_and_b32 s24, s2, 7
    s_bfe_u32 s16, s2, 0x20003
    v_readfirstlane_b32 s14, v2
    s_lshl2_add_u32 s12, s24, s16
    s_lshr_b32 s13, s2, 5
    s_and_b32 s17, s12, 1
    s_lshr_b32 s15, s12, 1
    s_mul_i32 s15, s15, 163840
    s_add_u32 s19, s15, 65536
    s_mul_i32 s18, s17, 98304
    s_add_u32 s18, s18, s15
    s_mov_b32 s22, 42991616
    s_mov_b32 s23, 0x20000
    s_lshr_b32 s28, s24, 1
    s_lshl2_add_u32 s28, s28, s16
    s_cmp_ge_u32 s14, 4
    s_cbranch_scc1 kx_fused_kernel_comp2
    s_load_dwordx8 s[32:39], s[0:1], 16
    s_load_dwordx4 s[40:43], s[0:1], 48
    s_lshl_b32 s15, s14, 5
    v_lshrrev_b32 v5, 3, v1
    v_add_u32 v2, s15, v5
    v_and_b32 v3, 7, v1
    v_bfe_u32 v4, v1, 4, 2
    v_xor_b32 v6, v4, v3
    v_lshlrev_b32 v6, 4, v6
    v_mul_u32_u24 v2, 1280, v2
    v_add_u32 v17, v2, v6
    v_xor_b32 v18, 64, v17
    v_add_u32 v18, 9216, v18
    v_add_u32 v19, 18432, v17
    v_add_u32 v20, 18432, v18
    v_lshl_add_u32 v2, s14, 4, v5
    v_lshlrev_b32 v4, 2, v4
    v_and_b32 v4, 4, v4
    v_xor_b32 v3, v3, v4
    v_mul_u32_u24 v2, 3840, v2
    v_lshl_add_u32 v21, v3, 4, v2
    v_add_u32 v22, 29696, v21
    s_and_b32 s64, s24, 1
    s_lshr_b32 s65, s24, 1
    s_mul_i32 s65, s65, 5
    s_lshr_b32 s65, s65, 1
    s_add_u32 s65, s65, s13
    s_mul_i32 s15, s64, 5
    s_add_u32 s63, s15, s13
    s_lshl1_add_u32 s15, s15, s65
    s_add_u32 s15, s15, 5
    s_cmp_lt_u32 s13, 5
    s_cselect_b32 s63, s63, s15
    s_lshl3_add_u32 s15, s64, s13
    s_and_b32 s16, s28, 3
    s_mul_i32 s16, s16, 5
    s_add_u32 s16, s16, 1
    s_lshr_b32 s16, s16, 1
    s_add_u32 s15, s15, s16
    s_lshr_b32 s16, s28, 2
    s_add_u32 s15, s15, s16
    s_sub_u32 s16, s15, 20
    s_min_u32 s15, s15, s16
    s_sub_u32 s16, s15, 10
    s_min_u32 s15, s15, s16
    s_lshl_b32 s57, s15, 7
    s_mul_i32 s60, s15, 245760
    s_lshl_b32 s26, s63, 7
    s_add_u32 s60, s60, s26
    s_lshl_b32 s62, s14, 12
    s_lshl_b32 s25, s14, 11
    s_mul_i32 s15, s28, 163840
    s_waitcnt lgkmcnt(0)
    s_add_u32 s68, s8, s15
    s_addc_u32 s69, s9, 0
    s_mov_b32 s70, 163840
    s_mov_b32 s71, 0x20000
    s_mov_b32 s72, s10
    s_mov_b32 s73, s11
    s_mov_b32 s74, 2457600
    s_mov_b32 s75, 0x20000
    s_add_u32 m0, s62, 0
    s_nop 0
    buffer_load_dwordx4 v17, s[68:71], s57 offen offset:0 lds
    buffer_load_dwordx4 v18, s[68:71], s57 offen offset:1024 lds
    buffer_load_dwordx4 v19, s[68:71], s57 offen offset:2048 lds
    buffer_load_dwordx4 v20, s[68:71], s57 offen offset:3072 lds
    s_add_u32 m0, s25, 16384
    s_nop 0
    buffer_load_dwordx4 v21, s[72:75], s60 offen offset:0 lds
    buffer_load_dwordx4 v22, s[72:75], s60 offen offset:1024 lds
    s_add_u32 s57, s57, 128
    s_add_u32 s60, s60, 245760
    s_cmp_eq_u32 s57, 1280
    s_cselect_b32 s57, 0, s57
    s_cselect_b32 s60, s26, s60
    s_add_u32 m0, s62, 24576
    s_nop 0
    buffer_load_dwordx4 v17, s[68:71], s57 offen offset:0 lds
    buffer_load_dwordx4 v18, s[68:71], s57 offen offset:1024 lds
    buffer_load_dwordx4 v19, s[68:71], s57 offen offset:2048 lds
    buffer_load_dwordx4 v20, s[68:71], s57 offen offset:3072 lds
    s_add_u32 m0, s25, 40960
    s_nop 0
    buffer_load_dwordx4 v21, s[72:75], s60 offen offset:0 lds
    buffer_load_dwordx4 v22, s[72:75], s60 offen offset:1024 lds
    s_add_u32 s57, s57, 128
    s_add_u32 s60, s60, 245760
    s_cmp_eq_u32 s57, 1280
    s_cselect_b32 s57, 0, s57
    s_cselect_b32 s60, s26, s60
    v_bfe_u32 v2, v1, 4, 1
    v_bfe_u32 v3, v1, 2, 2
    v_lshl_add_u32 v2, v2, 3, v3
    v_lshlrev_b32 v2, 7, v2
    v_lshrrev_b32 v4, 5, v1
    v_bfe_u32 v5, v1, 1, 1
    v_lshl_add_u32 v5, v4, 1, v5
    v_lshlrev_b32 v3, 1, v3
    v_and_b32 v3, 4, v3
    v_add_u32 v5, v5, v3
    v_lshl_add_u32 v2, v5, 4, v2
    v_and_b32 v5, 1, v1
    v_lshl_add_u32 v2, v5, 3, v2
    s_add_u32 s15, s25, 16384
    v_add_u32 v76, s15, v2
    v_xor_b32 v77, 64, v76
    v_add_u32 v78, 73728, v76
    v_add_u32 v79, 73728, v77
    s_lshl3_add_u32 s15, s14, 159744
    v_lshl_add_u32 v80, v1, 5, s15
    v_and_b32 v2, 15, v1
    v_lshlrev_b32 v4, 2, v4
    v_mov_b32 v5, 0x3f803f80
    v_cmp_eq_u32 vcc, v2, v4
    s_nop 1
    v_cndmask_b32 v32, 0, v5, vcc
    v_add_u32 v4, 8, v4
    v_cmp_eq_u32 vcc, v2, v4
    s_nop 1
    v_cndmask_b32 v36, 0, v5, vcc
    v_mov_b32 v33, v32
    v_mov_b32 v34, v32
    v_mov_b32 v35, v32
    v_mov_b32 v37, v36
    v_mov_b32 v38, v36
    v_mov_b32 v39, v36
    s_waitcnt vmcnt(6)
    s_barrier
    s_add_u32 m0, s62, 49152
    s_nop 0
    buffer_load_dwordx4 v17, s[68:71], s57 offen offset:0 lds
    buffer_load_dwordx4 v18, s[68:71], s57 offen offset:1024 lds
    buffer_load_dwordx4 v19, s[68:71], s57 offen offset:2048 lds
    buffer_load_dwordx4 v20, s[68:71], s57 offen offset:3072 lds
    s_add_u32 m0, s25, 65536
    s_nop 0
    buffer_load_dwordx4 v21, s[72:75], s60 offen offset:0 lds
    buffer_load_dwordx4 v22, s[72:75], s60 offen offset:1024 lds
    s_add_u32 s57, s57, 128
    s_add_u32 s60, s60, 245760
    s_cmp_eq_u32 s57, 1280
    s_cselect_b32 s57, 0, s57
    s_cselect_b32 s60, s26, s60
    ds_read_b64_tr_b16 v[60:61], v76 offset:0
    ds_read_b64_tr_b16 v[62:63], v76 offset:512
    ds_read_b64_tr_b16 v[64:65], v77 offset:0
    ds_read_b64_tr_b16 v[66:67], v77 offset:512
    s_waitcnt lgkmcnt(2)
    v_mfma_f32_16x16x32_bf16 v[40:43], v[32:35], v[60:63], 0
    s_waitcnt lgkmcnt(0)
    v_mfma_f32_16x16x32_bf16 v[40:43], v[36:39], v[64:67], v[40:43]
    s_waitcnt vmcnt(6)
    s_barrier
    s_add_u32 m0, s62, 73728
    s_nop 0
    buffer_load_dwordx4 v17, s[68:71], s57 offen offset:0 lds
    buffer_load_dwordx4 v18, s[68:71], s57 offen offset:1024 lds
    buffer_load_dwordx4 v19, s[68:71], s57 offen offset:2048 lds
    buffer_load_dwordx4 v20, s[68:71], s57 offen offset:3072 lds
    s_add_u32 m0, s25, 90112
    s_nop 0
    buffer_load_dwordx4 v21, s[72:75], s60 offen offset:0 lds
    buffer_load_dwordx4 v22, s[72:75], s60 offen offset:1024 lds
    s_add_u32 s57, s57, 128
    s_add_u32 s60, s60, 245760
    s_cmp_eq_u32 s57, 1280
    s_cselect_b32 s57, 0, s57
    s_cselect_b32 s60, s26, s60
    ds_read_b64_tr_b16 v[60:61], v76 offset:24576
    ds_read_b64_tr_b16 v[62:63], v76 offset:25088
    ds_read_b64_tr_b16 v[64:65], v77 offset:24576
    ds_read_b64_tr_b16 v[66:67], v77 offset:25088
    s_waitcnt lgkmcnt(2)
    v_mfma_f32_16x16x32_bf16 v[40:43], v[32:35], v[60:63], v[40:43]
    s_waitcnt lgkmcnt(0)
    v_mfma_f32_16x16x32_bf16 v[40:43], v[36:39], v[64:67], v[40:43]
    s_add_u32 s15, s65, 3
    s_sub_u32 s27, s15, 10
    s_min_u32 s15, s15, s27
    s_mul_i32 s27, s64, 10
    s_add_u32 s27, s27, s15
    s_add_u32 s27, s27, 10
    v_add_u32 v2, 0, v1
    v_mul_u32_u24 v3, 205, v2
    v_lshrrev_b32 v3, 11, v3
    v_lshlrev_b32 v2, 4, v2
    v_mul_u32_u24 v3, 1120, v3
    v_add_u32 v2, v2, v3
    v_subrev_u32 v160, 0, v2
    v_add_u32 v2, 64, v1
    v_mul_u32_u24 v3, 205, v2
    v_lshrrev_b32 v3, 11, v3
    v_lshlrev_b32 v2, 4, v2
    v_mul_u32_u24 v3, 1120, v3
    v_add_u32 v2, v2, v3
    v_subrev_u32 v161, 1024, v2
    v_add_u32 v2, 128, v1
    v_mul_u32_u24 v3, 205, v2
    v_lshrrev_b32 v3, 11, v3
    v_lshlrev_b32 v2, 4, v2
    v_mul_u32_u24 v3, 1120, v3
    v_add_u32 v2, v2, v3
    v_subrev_u32 v162, 2048, v2
    v_add_u32 v2, 192, v1
    v_mul_u32_u24 v3, 205, v2
    v_lshrrev_b32 v3, 11, v3
    v_lshlrev_b32 v2, 4, v2
    v_mul_u32_u24 v3, 1120, v3
    v_add_u32 v2, v2, v3
    s_waitcnt vmcnt(6)
    s_barrier
    s_add_u32 m0, s62, 0
    s_nop 0
    buffer_load_dwordx4 v17, s[68:71], s57 offen offset:0 lds
    buffer_load_dwordx4 v18, s[68:71], s57 offen offset:1024 lds
    buffer_load_dwordx4 v19, s[68:71], s57 offen offset:2048 lds
    buffer_load_dwordx4 v20, s[68:71], s57 offen offset:3072 lds
    s_add_u32 m0, s25, 16384
    s_nop 0
    buffer_load_dwordx4 v21, s[72:75], s60 offen offset:0 lds
    buffer_load_dwordx4 v22, s[72:75], s60 offen offset:1024 lds
    s_add_u32 s57, s57, 128
    s_add_u32 s60, s60, 245760
    s_cmp_eq_u32 s57, 1280
    s_cselect_b32 s57, 0, s57
    s_cselect_b32 s60, s26, s60
    ds_read_b64_tr_b16 v[60:61], v76 offset:49152
    ds_read_b64_tr_b16 v[62:63], v76 offset:49664
    ds_read_b64_tr_b16 v[64:65], v77 offset:49152
    ds_read_b64_tr_b16 v[66:67], v77 offset:49664
    s_waitcnt lgkmcnt(2)
    v_mfma_f32_16x16x32_bf16 v[40:43], v[32:35], v[60:63], v[40:43]
    s_waitcnt lgkmcnt(0)
    v_mfma_f32_16x16x32_bf16 v[40:43], v[36:39], v[64:67], v[40:43]
    v_subrev_u32 v163, 3072, v2
    v_add_u32 v2, 256, v1
    v_mul_u32_u24 v3, 205, v2
    v_lshrrev_b32 v3, 11, v3
    v_lshlrev_b32 v2, 4, v2
    v_mul_u32_u24 v3, 1120, v3
    v_add_u32 v2, v2, v3
    v_subrev_u32 v164, 0, v2
    v_lshlrev_b32 v5, 4, v1
    s_lshr_b32 s16, s14, 1
    s_lshl_b32 s15, s16, 10
    s_add_u32 s15, s15, 2621440
    s_add_u32 s52, s18, s15
    s_add_u32 s53, s52, 31744
    s_add_u32 s54, s19, s15
    s_sub_u32 s54, s54, 2048
    s_mul_i32 s15, s12, 0
    s_mul_i32 s16, s16, 82944
    s_add_u32 s15, s15, s16
    s_add_u32 s15, s15, 5242880
    s_movk_i32 s55, 2048
    s_bitcmp1_b32 s14, 0
    s_cmov_b32 s52, s15
    s_cmov_b32 s53, s15
    s_cmov_b32 s54, s15
    s_cmov_b32 s55, 165888
    s_cselect_b64 vcc, -1, 0
    s_mul_i32 s56, s14, 3072
    s_mul_i32 s15, s12, 320
    v_mov_b32 v6, 10240
    v_add_u32 v2, 0, v1
    v_min_u32 v2, 167, v2
    v_mul_u32_u24 v3, 3121, v2
    s_waitcnt vmcnt(6)
    s_barrier
    s_add_u32 m0, s62, 24576
    s_nop 0
    buffer_load_dwordx4 v17, s[68:71], s57 offen offset:0 lds
    buffer_load_dwordx4 v18, s[68:71], s57 offen offset:1024 lds
    buffer_load_dwordx4 v19, s[68:71], s57 offen offset:2048 lds
    buffer_load_dwordx4 v20, s[68:71], s57 offen offset:3072 lds
    s_add_u32 m0, s25, 40960
    s_nop 0
    buffer_load_dwordx4 v21, s[72:75], s60 offen offset:0 lds
    buffer_load_dwordx4 v22, s[72:75], s60 offen offset:1024 lds
    s_add_u32 s57, s57, 128
    s_add_u32 s60, s60, 245760
    s_cmp_eq_u32 s57, 1280
    s_cselect_b32 s57, 0, s57
    s_cselect_b32 s60, s26, s60
    ds_read_b64_tr_b16 v[60:61], v78 offset:0
    ds_read_b64_tr_b16 v[62:63], v78 offset:512
    ds_read_b64_tr_b16 v[64:65], v79 offset:0
    ds_read_b64_tr_b16 v[66:67], v79 offset:512
    s_waitcnt lgkmcnt(2)
    v_mfma_f32_16x16x32_bf16 v[40:43], v[32:35], v[60:63], v[40:43]
    s_waitcnt lgkmcnt(0)
    v_mfma_f32_16x16x32_bf16 v[40:43], v[36:39], v[64:67], v[40:43]
    v_lshrrev_b32 v3, 16, v3
    v_mul_u32_u24 v7, 21, v3
    v_sub_u32 v2, v2, v7
    v_cmp_gt_u32 s[44:45], 20, v2
    v_lshl_add_u32 v2, v2, 4, s15
    s_nop 0
    v_cndmask_b32 v2, v6, v2, s[44:45]
    v_mul_u32_u24 v3, 10368, v3
    v_add_u32 v2, v2, v3
    v_subrev_u32 v2, 0, v2
    v_cndmask_b32 v16, v5, v2, vcc
    v_add_u32 v2, 64, v1
    v_min_u32 v2, 167, v2
    v_mul_u32_u24 v3, 3121, v2
    v_lshrrev_b32 v3, 16, v3
    v_mul_u32_u24 v7, 21, v3
    v_sub_u32 v2, v2, v7
    v_cmp_gt_u32 s[44:45], 20, v2
    v_lshl_add_u32 v2, v2, 4, s15
    s_nop 0
    v_cndmask_b32 v2, v6, v2, s[44:45]
    v_mul_u32_u24 v3, 10368, v3
    v_add_u32 v2, v2, v3
    v_subrev_u32 v2, 1024, v2
    v_cndmask_b32 v10, v5, v2, vcc
    v_add_u32 v2, 128, v1
    v_min_u32 v2, 167, v2
    v_mul_u32_u24 v3, 3121, v2
    v_lshrrev_b32 v3, 16, v3
    v_mul_u32_u24 v7, 21, v3
    v_sub_u32 v2, v2, v7
    v_cmp_gt_u32 s[44:45], 20, v2
    v_lshl_add_u32 v2, v2, 4, s15
    s_nop 0
    v_cndmask_b32 v2, v6, v2, s[44:45]
    s_waitcnt vmcnt(6)
    s_barrier
    s_add_u32 m0, s62, 49152
    s_nop 0
    buffer_load_dwordx4 v17, s[68:71], s57 offen offset:0 lds
    buffer_load_dwordx4 v18, s[68:71], s57 offen offset:1024 lds
    buffer_load_dwordx4 v19, s[68:71], s57 offen offset:2048 lds
    buffer_load_dwordx4 v20, s[68:71], s57 offen offset:3072 lds
    s_add_u32 m0, s25, 65536
    s_nop 0
    buffer_load_dwordx4 v21, s[72:75], s60 offen offset:0 lds
    buffer_load_dwordx4 v22, s[72:75], s60 offen offset:1024 lds
    s_add_u32 s57, s57, 128
    s_add_u32 s60, s60, 245760
    s_cmp_eq_u32 s57, 1280
    s_cselect_b32 s57, 0, s57
    s_cselect_b32 s60, s26, s60
    ds_read_b64_tr_b16 v[60:61], v76 offset:0
    ds_read_b64_tr_b16 v[62:63], v76 offset:512
    ds_read_b64_tr_b16 v[64:65], v77 offset:0
    ds_read_b64_tr_b16 v[66:67], v77 offset:512
    s_waitcnt lgkmcnt(2)
    v_mfma_f32_16x16x32_bf16 v[40:43], v[32:35], v[60:63], v[40:43]
    s_waitcnt lgkmcnt(0)
    v_mfma_f32_16x16x32_bf16 v[40:43], v[36:39], v[64:67], v[40:43]
    v_mul_u32_u24 v3, 10368, v3
    v_add_u32 v2, v2, v3
    v_subrev_u32 v2, 2048, v2
    v_cndmask_b32 v4, v5, v2, vcc
    s_waitcnt lgkmcnt(0)
    s_mov_b32 s20, s6
    s_mov_b32 s21, s7
    s_and_b32 s28, s12, 3
    s_lshl2_add_u32 s28, s24, s28
    s_lshl_b32 s29, s17, 1
    s_lshl2_add_u32 s29, s24, s29
    s_lshr_b32 s30, s2, 4
    s_getreg_b32 s31, hwreg(HW_REG_XCC_ID)
    s_add_u32 s31, s31, 1
    v_mov_b32 v8, s31
    s_lshl_b32 s15, s24, 7
    s_add_u32 s15, s15, 42467328
    v_and_b32 v7, 31, v1
    v_lshl_add_u32 v7, v7, 10, s15
    s_lshl2_add_u32 s58, s30, s14
    s_mul_i32 s58, s58, 61440
    s_add_u32 s58, s58, 23068672
    s_lshl2_add_u32 s59, s13, s14
    s_mul_i32 s59, s59, 25600
    s_add_u32 s59, s59, 27262976
    s_mul_i32 s61, s14, 25632
    s_add_u32 s61, s61, 49152
    s_mul_i32 s58, s14, 491520
    s_mul_i32 s15, s30, 192
    s_add_u32 s58, s58, s15
    s_mul_i32 s59, s14, 204800
    s_mul_i32 s15, s13, 160
    s_waitcnt vmcnt(6)
    s_barrier
    s_add_u32 m0, s62, 73728
    s_nop 0
    buffer_load_dwordx4 v17, s[68:71], s57 offen offset:0 lds
    buffer_load_dwordx4 v18, s[68:71], s57 offen offset:1024 lds
    buffer_load_dwordx4 v19, s[68:71], s57 offen offset:2048 lds
    buffer_load_dwordx4 v20, s[68:71], s57 offen offset:3072 lds
    s_add_u32 m0, s25, 90112
    s_nop 0
    buffer_load_dwordx4 v21, s[72:75], s60 offen offset:0 lds
    buffer_load_dwordx4 v22, s[72:75], s60 offen offset:1024 lds
    s_add_u32 s57, s57, 128
    s_add_u32 s60, s60, 245760
    s_cmp_eq_u32 s57, 1280
    s_cselect_b32 s57, 0, s57
    s_cselect_b32 s60, s26, s60
    ds_read_b64_tr_b16 v[60:61], v76 offset:24576
    ds_read_b64_tr_b16 v[62:63], v76 offset:25088
    ds_read_b64_tr_b16 v[64:65], v77 offset:24576
    ds_read_b64_tr_b16 v[66:67], v77 offset:25088
    s_waitcnt lgkmcnt(2)
    v_mfma_f32_16x16x32_bf16 v[40:43], v[32:35], v[60:63], v[40:43]
    s_waitcnt lgkmcnt(0)
    v_mfma_f32_16x16x32_bf16 v[40:43], v[36:39], v[64:67], v[40:43]
    s_add_u32 s59, s59, s15
    s_mov_b32 s44, s36
    s_mov_b32 s45, s37
    s_mov_b32 s46, 1966080
    s_mov_b32 s47, 0x20000
    s_mov_b32 s48, s38
    s_mov_b32 s49, s39
    s_mov_b32 s50, 1966080
    s_mov_b32 s51, 0x20000
    v_add_u32 v2, 0, v1
    v_mul_u32_u24 v3, 171, v2
    v_lshrrev_b32 v3, 11, v3
    v_mul_u32_u24 v3, 2880, v3
    v_add_u32 v12, v3, v5
    v_add_u32 v2, 64, v1
    v_mul_u32_u24 v3, 171, v2
    v_lshrrev_b32 v3, 11, v3
    v_mul_u32_u24 v3, 2880, v3
    v_add_u32 v13, v3, v5
    v_add_u32 v2, 128, v1
    v_mul_u32_u24 v3, 171, v2
    v_lshrrev_b32 v3, 11, v3
    v_mul_u32_u24 v3, 2880, v3
    v_add_u32 v14, v3, v5
    s_mul_i32 s15, s14, 48
    s_add_u32 s15, s15, 49152
    v_lshrrev_b32 v2, 4, v1
    v_mul_u32_u24 v2, 25632, v2
    v_bfe_u32 v3, v1, 2, 2
    v_mul_u32_u24 v3, 192, v3
    v_add3_u32 v2, v2, v3, s15
    v_and_b32 v3, 1, v1
    s_waitcnt vmcnt(6)
    s_barrier
    s_add_u32 m0, s62, 0
    s_nop 0
    buffer_load_dwordx4 v17, s[68:71], s57 offen offset:0 lds
    buffer_load_dwordx4 v18, s[68:71], s57 offen offset:1024 lds
    buffer_load_dwordx4 v19, s[68:71], s57 offen offset:2048 lds
    buffer_load_dwordx4 v20, s[68:71], s57 offen offset:3072 lds
    s_add_u32 m0, s25, 16384
    s_nop 0
    buffer_load_dwordx4 v21, s[72:75], s60 offen offset:0 lds
    buffer_load_dwordx4 v22, s[72:75], s60 offen offset:1024 lds
    s_add_u32 s57, s57, 128
    s_add_u32 s60, s60, 245760
    s_cmp_eq_u32 s57, 1280
    s_cselect_b32 s57, 0, s57
    s_cselect_b32 s60, s26, s60
    ds_read_b64_tr_b16 v[60:61], v76 offset:49152
    ds_read_b64_tr_b16 v[62:63], v76 offset:49664
    ds_read_b64_tr_b16 v[64:65], v77 offset:49152
    ds_read_b64_tr_b16 v[66:67], v77 offset:49664
    s_waitcnt lgkmcnt(2)
    v_mfma_f32_16x16x32_bf16 v[40:43], v[32:35], v[60:63], v[40:43]
    s_waitcnt lgkmcnt(0)
    v_mfma_f32_16x16x32_bf16 v[40:43], v[36:39], v[64:67], v[40:43]
    v_bfe_u32 v9, v1, 1, 1
    v_lshl_add_u32 v15, v3, 4, v2
    v_lshl_add_u32 v15, v9, 3, v15
    v_lshl_add_u32 v6, v3, 3, v2
    v_mul_u32_u24 v9, 3072, v9
    v_add3_u32 v6, v6, v9, 32
    v_mov_b32 v5, v16
    s_lshr_b32 s16, s12, 3
    s_mul_i32 s15, s16, s55
    s_lshl2_add_u32 s52, s15, s52
    s_lshl2_add_u32 s53, s15, s53
    s_lshl2_add_u32 s54, s15, s54
    s_lshl3_add_u32 s15, s12, s14
    s_lshl_b32 s15, s15, 8
    s_add_u32 s15, s15, 42532864
    v_lshl_add_u32 v56, v1, 2, s15
    s_lshl_b32 s16, s16, 6
    v_add_u32 v2, s16, v56
    s_lshl2_add_u32 s16, s13, s14
    s_lshl_b32 s15, s12, 11
    s_lshl4_add_u32 s15, s16, s15
    s_add_u32 s15, s15, 42533888
    v_and_b32 v3, 3, v1
    v_lshl_add_u32 v3, v3, 2, s15
    v_cmp_gt_u32 vcc, 16, v1
    s_nop 1
    v_cndmask_b32 v2, v3, v2, vcc
    v_lshlrev_b32 v58, 4, v1
    s_lshl_b32 s16, s16, 10
    s_add_u32 s63, s18, s16
    s_add_u32 s64, s63, 31744
    s_add_u32 s65, s19, s16
    s_sub_u32 s65, s65, 2048
    s_waitcnt vmcnt(6)
    s_barrier
    s_add_u32 m0, s62, 24576
    s_nop 0
    buffer_load_dwordx4 v17, s[68:71], s57 offen offset:0 lds
    buffer_load_dwordx4 v18, s[68:71], s57 offen offset:1024 lds
    buffer_load_dwordx4 v19, s[68:71], s57 offen offset:2048 lds
    buffer_load_dwordx4 v20, s[68:71], s57 offen offset:3072 lds
    s_add_u32 m0, s25, 40960
    s_nop 0
    buffer_load_dwordx4 v21, s[72:75], s60 offen offset:0 lds
    buffer_load_dwordx4 v22, s[72:75], s60 offen offset:1024 lds
    s_add_u32 s57, s57, 128
    s_add_u32 s60, s60, 245760
    s_cmp_eq_u32 s57, 1280
    s_cselect_b32 s57, 0, s57
    s_cselect_b32 s60, s26, s60
    s_sub_u32 s60, s60, s26
    s_lshl_b32 s26, s27, 7
    s_add_u32 s60, s60, s26
    s_cmp_eq_u32 s13, 7
    s_cbranch_scc1 kx_fused_kernel_sp6
    s_add_u32 m0, s25, 110592
    s_nop 0
    buffer_load_dwordx4 v21, s[72:75], s60 offen offset:0 lds
    buffer_load_dwordx4 v22, s[72:75], s60 offen offset:1024 lds
    s_add_u32 s57, s57, 128
    s_add_u32 s60, s60, 245760
    s_cmp_eq_u32 s57, 1280
    s_cselect_b32 s57, 0, s57
    s_cselect_b32 s60, s26, s60
    s_add_u32 m0, s25, 118784
    s_nop 0
    buffer_load_dwordx4 v21, s[72:75], s60 offen offset:0 lds
    buffer_load_dwordx4 v22, s[72:75], s60 offen offset:1024 lds
    s_add_u32 s57, s57, 128
    s_add_u32 s60, s60, 245760
    s_cmp_eq_u32 s57, 1280
    s_cselect_b32 s57, 0, s57
    s_cselect_b32 s60, s26, s60
    s_add_u32 m0, s25, 126976
    s_nop 0
    buffer_load_dwordx4 v21, s[72:75], s60 offen offset:0 lds
    buffer_load_dwordx4 v22, s[72:75], s60 offen offset:1024 lds
    s_add_u32 s57, s57, 128
    s_add_u32 s60, s60, 245760
    s_cmp_eq_u32 s57, 1280
    s_cselect_b32 s57, 0, s57
    s_cselect_b32 s60, s26, s60
    ds_read_b64_tr_b16 v[60:61], v78 offset:0
    ds_read_b64_tr_b16 v[62:63], v78 offset:512
    ds_read_b64_tr_b16 v[64:65], v79 offset:0
    ds_read_b64_tr_b16 v[66:67], v79 offset:512
    s_waitcnt lgkmcnt(2)
    v_mfma_f32_16x16x32_bf16 v[40:43], v[32:35], v[60:63], v[40:43]
    s_waitcnt lgkmcnt(0)
    v_mfma_f32_16x16x32_bf16 v[40:43], v[36:39], v[64:67], v[40:43]
    s_waitcnt vmcnt(12)
    s_barrier
    s_add_u32 m0, s25, 135168
    s_nop 0
    buffer_load_dwordx4 v21, s[72:75], s60 offen offset:0 lds
    buffer_load_dwordx4 v22, s[72:75], s60 offen offset:1024 lds
    s_add_u32 s57, s57, 128
    s_add_u32 s60, s60, 245760
    s_cmp_eq_u32 s57, 1280
    s_cselect_b32 s57, 0, s57
    s_cselect_b32 s60, s26, s60
    s_add_u32 m0, s25, 143360
    s_nop 0
    buffer_load_dwordx4 v21, s[72:75], s60 offen offset:0 lds
    buffer_load_dwordx4 v22, s[72:75], s60 offen offset:1024 lds
    s_add_u32 s57, s57, 128
    s_add_u32 s60, s60, 245760
    s_cmp_eq_u32 s57, 1280
    s_cselect_b32 s57, 0, s57
    s_cselect_b32 s60, s26, s60
    s_add_u32 m0, s25, 151552
    s_nop 0
    buffer_load_dwordx4 v21, s[72:75], s60 offen offset:0 lds
    buffer_load_dwordx4 v22, s[72:75], s60 offen offset:1024 lds
    s_add_u32 s57, s57, 128
    s_add_u32 s60, s60, 245760
    s_cmp_eq_u32 s57, 1280
    s_cselect_b32 s57, 0, s57
    s_cselect_b32 s60, s26, s60
    ds_read_b64_tr_b16 v[60:61], v76 offset:0
    ds_read_b64_tr_b16 v[62:63], v76 offset:512
    ds_read_b64_tr_b16 v[64:65], v77 offset:0
    ds_read_b64_tr_b16 v[66:67], v77 offset:512
    s_waitcnt lgkmcnt(2)
    v_mfma_f32_16x16x32_bf16 v[40:43], v[32:35], v[60:63], v[40:43]
    s_waitcnt lgkmcnt(0)
    v_mfma_f32_16x16x32_bf16 v[40:43], v[36:39], v[64:67], v[40:43]
    s_waitcnt vmcnt(12)
    s_barrier
    ds_read_b64_tr_b16 v[60:61], v76 offset:24576
    ds_read_b64_tr_b16 v[62:63], v76 offset:25088
    ds_read_b64_tr_b16 v[64:65], v77 offset:24576
    ds_read_b64_tr_b16 v[66:67], v77 offset:25088
    s_waitcnt lgkmcnt(2)
    v_mfma_f32_16x16x32_bf16 v[40:43], v[32:35], v[60:63], v[40:43]
    s_waitcnt lgkmcnt(0)
    v_mfma_f32_16x16x32_bf16 v[40:43], v[36:39], v[64:67], v[40:43]
    s_nop 7
    v_cvt_pk_bf16_f32 v42, v40, v40
    v_and_b32 v41, 0xffff0000, v42
    v_sub_f32 v40, v40, v41
    v_cvt_pk_bf16_f32 v43, v40, v40
    ds_write_b64 v80, v[42:43] offset:0
    s_waitcnt lgkmcnt(0)
    s_add_u32 m0, s25, 49152
    s_nop 0
    buffer_load_dwordx4 v21, s[72:75], s60 offen offset:0 lds
    buffer_load_dwordx4 v22, s[72:75], s60 offen offset:1024 lds
    s_add_u32 s57, s57, 128
    s_add_u32 s60, s60, 245760
    s_cmp_eq_u32 s57, 1280
    s_cselect_b32 s57, 0, s57
    s_cselect_b32 s60, s26, s60
    s_add_u32 m0, s25, 57344
    s_nop 0
    buffer_load_dwordx4 v21, s[72:75], s60 offen offset:0 lds
    buffer_load_dwordx4 v22, s[72:75], s60 offen offset:1024 lds
    s_add_u32 s57, s57, 128
    s_add_u32 s60, s60, 245760
    s_cmp_eq_u32 s57, 1280
    s_cselect_b32 s57, 0, s57
    s_cselect_b32 s60, s26, s60
    s_add_u32 m0, s25, 65536
    s_nop 0
    buffer_load_dwordx4 v21, s[72:75], s60 offen offset:0 lds
    buffer_load_dwordx4 v22, s[72:75], s60 offen offset:1024 lds
    s_add_u32 s57, s57, 128
    s_add_u32 s60, s60, 245760
    s_cmp_eq_u32 s57, 1280
    s_cselect_b32 s57, 0, s57
    s_cselect_b32 s60, s26, s60
    s_add_u32 m0, s25, 73728
    s_nop 0
    buffer_load_dwordx4 v21, s[72:75], s60 offen offset:0 lds
    buffer_load_dwordx4 v22, s[72:75], s60 offen offset:1024 lds
    s_barrier
    v_add_u32 v78, 94208, v76
    v_add_u32 v79, 94208, v77
    s_waitcnt vmcnt(8)
    s_barrier
    ds_read_b64_tr_b16 v[60:61], v78 offset:0
    ds_read_b64_tr_b16 v[62:63], v78 offset:512
    ds_read_b64_tr_b16 v[64:65], v79 offset:0
    ds_read_b64_tr_b16 v[66:67], v79 offset:512
    ds_read_b64_tr_b16 v[68:69], v78 offset:8192
    ds_read_b64_tr_b16 v[70:71], v78 offset:8704
    ds_read_b64_tr_b16 v[72:73], v79 offset:8192
    ds_read_b64_tr_b16 v[74:75], v79 offset:8704
    s_waitcnt lgkmcnt(6)
    v_mfma_f32_16x16x32_bf16 v[40:43], v[32:35], v[60:63], 0
    s_waitcnt lgkmcnt(4)
    v_mfma_f32_16x16x32_bf16 v[40:43], v[36:39], v[64:67], v[40:43]
    ds_read_b64_tr_b16 v[60:61], v78 offset:16384
    ds_read_b64_tr_b16 v[62:63], v78 offset:16896
    ds_read_b64_tr_b16 v[64:65], v79 offset:16384
    ds_read_b64_tr_b16 v[66:67], v79 offset:16896
    s_waitcnt lgkmcnt(6)
    v_mfma_f32_16x16x32_bf16 v[40:43], v[32:35], v[68:71], v[40:43]
    s_waitcnt lgkmcnt(4)
    v_mfma_f32_16x16x32_bf16 v[40:43], v[36:39], v[72:75], v[40:43]
    ds_read_b64_tr_b16 v[68:69], v78 offset:24576
    ds_read_b64_tr_b16 v[70:71], v78 offset:25088
    ds_read_b64_tr_b16 v[72:73], v79 offset:24576
    ds_read_b64_tr_b16 v[74:75], v79 offset:25088
    s_waitcnt lgkmcnt(6)
    v_mfma_f32_16x16x32_bf16 v[40:43], v[32:35], v[60:63], v[40:43]
    s_waitcnt lgkmcnt(4)
    v_mfma_f32_16x16x32_bf16 v[40:43], v[36:39], v[64:67], v[40:43]
    ds_read_b64_tr_b16 v[60:61], v78 offset:32768
    ds_read_b64_tr_b16 v[62:63], v78 offset:33280
    ds_read_b64_tr_b16 v[64:65], v79 offset:32768
    ds_read_b64_tr_b16 v[66:67], v79 offset:33280
    s_waitcnt lgkmcnt(6)
    v_mfma_f32_16x16x32_bf16 v[40:43], v[32:35], v[68:71], v[40:43]
    s_waitcnt lgkmcnt(4)
    v_mfma_f32_16x16x32_bf16 v[40:43], v[36:39], v[72:75], v[40:43]
    ds_read_b64_tr_b16 v[68:69], v78 offset:40960
    ds_read_b64_tr_b16 v[70:71], v78 offset:41472
    ds_read_b64_tr_b16 v[72:73], v79 offset:40960
    ds_read_b64_tr_b16 v[74:75], v79 offset:41472
    s_waitcnt lgkmcnt(6)
    v_mfma_f32_16x16x32_bf16 v[40:43], v[32:35], v[60:63], v[40:43]
    s_waitcnt lgkmcnt(4)
    v_mfma_f32_16x16x32_bf16 v[40:43], v[36:39], v[64:67], v[40:43]
    s_waitcnt lgkmcnt(2)
    v_mfma_f32_16x16x32_bf16 v[40:43], v[32:35], v[68:71], v[40:43]
    s_waitcnt lgkmcnt(0)
    v_mfma_f32_16x16x32_bf16 v[40:43], v[36:39], v[72:75], v[40:43]
    s_waitcnt vmcnt(0)
    ds_read_b64_tr_b16 v[60:61], v76 offset:32768
    ds_read_b64_tr_b16 v[62:63], v76 offset:33280
    ds_read_b64_tr_b16 v[64:65], v77 offset:32768
    ds_read_b64_tr_b16 v[66:67], v77 offset:33280
    ds_read_b64_tr_b16 v[68:69], v76 offset:40960
    ds_read_b64_tr_b16 v[70:71], v76 offset:41472
    ds_read_b64_tr_b16 v[72:73], v77 offset:40960
    ds_read_b64_tr_b16 v[74:75], v77 offset:41472
    s_waitcnt lgkmcnt(6)
    v_mfma_f32_16x16x32_bf16 v[40:43], v[32:35], v[60:63], v[40:43]
    s_waitcnt lgkmcnt(4)
    v_mfma_f32_16x16x32_bf16 v[40:43], v[36:39], v[64:67], v[40:43]
    ds_read_b64_tr_b16 v[60:61], v76 offset:49152
    ds_read_b64_tr_b16 v[62:63], v76 offset:49664
    ds_read_b64_tr_b16 v[64:65], v77 offset:49152
    ds_read_b64_tr_b16 v[66:67], v77 offset:49664
    s_waitcnt lgkmcnt(6)
    v_mfma_f32_16x16x32_bf16 v[40:43], v[32:35], v[68:71], v[40:43]
    s_waitcnt lgkmcnt(4)
    v_mfma_f32_16x16x32_bf16 v[40:43], v[36:39], v[72:75], v[40:43]
    ds_read_b64_tr_b16 v[68:69], v76 offset:57344
    ds_read_b64_tr_b16 v[70:71], v76 offset:57856
    ds_read_b64_tr_b16 v[72:73], v77 offset:57344
    ds_read_b64_tr_b16 v[74:75], v77 offset:57856
    s_waitcnt lgkmcnt(6)
    v_mfma_f32_16x16x32_bf16 v[40:43], v[32:35], v[60:63], v[40:43]
    s_waitcnt lgkmcnt(4)
    v_mfma_f32_16x16x32_bf16 v[40:43], v[36:39], v[64:67], v[40:43]
    s_waitcnt lgkmcnt(2)
    v_mfma_f32_16x16x32_bf16 v[40:43], v[32:35], v[68:71], v[40:43]
    s_waitcnt lgkmcnt(0)
    v_mfma_f32_16x16x32_bf16 v[40:43], v[36:39], v[72:75], v[40:43]
    s_nop 7
    v_cvt_pk_bf16_f32 v42, v40, v40
    v_and_b32 v41, 0xffff0000, v42
    v_sub_f32 v40, v40, v41
    v_cvt_pk_bf16_f32 v43, v40, v40
    ds_write_b64 v80, v[42:43] offset:2048
    s_waitcnt lgkmcnt(0)
    s_barrier
kx_fused_kernel_hset4:
    s_mov_b64 exec, 0xfffff
    s_mov_b32 s27, 65536
kx_fused_kernel_poll7:
    buffer_load_dword v3, v2, s[20:23], 0 offen sc1
    s_sub_u32 s27, s27, 1
    s_waitcnt vmcnt(0)
    s_cbranch_scc1 kx_fused_kernel_pollx8
kx_fused_kernel_pollc9:
    v_cmp_eq_u32 vcc, 0, v3
    s_cbranch_vccnz kx_fused_kernel_poll7
kx_fused_kernel_pollx8:
    s_mov_b64 exec, -1
    s_add_u32 m0, s56, 36864
    s_nop 0
    buffer_load_dwordx4 v58, s[20:23], s63 offen offset:0 lds
    buffer_load_dwordx4 v58, s[20:23], s64 offen offset:1024 lds
    buffer_load_dwordx4 v58, s[20:23], s65 offen offset:2048 lds
    s_add_u32 m0, s56, 0
    s_nop 0
    buffer_load_dwordx4 v5, s[20:23], s52 offen offset:0 lds
    buffer_load_dwordx4 v10, s[20:23], s53 offen offset:1024 lds
    buffer_load_dwordx4 v4, s[20:23], s54 offen offset:2048 lds
    s_add_u32 s52, s52, s55
    s_add_u32 s53, s53, s55
    s_add_u32 s54, s54, s55
    s_add_u32 m0, s56, 12288
    s_nop 0
    buffer_load_dwordx4 v5, s[20:23], s52 offen offset:0 lds
    buffer_load_dwordx4 v10, s[20:23], s53 offen offset:1024 lds
    buffer_load_dwordx4 v4, s[20:23], s54 offen offset:2048 lds
    s_add_u32 s52, s52, s55
    s_add_u32 s53, s53, s55
    s_add_u32 s54, s54, s55
    s_mov_b32 s64, s40
    s_mov_b32 s65, s41
    s_mov_b32 s66, 1966080
    s_mov_b32 s67, 0x20000
    s_and_b32 s69, s14, 1
    s_lshl1_add_u32 s57, s2, s69
    s_and_b32 s16, s57, 7
    s_lshr_b32 s15, s57, 3
    s_mul_i32 s68, s15, 40960
    s_mul_i32 s16, s16, 160
    s_add_u32 s68, s68, s16
    s_and_b32 s16, s57, 7
    s_lshr_b32 s15, s57, 3
    s_lshl_b32 s60, s16, 11
    s_lshl2_add_u32 s60, s15, s60
    s_add_u32 s60, s60, 42534400
    s_mul_i32 s62, s16, 240
    s_add_u32 s62, s62, s15
    s_mul_i32 s15, s15, 43
    s_lshr_b32 s15, s15, 8
    s_mul_i32 s15, s15, 24
    s_add_u32 s62, s62, s15
    s_lshl_b32 s62, s62, 10
    s_add_u32 s62, s62, 20971520
    s_mul_i32 s69, s69, 5120
    s_add_u32 s69, s69, 151680
    s_cmp_lt_u32 s57, 384
    s_cselect_b32 s68, s68, 0
    s_sub_u32 s15, s14, 1
    s_cmp_lt_u32 s15, 2
    s_cselect_b32 s57, 999, s57
    s_cmp_lt_u32 s57, 384
    s_cselect_b32 s15, 0, 1073741824
    s_cselect_b32 s62, s62, 0
    s_cselect_b32 s60, s60, 0
    v_lshl_add_u32 v157, v1, 4, s15
    v_mov_b32 v158, s15
    v_lshrrev_b32 v156, 4, v1
    v_bfe_u32 v159, v1, 2, 2
    v_lshl_add_u32 v156, v156, 3, v159
    v_mul_u32_u24 v156, 160, v156
    v_and_b32 v159, 3, v1
    v_lshl_add_u32 v159, v159, 3, s69
    v_add_u32 v156, v156, v159
    v_mov_b32 v159, 1
    s_lshl_b32 s15, s13, 11
    s_add_u32 s15, s15, 42534400
    v_min_u32 v2, 47, v1
    v_lshl_add_u32 v2, v2, 2, s15
    s_waitcnt vmcnt(3)
    s_barrier
    s_add_u32 m0, s56, 24576
    s_nop 0
    buffer_load_dwordx4 v5, s[20:23], s52 offen offset:0 lds
    buffer_load_dwordx4 v10, s[20:23], s53 offen offset:1024 lds
    buffer_load_dwordx4 v4, s[20:23], s54 offen offset:2048 lds
    s_add_u32 s52, s52, s55
    s_add_u32 s53, s53, s55
    s_add_u32 s54, s54, s55
    s_lshl_b32 s15, s2, 7
    s_add_u32 s15, s15, 42467328
    s_cmp_eq_u32 s14, 3
    s_cselect_b32 s15, s15, 1073741824
    v_mov_b32 v9, s15
    s_mov_b64 exec, 1
    buffer_store_dword v8, v9, s[20:23], 0 offen sc1
    s_mov_b64 exec, -1
    s_add_u32 m0, s61, 12288
    s_nop 0
    buffer_load_dwordx4 v12, s[44:47], s58 offen offset:0  lds
    buffer_load_dwordx4 v13, s[44:47], s58 offen offset:1024  lds
    buffer_load_dwordx4 v14, s[44:47], s58 offen offset:2048  lds
    s_add_u32 m0, s61, 15360
    s_nop 0
    buffer_load_dwordx4 v12, s[48:51], s58 offen offset:0  lds
    buffer_load_dwordx4 v13, s[48:51], s58 offen offset:1024  lds
    buffer_load_dwordx4 v14, s[48:51], s58 offen offset:2048  lds
    s_add_u32 s58, s58, 49152
    s_waitcnt vmcnt(10)
    s_barrier
    s_add_u32 m0, s56, 36864
    s_nop 0
    buffer_load_dwordx4 v5, s[20:23], s52 offen offset:0 lds
    buffer_load_dwordx4 v10, s[20:23], s53 offen offset:1024 lds
    buffer_load_dwordx4 v4, s[20:23], s54 offen offset:2048 lds
    s_lshr_b32 s15, s12, 3
    s_cmp_eq_u32 s15, 3
    s_cselect_b32 s15, -15, 1
    s_mul_i32 s15, s15, s55
    s_add_u32 s52, s52, s15
    s_add_u32 s53, s53, s15
    s_add_u32 s54, s54, s15
    s_cmp_lt_u32 s57, 384
    s_cselect_b64 exec, -1, 1
    s_add_u32 m0, s69, 0
    s_nop 0
    buffer_load_dwordx4 v160, s[64:67], s68 offen offset:0 nt lds
    buffer_load_dwordx4 v161, s[64:67], s68 offen offset:1024 nt lds
    buffer_load_dwordx4 v162, s[64:67], s68 offen offset:2048 nt lds
    buffer_load_dwordx4 v163, s[64:67], s68 offen offset:3072 nt lds
    s_add_u32 m0, s69, 4096
    s_nop 0
    buffer_load_dwordx4 v164, s[64:67], s68 offen offset:0 nt lds
    s_mov_b64 exec, -1
    s_add_u32 m0, s61, 18432
    s_nop 0
    buffer_load_dwordx4 v12, s[44:47], s58 offen offset:0  lds
    buffer_load_dwordx4 v13, s[44:47], s58 offen offset:1024  lds
    buffer_load_dwordx4 v14, s[44:47], s58 offen offset:2048  lds
    s_add_u32 m0, s61, 21504
    s_nop 0
    buffer_load_dwordx4 v12, s[48:51], s58 offen offset:0  lds
    buffer_load_dwordx4 v13, s[48:51], s58 offen offset:1024  lds
    buffer_load_dwordx4 v14, s[48:51], s58 offen offset:2048  lds
    s_add_u32 s58, s58, 49152
    s_waitcnt vmcnt(21)
    s_barrier
    buffer_load_dword v57, v56, s[20:23], 0 offen sc1
    s_add_u32 m0, s61, 0
    s_nop 0
    buffer_load_dwordx4 v12, s[44:47], s58 offen offset:0  lds
    buffer_load_dwordx4 v13, s[44:47], s58 offen offset:1024  lds
    buffer_load_dwordx4 v14, s[44:47], s58 offen offset:2048  lds
    s_add_u32 m0, s61, 3072
    s_nop 0
    buffer_load_dwordx4 v12, s[48:51], s58 offen offset:0  lds
    buffer_load_dwordx4 v13, s[48:51], s58 offen offset:1024  lds
    buffer_load_dwordx4 v14, s[48:51], s58 offen offset:2048  lds
    s_add_u32 s58, s58, 49152
    s_waitcnt vmcnt(6)
    s_mov_b32 s27, 65536
    s_waitcnt vmcnt(63)
    s_branch kx_fused_kernel_pollc12
kx_fused_kernel_poll10:
    buffer_load_dword v57, v56, s[20:23], 0 offen sc1
    s_sub_u32 s27, s27, 1
    s_waitcnt vmcnt(0)
    s_cbranch_scc1 kx_fused_kernel_pollx11
kx_fused_kernel_pollc12:
    v_cmp_eq_u32 vcc, 0, v57
    s_cbranch_vccnz kx_fused_kernel_poll10
kx_fused_kernel_pollx11:
    s_add_u32 m0, s56, 0
    s_nop 0
    buffer_load_dwordx4 v5, s[20:23], s52 offen offset:0 lds
    buffer_load_dwordx4 v10, s[20:23], s53 offen offset:1024 lds
    buffer_load_dwordx4 v4, s[20:23], s54 offen offset:2048 lds
    s_add_u32 s52, s52, s55
    s_add_u32 s53, s53, s55
    s_add_u32 s54, s54, s55
    s_barrier
    s_add_u32 m0, s56, 12288
    s_nop 0
    buffer_load_dwordx4 v5, s[20:23], s52 offen offset:0 lds
    buffer_load_dwordx4 v10, s[20:23], s53 offen offset:1024 lds
    buffer_load_dwordx4 v4, s[20:23], s54 offen offset:2048 lds
    s_add_u32 s52, s52, s55
    s_add_u32 s53, s53, s55
    s_add_u32 s54, s54, s55
    ds_read_b64_tr_b16 v[16:17], v15 offset:12288
    ds_read_b64_tr_b16 v[18:19], v15 offset:13056
    ds_read_b64_tr_b16 v[20:21], v15 offset:15360
    ds_read_b64_tr_b16 v[22:23], v15 offset:16128
    ds_read_b64_tr_b16 v[176:177], v6 offset:12288
    ds_read_b64_tr_b16 v[178:179], v6 offset:13056
    ds_read_b64_tr_b16 v[24:25], v15 offset:13824
    ds_read_b64_tr_b16 v[26:27], v15 offset:14592
    ds_read_b64_tr_b16 v[28:29], v15 offset:16896
    ds_read_b64_tr_b16 v[30:31], v15 offset:17664
    ds_read_b64_tr_b16 v[180:181], v6 offset:13824
    ds_read_b64_tr_b16 v[182:183], v6 offset:14592
    s_add_u32 m0, s61, 6144
    s_nop 0
    buffer_load_dwordx4 v12, s[44:47], s58 offen offset:0  lds
    buffer_load_dwordx4 v13, s[44:47], s58 offen offset:1024  lds
    buffer_load_dwordx4 v14, s[44:47], s58 offen offset:2048  lds
    s_add_u32 m0, s61, 9216
    s_nop 0
    buffer_load_dwordx4 v12, s[48:51], s58 offen offset:0  lds
    buffer_load_dwordx4 v13, s[48:51], s58 offen offset:1024  lds
    buffer_load_dwordx4 v14, s[48:51], s58 offen offset:2048  lds
    s_add_u32 s58, s58, 49152
    s_waitcnt lgkmcnt(0)
    s_waitcnt vmcnt(9)
    s_barrier
    s_add_u32 m0, s56, 24576
    s_nop 0
    buffer_load_dwordx4 v5, s[20:23], s52 offen offset:0 lds
    buffer_load_dwordx4 v10, s[20:23], s53 offen offset:1024 lds
    buffer_load_dwordx4 v4, s[20:23], s54 offen offset:2048 lds
    s_add_u32 s52, s52, s55
    s_add_u32 s53, s53, s55
    s_add_u32 s54, s54, s55
    ds_read_b64_tr_b16 v[136:137], v156 offset:0
    ds_read_b64_tr_b16 v[138:139], v156 offset:640
    ds_read_b64_tr_b16 v[140:141], v156 offset:32
    ds_read_b64_tr_b16 v[142:143], v156 offset:672
    ds_read_b64_tr_b16 v[144:145], v156 offset:64
    ds_read_b64_tr_b16 v[146:147], v156 offset:704
    ds_read_b64_tr_b16 v[148:149], v156 offset:96
    ds_read_b64_tr_b16 v[150:151], v156 offset:736
    ds_read_b64_tr_b16 v[152:153], v156 offset:128
    ds_read_b64_tr_b16 v[154:155], v156 offset:768
    s_waitcnt lgkmcnt(8)
    buffer_store_dwordx4 v[136:139], v157, s[20:23], s62 offen sc1
    s_add_u32 s62, s62, 6144
    s_waitcnt lgkmcnt(6)
    buffer_store_dwordx4 v[140:143], v157, s[20:23], s62 offen sc1
    s_add_u32 s62, s62, 6144
    s_waitcnt lgkmcnt(4)
    buffer_store_dwordx4 v[144:147], v157, s[20:23], s62 offen sc1
    s_add_u32 s62, s62, 6144
    s_waitcnt lgkmcnt(2)
    buffer_store_dwordx4 v[148:151], v157, s[20:23], s62 offen sc1
    s_add_u32 s62, s62, 6144
    s_waitcnt lgkmcnt(0)
    buffer_store_dwordx4 v[152:155], v157, s[20:23], s62 offen sc1
    ds_read_b64_tr_b16 v[32:33], v15 offset:18432
    ds_read_b64_tr_b16 v[34:35], v15 offset:19200
    ds_read_b64_tr_b16 v[36:37], v15 offset:21504
    ds_read_b64_tr_b16 v[38:39], v15 offset:22272
    ds_read_b64_tr_b16 v[184:185], v6 offset:18432
    ds_read_b64_tr_b16 v[186:187], v6 offset:19200
    ds_read_b64_tr_b16 v[40:41], v15 offset:19968
    ds_read_b64_tr_b16 v[42:43], v15 offset:20736
    ds_read_b64_tr_b16 v[44:45], v15 offset:23040
    ds_read_b64_tr_b16 v[46:47], v15 offset:23808
    ds_read_b64_tr_b16 v[188:189], v6 offset:19968
    ds_read_b64_tr_b16 v[190:191], v6 offset:20736
    s_add_u32 m0, s61, 12288
    s_nop 0
    buffer_load_dwordx4 v12, s[44:47], s58 offen offset:0  lds
    buffer_load_dwordx4 v13, s[44:47], s58 offen offset:1024  lds
    buffer_load_dwordx4 v14, s[44:47], s58 offen offset:2048  lds
    s_add_u32 m0, s61, 15360
    s_nop 0
    buffer_load_dwordx4 v12, s[48:51], s58 offen offset:0  lds
    buffer_load_dwordx4 v13, s[48:51], s58 offen offset:1024  lds
    buffer_load_dwordx4 v14, s[48:51], s58 offen offset:2048  lds
    s_add_u32 s58, s58, 49152
    s_waitcnt lgkmcnt(0)
    s_waitcnt vmcnt(20)
    s_barrier
    s_add_u32 m0, s56, 36864
    s_nop 0
    buffer_load_dwordx4 v5, s[20:23], s52 offen offset:0 lds
    buffer_load_dwordx4 v10, s[20:23], s53 offen offset:1024 lds
    buffer_load_dwordx4 v4, s[20:23], s54 offen offset:2048 lds
    s_lshr_b32 s15, s12, 3
    s_cmp_eq_u32 s15, 2
    s_cselect_b32 s15, -15, 1
    s_mul_i32 s15, s15, s55
    s_add_u32 s52, s52, s15
    s_add_u32 s53, s53, s15
    s_add_u32 s54, s54, s15
    ds_read_b64_tr_b16 v[48:49], v15 offset:0
    ds_read_b64_tr_b16 v[50:51], v15 offset:768
    ds_read_b64_tr_b16 v[52:53], v15 offset:3072
    ds_read_b64_tr_b16 v[54:55], v15 offset:3840
    ds_read_b64_tr_b16 v[192:193], v6 offset:0
    ds_read_b64_tr_b16 v[194:195], v6 offset:768
    ds_read_b64_tr_b16 v[56:57], v15 offset:1536
    ds_read_b64_tr_b16 v[58:59], v15 offset:2304
    ds_read_b64_tr_b16 v[60:61], v15 offset:4608
    ds_read_b64_tr_b16 v[62:63], v15 offset:5376
    ds_read_b64_tr_b16 v[196:197], v6 offset:1536
    ds_read_b64_tr_b16 v[198:199], v6 offset:2304
    s_add_u32 m0, s61, 18432
    s_nop 0
    buffer_load_dwordx4 v12, s[44:47], s58 offen offset:0  lds
    buffer_load_dwordx4 v13, s[44:47], s58 offen offset:1024  lds
    buffer_load_dwordx4 v14, s[44:47], s58 offen offset:2048  lds
    s_add_u32 m0, s61, 21504
    s_nop 0
    buffer_load_dwordx4 v12, s[48:51], s58 offen offset:0  lds
    buffer_load_dwordx4 v13, s[48:51], s58 offen offset:1024  lds
    buffer_load_dwordx4 v14, s[48:51], s58 offen offset:2048  lds
    s_add_u32 s58, s58, 49152
    s_waitcnt lgkmcnt(0)
    s_waitcnt vmcnt(23)
    s_waitcnt vmcnt(20)
    s_barrier
    s_add_u32 m0, s56, 0
    s_nop 0
    buffer_load_dwordx4 v5, s[20:23], s52 offen offset:0 lds
    buffer_load_dwordx4 v10, s[20:23], s53 offen offset:1024 lds
    buffer_load_dwordx4 v4, s[20:23], s54 offen offset:2048 lds
    s_add_u32 s52, s52, s55
    s_add_u32 s53, s53, s55
    s_add_u32 s54, s54, s55
    ds_read_b64_tr_b16 v[64:65], v15 offset:6144
    ds_read_b64_tr_b16 v[66:67], v15 offset:6912
    ds_read_b64_tr_b16 v[68:69], v15 offset:9216
    ds_read_b64_tr_b16 v[70:71], v15 offset:9984
    ds_read_b64_tr_b16 v[200:201], v6 offset:6144
    ds_read_b64_tr_b16 v[202:203], v6 offset:6912
    ds_read_b64_tr_b16 v[72:73], v15 offset:7680
    ds_read_b64_tr_b16 v[74:75], v15 offset:8448
    ds_read_b64_tr_b16 v[76:77], v15 offset:10752
    ds_read_b64_tr_b16 v[78:79], v15 offset:11520
    ds_read_b64_tr_b16 v[204:205], v6 offset:7680
    ds_read_b64_tr_b16 v[206:207], v6 offset:8448
    s_add_u32 m0, s61, 0
    s_nop 0
    buffer_load_dwordx4 v12, s[44:47], s58 offen offset:0  lds
    buffer_load_dwordx4 v13, s[44:47], s58 offen offset:1024  lds
    buffer_load_dwordx4 v14, s[44:47], s58 offen offset:2048  lds
    s_add_u32 m0, s61, 3072
    s_nop 0
    buffer_load_dwordx4 v12, s[48:51], s58 offen offset:0  lds
    buffer_load_dwordx4 v13, s[48:51], s58 offen offset:1024  lds
    buffer_load_dwordx4 v14, s[48:51], s58 offen offset:2048  lds
    s_add_u32 s58, s58, 49152
    s_waitcnt lgkmcnt(0)
    s_waitcnt vmcnt(18)
    s_waitcnt vmcnt(15)
    s_barrier
    s_add_u32 m0, s56, 12288
    s_nop 0
    buffer_load_dwordx4 v5, s[20:23], s52 offen offset:0 lds
    buffer_load_dwordx4 v10, s[20:23], s53 offen offset:1024 lds
    buffer_load_dwordx4 v4, s[20:23], s54 offen offset:2048 lds
    s_add_u32 s52, s52, s55
    s_add_u32 s53, s53, s55
    s_add_u32 s54, s54, s55
    s_mov_b64 exec, 1
    buffer_store_dword v159, v158, s[20:23], s60 offen sc1
    s_mov_b64 exec, -1
    ds_read_b64_tr_b16 v[80:81], v15 offset:12288
    ds_read_b64_tr_b16 v[82:83], v15 offset:13056
    ds_read_b64_tr_b16 v[84:85], v15 offset:15360
    ds_read_b64_tr_b16 v[86:87], v15 offset:16128
    ds_read_b64_tr_b16 v[208:209], v6 offset:12288
    ds_read_b64_tr_b16 v[210:211], v6 offset:13056
    ds_read_b64_tr_b16 v[88:89], v15 offset:13824
    ds_read_b64_tr_b16 v[90:91], v15 offset:14592
    ds_read_b64_tr_b16 v[92:93], v15 offset:16896
    ds_read_b64_tr_b16 v[94:95], v15 offset:17664
    ds_read_b64_tr_b16 v[212:213], v6 offset:13824
    ds_read_b64_tr_b16 v[214:215], v6 offset:14592
    s_add_u32 m0, s61, 6144
    s_nop 0
    buffer_load_dwordx4 v12, s[44:47], s58 offen offset:0  lds
    buffer_load_dwordx4 v13, s[44:47], s58 offen offset:1024  lds
    buffer_load_dwordx4 v14, s[44:47], s58 offen offset:2048  lds
    s_add_u32 m0, s61, 9216
    s_nop 0
    buffer_load_dwordx4 v12, s[48:51], s58 offen offset:0  lds
    buffer_load_dwordx4 v13, s[48:51], s58 offen offset:1024  lds
    buffer_load_dwordx4 v14, s[48:51], s58 offen offset:2048  lds
    s_add_u32 s58, s58, 49152
    s_waitcnt lgkmcnt(0)
    s_waitcnt vmcnt(19)
    s_waitcnt vmcnt(16)
    s_barrier
    s_add_u32 m0, s56, 24576
    s_nop 0
    buffer_load_dwordx4 v5, s[20:23], s52 offen offset:0 lds
    buffer_load_dwordx4 v10, s[20:23], s53 offen offset:1024 lds
    buffer_load_dwordx4 v4, s[20:23], s54 offen offset:2048 lds
    s_add_u32 s52, s52, s55
    s_add_u32 s53, s53, s55
    s_add_u32 s54, s54, s55
    ds_read_b64_tr_b16 v[96:97], v15 offset:18432
    ds_read_b64_tr_b16 v[98:99], v15 offset:19200
    ds_read_b64_tr_b16 v[100:101], v15 offset:21504
    ds_read_b64_tr_b16 v[102:103], v15 offset:22272
    ds_read_b64_tr_b16 v[216:217], v6 offset:18432
    ds_read_b64_tr_b16 v[218:219], v6 offset:19200
    ds_read_b64_tr_b16 v[104:105], v15 offset:19968
    ds_read_b64_tr_b16 v[106:107], v15 offset:20736
    ds_read_b64_tr_b16 v[108:109], v15 offset:23040
    ds_read_b64_tr_b16 v[110:111], v15 offset:23808
    ds_read_b64_tr_b16 v[220:221], v6 offset:19968
    ds_read_b64_tr_b16 v[222:223], v6 offset:20736
    s_add_u32 m0, s61, 12288
    s_nop 0
    buffer_load_dwordx4 v12, s[44:47], s58 offen offset:0  lds
    buffer_load_dwordx4 v13, s[44:47], s58 offen offset:1024  lds
    buffer_load_dwordx4 v14, s[44:47], s58 offen offset:2048  lds
    s_add_u32 m0, s61, 15360
    s_nop 0
    buffer_load_dwordx4 v12, s[48:51], s58 offen offset:0  lds
    buffer_load_dwordx4 v13, s[48:51], s58 offen offset:1024  lds
    buffer_load_dwordx4 v14, s[48:51], s58 offen offset:2048  lds
    s_add_u32 s58, s58, 49152
    s_waitcnt lgkmcnt(0)
    s_waitcnt vmcnt(19)
    s_waitcnt vmcnt(16)
    s_barrier
    s_add_u32 m0, s56, 36864
    s_nop 0
    buffer_load_dwordx4 v5, s[20:23], s52 offen offset:0 lds
    buffer_load_dwordx4 v10, s[20:23], s53 offen offset:1024 lds
    buffer_load_dwordx4 v4, s[20:23], s54 offen offset:2048 lds
    s_lshr_b32 s15, s12, 3
    s_cmp_eq_u32 s15, 1
    s_cselect_b32 s15, -15, 1
    s_mul_i32 s15, s15, s55
    s_add_u32 s52, s52, s15
    s_add_u32 s53, s53, s15
    s_add_u32 s54, s54, s15
    buffer_load_dword v11, v7, s[20:23], 0 offen sc1
    buffer_load_dword v3, v2, s[20:23], 0 offen sc1
    ds_read_b64_tr_b16 v[112:113], v15 offset:0
    ds_read_b64_tr_b16 v[114:115], v15 offset:768
    ds_read_b64_tr_b16 v[116:117], v15 offset:3072
    ds_read_b64_tr_b16 v[118:119], v15 offset:3840
    ds_read_b64_tr_b16 v[224:225], v6 offset:0
    ds_read_b64_tr_b16 v[226:227], v6 offset:768
    ds_read_b64_tr_b16 v[120:121], v15 offset:1536
    ds_read_b64_tr_b16 v[122:123], v15 offset:2304
    ds_read_b64_tr_b16 v[124:125], v15 offset:4608
    ds_read_b64_tr_b16 v[126:127], v15 offset:5376
    ds_read_b64_tr_b16 v[228:229], v6 offset:1536
    ds_read_b64_tr_b16 v[230:231], v6 offset:2304
    s_add_u32 m0, s61, 18432
    s_nop 0
    buffer_load_dwordx4 v12, s[44:47], s58 offen offset:0  lds
    buffer_load_dwordx4 v13, s[44:47], s58 offen offset:1024  lds
    buffer_load_dwordx4 v14, s[44:47], s58 offen offset:2048  lds
    s_add_u32 m0, s61, 21504
    s_nop 0
    buffer_load_dwordx4 v12, s[48:51], s58 offen offset:0  lds
    buffer_load_dwordx4 v13, s[48:51], s58 offen offset:1024  lds
    buffer_load_dwordx4 v14, s[48:51], s58 offen offset:2048  lds
    s_add_u32 s58, s58, 49152
    s_mov_b32 s44, s32
    s_mov_b32 s45, s33
    s_mov_b32 s46, 819200
    s_mov_b32 s47, 0x20000
    v_mov_b32 v12, v160
    v_mov_b32 v13, v161
    v_mov_b32 v14, v162
    v_mov_b32 v8, v163
    v_mov_b32 v9, v164
    s_waitcnt lgkmcnt(0)
    s_waitcnt vmcnt(20)
    s_waitcnt vmcnt(17)
    s_barrier
    s_add_u32 m0, s56, 0
    s_nop 0
    buffer_load_dwordx4 v5, s[20:23], s52 offen offset:0 lds
    buffer_load_dwordx4 v10, s[20:23], s53 offen offset:1024 lds
    buffer_load_dwordx4 v4, s[20:23], s54 offen offset:2048 lds
    s_add_u32 s52, s52, s55
    s_add_u32 s53, s53, s55
    s_add_u32 s54, s54, s55
    ds_read_b64_tr_b16 v[128:129], v15 offset:6144
    ds_read_b64_tr_b16 v[130:131], v15 offset:6912
    ds_read_b64_tr_b16 v[132:133], v15 offset:9216
    ds_read_b64_tr_b16 v[134:135], v15 offset:9984
    ds_read_b64_tr_b16 v[232:233], v6 offset:6144
    ds_read_b64_tr_b16 v[234:235], v6 offset:6912
    ds_read_b64_tr_b16 v[136:137], v15 offset:7680
    ds_read_b64_tr_b16 v[138:139], v15 offset:8448
    ds_read_b64_tr_b16 v[140:141], v15 offset:10752
    ds_read_b64_tr_b16 v[142:143], v15 offset:11520
    ds_read_b64_tr_b16 v[236:237], v6 offset:7680
    ds_read_b64_tr_b16 v[238:239], v6 offset:8448
    s_add_u32 m0, s61, 0
    s_nop 0
    buffer_load_dwordx4 v12, s[44:47], s59 offen offset:0  lds
    buffer_load_dwordx4 v13, s[44:47], s59 offen offset:1024  lds
    buffer_load_dwordx4 v14, s[44:47], s59 offen offset:2048  lds
    buffer_load_dwordx4 v8, s[44:47], s59 offen offset:3072  lds
    s_add_u32 m0, s61, 4096
    s_nop 0
    buffer_load_dwordx4 v9, s[44:47], s59 offen offset:0  lds
    s_add_u32 s59, s59, 40960
    s_add_u32 m0, s61, 5120
    s_nop 0
    buffer_load_dwordx4 v12, s[44:47], s59 offen offset:0  lds
    s_waitcnt lgkmcnt(0)
    s_waitcnt vmcnt(20)
    s_waitcnt vmcnt(17)
    s_barrier
    s_add_u32 m0, s56, 12288
    s_nop 0
    buffer_load_dwordx4 v5, s[20:23], s52 offen offset:0 lds
    buffer_load_dwordx4 v10, s[20:23], s53 offen offset:1024 lds
    buffer_load_dwordx4 v4, s[20:23], s54 offen offset:2048 lds
    s_add_u32 s52, s52, s55
    s_add_u32 s53, s53, s55
    s_add_u32 s54, s54, s55
    ds_read_b64_tr_b16 v[144:145], v15 offset:12288
    ds_read_b64_tr_b16 v[146:147], v15 offset:13056
    ds_read_b64_tr_b16 v[148:149], v15 offset:15360
    ds_read_b64_tr_b16 v[150:151], v15 offset:16128
    ds_read_b64_tr_b16 v[240:241], v6 offset:12288
    ds_read_b64_tr_b16 v[242:243], v6 offset:13056
    ds_read_b64_tr_b16 v[152:153], v15 offset:13824
    ds_read_b64_tr_b16 v[154:155], v15 offset:14592
    ds_read_b64_tr_b16 v[156:157], v15 offset:16896
    ds_read_b64_tr_b16 v[158:159], v15 offset:17664
    ds_read_b64_tr_b16 v[244:245], v6 offset:13824
    ds_read_b64_tr_b16 v[246:247], v6 offset:14592
    s_add_u32 m0, s61, 5120
    s_nop 0
    buffer_load_dwordx4 v13, s[44:47], s59 offen offset:1024  lds
    buffer_load_dwordx4 v14, s[44:47], s59 offen offset:2048  lds
    buffer_load_dwordx4 v8, s[44:47], s59 offen offset:3072  lds
    s_add_u32 m0, s61, 9216
    s_nop 0
    buffer_load_dwordx4 v9, s[44:47], s59 offen offset:0  lds
    s_add_u32 s59, s59, 40960
    s_add_u32 m0, s61, 10240
    s_nop 0
    buffer_load_dwordx4 v12, s[44:47], s59 offen offset:0  lds
    buffer_load_dwordx4 v13, s[44:47], s59 offen offset:1024  lds
    s_waitcnt lgkmcnt(0)
    s_waitcnt vmcnt(18)
    s_waitcnt vmcnt(15)
    s_barrier
    s_add_u32 m0, s56, 24576
    s_nop 0
    buffer_load_dwordx4 v5, s[20:23], s52 offen offset:0 lds
    buffer_load_dwordx4 v10, s[20:23], s53 offen offset:1024 lds
    buffer_load_dwordx4 v4, s[20:23], s54 offen offset:2048 lds
    s_add_u32 s52, s52, s55
    s_add_u32 s53, s53, s55
    s_add_u32 s54, s54, s55
    s_mov_b32 s27, 65536
    s_waitcnt vmcnt(63)
    s_branch kx_fused_kernel_pollc15
kx_fused_kernel_poll13:
    buffer_load_dword v11, v7, s[20:23], 0 offen sc1
    buffer_load_dword v3, v2, s[20:23], 0 offen sc1
    s_sub_u32 s27, s27, 1
    s_waitcnt vmcnt(0)
    s_cbranch_scc1 kx_fused_kernel_pollx14
kx_fused_kernel_pollc15:
    v_min_u32 v3, v3, v11
    v_cmp_eq_u32 vcc, 0, v3
    s_cbranch_vccnz kx_fused_kernel_poll13
kx_fused_kernel_pollx14:
    v_cmp_ne_u32 vcc, s31, v11
    s_nop 0
    s_cmp_eq_u32 vcc_hi, 0
    s_cselect_b32 s26, 1, 0
    ds_read_b64_tr_b16 v[160:161], v15 offset:18432
    ds_read_b64_tr_b16 v[162:163], v15 offset:19200
    ds_read_b64_tr_b16 v[164:165], v15 offset:21504
    ds_read_b64_tr_b16 v[166:167], v15 offset:22272
    ds_read_b64_tr_b16 v[248:249], v6 offset:18432
    ds_read_b64_tr_b16 v[250:251], v6 offset:19200
    ds_read_b64_tr_b16 v[168:169], v15 offset:19968
    ds_read_b64_tr_b16 v[170:171], v15 offset:20736
    ds_read_b64_tr_b16 v[172:173], v15 offset:23040
    ds_read_b64_tr_b16 v[174:175], v15 offset:23808
    ds_read_b64_tr_b16 v[252:253], v6 offset:19968
    ds_read_b64_tr_b16 v[254:255], v6 offset:20736
    s_add_u32 m0, s61, 10240
    s_nop 0
    buffer_load_dwordx4 v14, s[44:47], s59 offen offset:2048  lds
    buffer_load_dwordx4 v8, s[44:47], s59 offen offset:3072  lds
    s_add_u32 m0, s61, 14336
    s_nop 0
    buffer_load_dwordx4 v9, s[44:47], s59 offen offset:0  lds
    s_add_u32 s59, s59, 40960
    s_add_u32 m0, s61, 15360
    s_nop 0
    buffer_load_dwordx4 v12, s[44:47], s59 offen offset:0  lds
    buffer_load_dwordx4 v13, s[44:47], s59 offen offset:1024  lds
    buffer_load_dwordx4 v14, s[44:47], s59 offen offset:2048  lds
    s_waitcnt lgkmcnt(0)
    s_waitcnt vmcnt(15)
    s_barrier
    s_add_u32 m0, s56, 36864
    s_nop 0
    buffer_load_dwordx4 v5, s[20:23], s52 offen offset:0 lds
    buffer_load_dwordx4 v10, s[20:23], s53 offen offset:1024 lds
    buffer_load_dwordx4 v4, s[20:23], s54 offen offset:2048 lds
    s_add_u32 s52, s52, s55
    s_add_u32 s53, s53, s55
    s_add_u32 s54, s54, s55
    s_add_u32 m0, s61, 15360
    s_nop 0
    buffer_load_dwordx4 v8, s[44:47], s59 offen offset:3072  lds
    s_add_u32 m0, s61, 19456
    s_nop 0
    buffer_load_dwordx4 v9, s[44:47], s59 offen offset:0  lds
    s_add_u32 s59, s59, 40960
    s_add_u32 m0, s61, 20480
    s_nop 0
    buffer_load_dwordx4 v12, s[44:47], s59 offen offset:0  lds
    buffer_load_dwordx4 v13, s[44:47], s59 offen offset:1024  lds
    buffer_load_dwordx4 v14, s[44:47], s59 offen offset:2048  lds
    buffer_load_dwordx4 v8, s[44:47], s59 offen offset:3072  lds
    s_add_u32 m0, s61, 24576
    s_nop 0
    buffer_load_dwordx4 v9, s[44:47], s59 offen offset:0  lds
    s_add_u32 s59, s59, 40960
    v_lshlrev_b32 v6, 7, v1
    s_lshl3_add_u32 s16, s28, s13
    s_lshl2_add_u32 s16, s16, s14
    s_mul_i32 s15, s16, 2560
    s_add_u32 s15, s15, 11534336
    s_mov_b64 exec, 0xfffff
    buffer_load_dword v0, v6, s[20:23], s15 offen sc1
    s_lshl_b32 s15, s16, 8
    s_add_u32 s15, s15, 40894464
    s_mov_b64 exec, 3
    buffer_load_dword v0, v6, s[20:23], s15 offen sc1
    s_lshl_b32 s15, s29, 13
    s_lshl2_add_u32 s57, s30, s14
    s_lshl_b32 s57, s57, 8
    s_add_u32 s15, s15, s57
    s_add_u32 s15, s15, 41943040
    buffer_load_dword v0, v6, s[20:23], s15 offen sc1
    s_lshl_b32 s15, s16, 7
    s_add_u32 s15, s15, 42205184
    s_mov_b64 exec, 1
    buffer_load_dword v0, v6, s[20:23], s15 offen sc1
    s_mov_b64 exec, -1
    v_lshlrev_b32 v6, 7, v1
    s_lshl2_add_u32 s15, s29, s14
    s_mul_i32 s15, s15, 49152
    s_mul_i32 s16, s30, 3072
    s_add_u32 s15, s15, s16
    s_add_u32 s15, s15, 14876672
    s_mov_b64 exec, 0xffffff
    buffer_load_dword v0, v6, s[20:23], s15 offen sc1
    s_mov_b64 exec, -1
    s_waitcnt vmcnt(21)
    s_barrier
    s_lshl2_add_u32 s16, s13, s14
    s_lshl_b32 s16, s16, 5
    s_add_u32 s16, s16, s12
    s_mul_i32 s15, s16, 2560
    s_add_u32 s15, s15, 8388608
    s_mov_b64 exec, 1
    buffer_load_dword v0, off, s[20:23], s15 sc1
    s_lshl_b32 s15, s16, 7
    s_add_u32 s15, s15, 42336256
    buffer_load_dword v0, off, s[20:23], s15 sc1
    s_lshl2_add_u32 s16, s28, s14
    s_mul_i32 s15, s16, 20480
    s_add_u32 s15, s15, 8388608
    buffer_load_dword v0, off, s[20:23], s15 sc1
    s_mov_b64 exec, -1
    s_waitcnt vmcnt(15)
    s_barrier
    s_waitcnt vmcnt(8)
    v_lshlrev_b32 v5, 4, v1
    s_barrier
    s_mov_b32 s44, s8
    s_mov_b32 s45, s9
    s_mov_b32 s46, 2621440
    s_mov_b32 s47, 0x20000
    s_mul_i32 s15, s14, 20480
    v_add_u32 v6, s15, v5
    s_and_b32 s15, s14, 1
    v_and_b32 v2, 7, v1
    v_lshl_add_u32 v2, s15, 3, v2
    s_lshr_b32 s15, s14, 1
    s_mul_i32 s15, s15, 5
    v_lshrrev_b32 v3, 3, v1
    v_add_u32 v3, s15, v3
    v_mul_u32_u24 v7, 1280, v2
    v_lshl_add_u32 v7, v3, 4, v7
    v_mul_u32_u24 v12, 336, v2
    v_lshl_add_u32 v12, v3, 5, v12
    v_add_u32 v12, 81920, v12
    v_lshlrev_b32 v13, 4, v2
    v_lshl_add_u32 v13, v3, 10, v13
    v_lshrrev_b32 v14, 4, v1
    v_and_b32 v2, 7, v1
    v_lshl_add_u32 v14, v14, 3, v2
    v_lshlrev_b32 v14, 3, v14
    s_mul_i32 s58, s28, 81920
    s_mul_i32 s15, s13, 160
    s_add_u32 s58, s58, s15
    s_lshl3_add_u32 s15, s28, s13
    s_mul_i32 s59, s15, 10240
    s_add_u32 s59, s59, 11534336
    s_lshl2_add_u32 s15, s15, s14
    s_lshl_b32 s57, s15, 8
    s_add_u32 s57, s57, 40894464
    s_lshl_b32 s60, s15, 7
    s_add_u32 s60, s60, 42205184
    s_barrier
    ds_write_b128 v6, v[176:179] offset:0
    ds_write_b128 v6, v[180:183] offset:1024
    ds_write_b128 v6, v[184:187] offset:2048
    ds_write_b128 v6, v[188:191] offset:3072
    ds_write_b128 v6, v[192:195] offset:4096
    ds_write_b128 v6, v[196:199] offset:5120
    ds_write_b128 v6, v[200:203] offset:6144
    ds_write_b128 v6, v[204:207] offset:7168
    ds_write_b128 v6, v[208:211] offset:8192
    ds_write_b128 v6, v[212:215] offset:9216
    ds_write_b128 v6, v[216:219] offset:10240
    ds_write_b128 v6, v[220:223] offset:11264
    ds_write_b128 v6, v[224:227] offset:12288
    ds_write_b128 v6, v[228:231] offset:13312
    ds_write_b128 v6, v[232:235] offset:14336
    ds_write_b128 v6, v[236:239] offset:15360
    ds_write_b128 v6, v[240:243] offset:16384
    ds_write_b128 v6, v[244:247] offset:17408
    ds_write_b128 v6, v[248:251] offset:18432
    ds_write_b128 v6, v[252:255] offset:19456
    s_mov_b32 exec_hi, 0xff
    s_waitcnt lgkmcnt(0)
    buffer_load_dwordx4 v[208:211], v7, s[44:47], s58 offen
    s_add_u32 s58, s58, 20480
    buffer_load_dwordx4 v[212:215], v7, s[44:47], s58 offen
    s_add_u32 s58, s58, 20480
    buffer_load_dwordx4 v[216:219], v7, s[44:47], s58 offen
    s_add_u32 s58, s58, 20480
    buffer_load_dwordx4 v[220:223], v7, s[44:47], s58 offen
    s_add_u32 s58, s58, 20480
    s_mov_b32 exec_hi, -1
    v_mov_b32 v8, 0x3f803f80
    v_mov_b32 v9, 0x3f803f80
    v_mov_b32 v10, 0x3f803f80
    v_mov_b32 v11, 0x3f803f80
    v_mov_b32 v248, 0
    v_mov_b32 v249, 0
    v_mov_b32 v250, 0
    v_mov_b32 v251, 0
    v_mov_b32 v252, 0
    v_mov_b32 v253, 0
    v_mov_b32 v254, 0
    v_mov_b32 v255, 0
    v_mfma_f32_16x16x32_bf16 v[240:243], v[16:19], v[8:11], 0
    v_mfma_f32_16x16x32_bf16 v[244:247], v[20:23], v[8:11], 0
    v_mfma_f32_16x16x32_bf16 v[240:243], v[24:27], v[8:11], v[240:243]
    v_mfma_f32_16x16x32_bf16 v[244:247], v[28:31], v[8:11], v[244:247]
    v_mfma_f32_16x16x32_bf16 v[240:243], v[32:35], v[8:11], v[240:243]
    v_mfma_f32_16x16x32_bf16 v[244:247], v[36:39], v[8:11], v[244:247]
    v_mfma_f32_16x16x32_bf16 v[240:243], v[40:43], v[8:11], v[240:243]
    v_mfma_f32_16x16x32_bf16 v[244:247], v[44:47], v[8:11], v[244:247]
    v_mfma_f32_16x16x32_bf16 v[240:243], v[48:51], v[8:11], v[240:243]
    v_mfma_f32_16x16x32_bf16 v[244:247], v[52:55], v[8:11], v[244:247]
    v_mfma_f32_16x16x32_bf16 v[240:243], v[56:59], v[8:11], v[240:243]
    v_mfma_f32_16x16x32_bf16 v[244:247], v[60:63], v[8:11], v[244:247]
    v_mfma_f32_16x16x32_bf16 v[240:243], v[64:67], v[8:11], v[240:243]
    v_mfma_f32_16x16x32_bf16 v[244:247], v[68:71], v[8:11], v[244:247]
    v_mfma_f32_16x16x32_bf16 v[240:243], v[72:75], v[8:11], v[240:243]
    v_mfma_f32_16x16x32_bf16 v[244:247], v[76:79], v[8:11], v[244:247]
    v_mfma_f32_16x16x32_bf16 v[240:243], v[80:83], v[8:11], v[240:243]
    v_mfma_f32_16x16x32_bf16 v[244:247], v[84:87], v[8:11], v[244:247]
    v_mfma_f32_16x16x32_bf16 v[240:243], v[88:91], v[8:11], v[240:243]
    v_mfma_f32_16x16x32_bf16 v[244:247], v[92:95], v[8:11], v[244:247]
    v_mfma_f32_16x16x32_bf16 v[240:243], v[96:99], v[8:11], v[240:243]
    v_mfma_f32_16x16x32_bf16 v[244:247], v[100:103], v[8:11], v[244:247]
    v_mfma_f32_16x16x32_bf16 v[240:243], v[104:107], v[8:11], v[240:243]
    v_mfma_f32_16x16x32_bf16 v[244:247], v[108:111], v[8:11], v[244:247]
    v_mfma_f32_16x16x32_bf16 v[240:243], v[112:115], v[8:11], v[240:243]
    v_mfma_f32_16x16x32_bf16 v[244:247], v[116:119], v[8:11], v[244:247]
    v_mfma_f32_16x16x32_bf16 v[240:243], v[120:123], v[8:11], v[240:243]
    v_mfma_f32_16x16x32_bf16 v[244:247], v[124:127], v[8:11], v[244:247]
    v_mfma_f32_16x16x32_bf16 v[240:243], v[128:131], v[8:11], v[240:243]
    v_mfma_f32_16x16x32_bf16 v[244:247], v[132:135], v[8:11], v[244:247]
    v_mfma_f32_16x16x32_bf16 v[240:243], v[136:139], v[8:11], v[240:243]
    v_mfma_f32_16x16x32_bf16 v[244:247], v[140:143], v[8:11], v[244:247]
    v_mfma_f32_16x16x32_bf16 v[240:243], v[144:147], v[8:11], v[240:243]
    v_mfma_f32_16x16x32_bf16 v[244:247], v[148:151], v[8:11], v[244:247]
    v_mfma_f32_16x16x32_bf16 v[240:243], v[152:155], v[8:11], v[240:243]
    v_mfma_f32_16x16x32_bf16 v[244:247], v[156:159], v[8:11], v[244:247]
    v_mfma_f32_16x16x32_bf16 v[240:243], v[160:163], v[8:11], v[240:243]
    v_mfma_f32_16x16x32_bf16 v[244:247], v[164:167], v[8:11], v[244:247]
    v_mfma_f32_16x16x32_bf16 v[240:243], v[168:171], v[8:11], v[240:243]
    v_mfma_f32_16x16x32_bf16 v[244:247], v[172:175], v[8:11], v[244:247]
    s_mov_b32 s64, s42
    s_mov_b32 s65, s43
    s_mov_b32 s66, 2621440
    s_mov_b32 s67, 0x20000
    s_and_b32 s16, s30, 1
    s_lshl1_add_u32 s15, s29, s16
    s_mul_i32 s68, s15, 98304
    s_mul_i32 s70, s15, 40960
    s_mul_i32 s15, s14, 6144
    s_add_u32 s68, s68, s15
    s_add_u32 s68, s68, 14680064
    s_mul_i32 s15, s14, 2560
    s_add_u32 s70, s70, s15
    s_mul_i32 s15, s13, 160
    s_add_u32 s70, s70, s15
    s_lshl3_add_u32 s69, s29, s13
    s_mul_i32 s69, s69, 10240
    s_lshl4_add_u32 s15, s16, s14
    s_lshl_b32 s15, s15, 5
    s_add_u32 s69, s69, s15
    s_add_u32 s69, s69, 11534336
    s_lshl_b32 s16, s29, 13
    s_add_u32 s16, s16, 41943040
    s_lshl3_add_u32 s15, s30, s14
    s_lshl_b32 s15, s15, 7
    s_add_u32 s71, s15, s16
    s_lshl_b32 s15, s14, 11
    s_add_u32 s15, s15, s16
    v_and_b32 v2, 15, v1
    v_lshl_add_u32 v6, v2, 7, s15
    s_mul_i32 s15, s14, 5376
    v_mul_u32_u24 v2, 336, v2
    v_and_b32 v3, 48, v1
    v_add3_u32 v7, v2, v3, s15
    v_min_u32 v2, 39, v1
    v_cmp_le_u32 vcc, 20, v2
    s_nop 1
    v_cndmask_b32_e64 v3, 0, 1, vcc
    v_mul_u32_u24 v4, 20, v3
    v_sub_u32 v2, v2, v4
    s_mul_i32 s15, s14, 672
    v_mul_u32_u24 v4, 336, v3
    v_lshl_add_u32 v4, v2, 4, v4
    v_add_u32 v8, s15, v4
    v_mul_u32_u24 v4, 1280, v3
    v_lshl_add_u32 v10, v2, 3, v4
    v_cmp_le_u32 vcc, 40, v1
    s_nop 1
    v_cndmask_b32_e64 v4, 0, 1, vcc
    v_lshl_add_u32 v10, v4, 30, v10
    v_lshrrev_b32 v4, 1, v2
    v_lshlrev_b32 v4, 10, v4
    v_lshl_add_u32 v4, v3, 4, v4
    v_and_b32 v2, 1, v2
    v_lshl_add_u32 v9, v2, 3, v4
    v_mov_b32 v11, 1
    v_lshrrev_b32 v2, 4, v1
    v_mul_u32_u24 v2, 20480, v2
    v_and_b32 v3, 0xf0, v5
    v_add_u32 v15, v2, v3
    s_mov_b32 exec_hi, 0xff
    s_waitcnt vmcnt(3)
    v_lshlrev_b32 v176, 16, v208
    v_and_b32 v177, 0xffff0000, v208
    v_lshlrev_b32 v178, 16, v209
    v_and_b32 v179, 0xffff0000, v209
    v_lshlrev_b32 v180, 16, v210
    v_and_b32 v181, 0xffff0000, v210
    v_lshlrev_b32 v182, 16, v211
    v_and_b32 v183, 0xffff0000, v211
    s_waitcnt vmcnt(2)
    v_lshlrev_b32 v184, 16, v212
    v_and_b32 v185, 0xffff0000, v212
    v_lshlrev_b32 v186, 16, v213
    v_and_b32 v187, 0xffff0000, v213
    v_lshlrev_b32 v188, 16, v214
    v_and_b32 v189, 0xffff0000, v214
    v_lshlrev_b32 v190, 16, v215
    v_and_b32 v191, 0xffff0000, v215
    s_waitcnt vmcnt(1)
    v_lshlrev_b32 v192, 16, v216
    v_and_b32 v193, 0xffff0000, v216
    v_lshlrev_b32 v194, 16, v217
    v_and_b32 v195, 0xffff0000, v217
    v_lshlrev_b32 v196, 16, v218
    v_and_b32 v197, 0xffff0000, v218
    v_lshlrev_b32 v198, 16, v219
    v_and_b32 v199, 0xffff0000, v219
    s_waitcnt vmcnt(0)
    v_lshlrev_b32 v200, 16, v220
    v_and_b32 v201, 0xffff0000, v220
    v_lshlrev_b32 v202, 16, v221
    v_and_b32 v203, 0xffff0000, v221
    v_lshlrev_b32 v204, 16, v222
    v_and_b32 v205, 0xffff0000, v222
    v_lshlrev_b32 v206, 16, v223
    v_and_b32 v207, 0xffff0000, v223
    s_barrier
    ds_read_b128 v[208:211], v12 offset:0
    ds_read_b128 v[212:215], v12 offset:5376
    ds_read_b128 v[216:219], v12 offset:10752
    ds_read_b128 v[220:223], v12 offset:16128
    ds_read_b128 v[224:227], v12 offset:16
    ds_read_b128 v[228:231], v12 offset:5392
    ds_read_b128 v[232:235], v12 offset:10768
    ds_read_b128 v[236:239], v12 offset:16144
    s_waitcnt lgkmcnt(7)
    v_add_f32 v176, v176, v208
    v_add_f32 v177, v177, v209
    v_add_f32 v178, v178, v210
    v_add_f32 v179, v179, v211
    s_waitcnt lgkmcnt(5)
    v_add_f32 v212, v212, v216
    v_add_f32 v213, v213, v217
    v_add_f32 v214, v214, v218
    v_add_f32 v215, v215, v219
    s_waitcnt lgkmcnt(4)
    v_add_f32 v176, v176, v220
    v_add_f32 v177, v177, v221
    v_add_f32 v178, v178, v222
    v_add_f32 v179, v179, v223
    v_add_f32 v176, v176, v212
    v_add_f32 v177, v177, v213
    v_add_f32 v178, v178, v214
    v_add_f32 v179, v179, v215
    v_cvt_pk_bf16_f32 v208, v176, v177
    v_cvt_pk_bf16_f32 v209, v178, v179
    s_waitcnt lgkmcnt(3)
    v_add_f32 v180, v180, v224
    v_add_f32 v181, v181, v225
    v_add_f32 v182, v182, v226
    v_add_f32 v183, v183, v227
    s_waitcnt lgkmcnt(1)
    v_add_f32 v228, v228, v232
    v_add_f32 v229, v229, v233
    v_add_f32 v230, v230, v234
    v_add_f32 v231, v231, v235
    s_waitcnt lgkmcnt(0)
    v_add_f32 v180, v180, v236
    v_add_f32 v181, v181, v237
    v_add_f32 v182, v182, v238
    v_add_f32 v183, v183, v239
    v_add_f32 v180, v180, v228
    v_add_f32 v181, v181, v229
    v_add_f32 v182, v182, v230
    v_add_f32 v183, v183, v231
    v_cvt_pk_bf16_f32 v210, v180, v181
    v_cvt_pk_bf16_f32 v211, v182, v183
    s_cmp_eq_u32 s26, 0
    s_cbranch_scc1 kx_fused_kernel_slow16
    buffer_store_dwordx4 v[208:211], v13, s[20:23], s59 offen offset:0
kx_fused_kernel_back17:
    s_barrier
    s_nop 0
    ds_read_b128 v[208:211], v12 offset:21504
    ds_read_b128 v[212:215], v12 offset:26880
    ds_read_b128 v[216:219], v12 offset:32256
    ds_read_b128 v[220:223], v12 offset:37632
    ds_read_b128 v[224:227], v12 offset:21520
    ds_read_b128 v[228:231], v12 offset:26896
    ds_read_b128 v[232:235], v12 offset:32272
    ds_read_b128 v[236:239], v12 offset:37648
    v_add_f32 v248, v176, v177
    v_mul_f32 v249, v176, v176
    v_add_f32 v2, v178, v179
    v_mul_f32 v3, v177, v177
    v_fmac_f32 v249, v178, v178
    v_fmac_f32 v3, v179, v179
    v_add_f32 v248, v248, v180
    v_add_f32 v2, v2, v181
    v_fmac_f32 v249, v180, v180
    v_fmac_f32 v3, v181, v181
    v_add_f32 v248, v248, v182
    v_add_f32 v2, v2, v183
    v_fmac_f32 v249, v182, v182
    v_fmac_f32 v3, v183, v183
    v_add_f32 v248, v248, v2
    v_add_f32 v249, v249, v3
    s_waitcnt lgkmcnt(7)
    v_add_f32 v184, v184, v208
    v_add_f32 v185, v185, v209
    v_add_f32 v186, v186, v210
    v_add_f32 v187, v187, v211
    s_waitcnt lgkmcnt(5)
    v_add_f32 v212, v212, v216
    v_add_f32 v213, v213, v217
    v_add_f32 v214, v214, v218
    v_add_f32 v215, v215, v219
    s_waitcnt lgkmcnt(4)
    v_add_f32 v184, v184, v220
    v_add_f32 v185, v185, v221
    v_add_f32 v186, v186, v222
    v_add_f32 v187, v187, v223
    v_add_f32 v184, v184, v212
    v_add_f32 v185, v185, v213
    v_add_f32 v186, v186, v214
    v_add_f32 v187, v187, v215
    v_cvt_pk_bf16_f32 v208, v184, v185
    v_cvt_pk_bf16_f32 v209, v186, v187
    s_waitcnt lgkmcnt(3)
    v_add_f32 v188, v188, v224
    v_add_f32 v189, v189, v225
    v_add_f32 v190, v190, v226
    v_add_f32 v191, v191, v227
    s_waitcnt lgkmcnt(1)
    v_add_f32 v228, v228, v232
    v_add_f32 v229, v229, v233
    v_add_f32 v230, v230, v234
    v_add_f32 v231, v231, v235
    s_waitcnt lgkmcnt(0)
    v_add_f32 v188, v188, v236
    v_add_f32 v189, v189, v237
    v_add_f32 v190, v190, v238
    v_add_f32 v191, v191, v239
    v_add_f32 v188, v188, v228
    v_add_f32 v189, v189, v229
    v_add_f32 v190, v190, v230
    v_add_f32 v191, v191, v231
    v_cvt_pk_bf16_f32 v210, v188, v189
    v_cvt_pk_bf16_f32 v211, v190, v191
    s_cmp_eq_u32 s26, 0
    s_cbranch_scc1 kx_fused_kernel_slow18
    buffer_store_dwordx4 v[208:211], v13, s[20:23], s59 offen offset:256
kx_fused_kernel_back19:
    s_barrier
    s_nop 0
    ds_read_b128 v[208:211], v12 offset:43008
    ds_read_b128 v[212:215], v12 offset:48384
    ds_read_b128 v[216:219], v12 offset:53760
    ds_read_b128 v[220:223], v12 offset:59136
    ds_read_b128 v[224:227], v12 offset:43024
    ds_read_b128 v[228:231], v12 offset:48400
    ds_read_b128 v[232:235], v12 offset:53776
    ds_read_b128 v[236:239], v12 offset:59152
    v_add_f32 v250, v184, v185
    v_mul_f32 v251, v184, v184
    v_add_f32 v2, v186, v187
    v_mul_f32 v3, v185, v185
    v_fmac_f32 v251, v186, v186
    v_fmac_f32 v3, v187, v187
    v_add_f32 v250, v250, v188
    v_add_f32 v2, v2, v189
    v_fmac_f32 v251, v188, v188
    v_fmac_f32 v3, v189, v189
    v_add_f32 v250, v250, v190
    v_add_f32 v2, v2, v191
    v_fmac_f32 v251, v190, v190
    v_fmac_f32 v3, v191, v191
    v_add_f32 v250, v250, v2
    v_add_f32 v251, v251, v3
    s_waitcnt lgkmcnt(7)
    v_add_f32 v192, v192, v208
    v_add_f32 v193, v193, v209
    v_add_f32 v194, v194, v210
    v_add_f32 v195, v195, v211
    s_waitcnt lgkmcnt(5)
    v_add_f32 v212, v212, v216
    v_add_f32 v213, v213, v217
    v_add_f32 v214, v214, v218
    v_add_f32 v215, v215, v219
    s_waitcnt lgkmcnt(4)
    v_add_f32 v192, v192, v220
    v_add_f32 v193, v193, v221
    v_add_f32 v194, v194, v222
    v_add_f32 v195, v195, v223
    v_add_f32 v192, v192, v212
    v_add_f32 v193, v193, v213
    v_add_f32 v194, v194, v214
    v_add_f32 v195, v195, v215
    v_cvt_pk_bf16_f32 v208, v192, v193
    v_cvt_pk_bf16_f32 v209, v194, v195
    s_waitcnt lgkmcnt(3)
    v_add_f32 v196, v196, v224
    v_add_f32 v197, v197, v225
    v_add_f32 v198, v198, v226
    v_add_f32 v199, v199, v227
    s_waitcnt lgkmcnt(1)
    v_add_f32 v228, v228, v232
    v_add_f32 v229, v229, v233
    v_add_f32 v230, v230, v234
    v_add_f32 v231, v231, v235
    s_waitcnt lgkmcnt(0)
    v_add_f32 v196, v196, v236
    v_add_f32 v197, v197, v237
    v_add_f32 v198, v198, v238
    v_add_f32 v199, v199, v239
    v_add_f32 v196, v196, v228
    v_add_f32 v197, v197, v229
    v_add_f32 v198, v198, v230
    v_add_f32 v199, v199, v231
    v_cvt_pk_bf16_f32 v210, v196, v197
    v_cvt_pk_bf16_f32 v211, v198, v199
    s_cmp_eq_u32 s26, 0
    s_cbranch_scc1 kx_fused_kernel_slow20
    buffer_store_dwordx4 v[208:211], v13, s[20:23], s59 offen offset:512
kx_fused_kernel_back21:
    s_barrier
    s_nop 0
    ds_read_b128 v[208:211], v12 offset:0
    ds_read_b128 v[212:215], v12 offset:5376
    ds_read_b128 v[216:219], v12 offset:10752
    ds_read_b128 v[220:223], v12 offset:16128
    ds_read_b128 v[224:227], v12 offset:16
    ds_read_b128 v[228:231], v12 offset:5392
    ds_read_b128 v[232:235], v12 offset:10768
    ds_read_b128 v[236:239], v12 offset:16144
    v_add_f32 v252, v192, v193
    v_mul_f32 v253, v192, v192
    v_add_f32 v2, v194, v195
    v_mul_f32 v3, v193, v193
    v_fmac_f32 v253, v194, v194
    v_fmac_f32 v3, v195, v195
    v_add_f32 v252, v252, v196
    v_add_f32 v2, v2, v197
    v_fmac_f32 v253, v196, v196
    v_fmac_f32 v3, v197, v197
    v_add_f32 v252, v252, v198
    v_add_f32 v2, v2, v199
    v_fmac_f32 v253, v198, v198
    v_fmac_f32 v3, v199, v199
    v_add_f32 v252, v252, v2
    v_add_f32 v253, v253, v3
    s_mov_b32 exec_hi, -1
    v_permlane32_swap_b32 v248, v252
    v_permlane32_swap_b32 v249, v253
    v_add_f32 v248, v248, v252
    v_add_f32 v249, v249, v253
    s_mov_b32 exec_hi, 0xff
    s_waitcnt lgkmcnt(7)
    v_pk_add_f32 v[200:201], v[200:201], v[208:209]
    v_pk_add_f32 v[202:203], v[202:203], v[210:211]
    s_waitcnt lgkmcnt(5)
    v_pk_add_f32 v[212:213], v[212:213], v[216:217]
    v_pk_add_f32 v[214:215], v[214:215], v[218:219]
    s_waitcnt lgkmcnt(4)
    v_pk_add_f32 v[200:201], v[200:201], v[220:221]
    v_pk_add_f32 v[202:203], v[202:203], v[222:223]
    v_pk_add_f32 v[200:201], v[200:201], v[212:213]
    v_pk_add_f32 v[202:203], v[202:203], v[214:215]
    v_cvt_pk_bf16_f32 v208, v200, v201
    v_cvt_pk_bf16_f32 v209, v202, v203
    s_waitcnt lgkmcnt(3)
    v_pk_add_f32 v[204:205], v[204:205], v[224:225]
    v_pk_add_f32 v[206:207], v[206:207], v[226:227]
    s_waitcnt lgkmcnt(1)
    v_pk_add_f32 v[228:229], v[228:229], v[232:233]
    v_pk_add_f32 v[230:231], v[230:231], v[234:235]
    s_waitcnt lgkmcnt(0)
    v_pk_add_f32 v[204:205], v[204:205], v[236:237]
    v_pk_add_f32 v[206:207], v[206:207], v[238:239]
    v_pk_add_f32 v[204:205], v[204:205], v[228:229]
    v_pk_add_f32 v[206:207], v[206:207], v[230:231]
    v_cvt_pk_bf16_f32 v210, v204, v205
    v_cvt_pk_bf16_f32 v211, v206, v207
    s_cmp_eq_u32 s26, 0
    s_cbranch_scc1 kx_fused_kernel_slow22
    buffer_store_dwordx4 v[208:211], v13, s[20:23], s59 offen offset:768
kx_fused_kernel_back23:
    v_add_f32 v254, v200, v201
    v_mul_f32 v255, v200, v200
    v_add_f32 v2, v202, v203
    v_mul_f32 v3, v201, v201
    v_fmac_f32 v255, v202, v202
    v_fmac_f32 v3, v203, v203
    v_add_f32 v254, v254, v204
    v_add_f32 v2, v2, v205
    v_fmac_f32 v255, v204, v204
    v_fmac_f32 v3, v205, v205
    v_add_f32 v254, v254, v206
    v_add_f32 v2, v2, v207
    v_fmac_f32 v255, v206, v206
    v_fmac_f32 v3, v207, v207
    v_add_f32 v254, v254, v2
    v_add_f32 v255, v255, v3
    s_mov_b32 exec_hi, -1
    v_permlane32_swap_b32 v250, v254
    v_permlane32_swap_b32 v251, v255
    v_add_f32 v250, v250, v254
    v_add_f32 v251, v251, v255
    s_nop 0
    v_permlane16_swap_b32 v248, v250
    v_permlane16_swap_b32 v249, v251
    v_add_f32 v248, v248, v250
    v_add_f32 v249, v249, v251
    s_nop 0
    v_add_f32_dpp v248, v248, v248 row_ror:8 row_mask:0xf bank_mask:0xf
    v_add_f32_dpp v249, v249, v249 row_ror:8 row_mask:0xf bank_mask:0xf
    s_cmp_eq_u32 s26, 0
    s_cbranch_scc1 kx_fused_kernel_slow24
    buffer_store_dwordx2 v[248:249], v14, s[20:23], s57 offen
kx_fused_kernel_back25:
    s_barrier
    v_add_u32 v14, 81920, v15
    v_lshrrev_b32 v2, 5, v1
    v_mul_u32_u24 v2, 49152, v2
    v_and_b32 v3, 0x1f0, v5
    v_add_u32 v13, v2, v3
    v_and_b32 v12, 0xf0, v5
    v_add_u32 v12, 81920, v12
    v_lshlrev_b32 v2, 7, v1
    s_lshl2_add_u32 s15, s30, s14
    s_mul_i32 s58, s15, 768
    s_mul_i32 s15, s29, 196608
    s_add_u32 s58, s58, s15
    s_add_u32 s58, s58, 14680064
    s_lshl3_add_u32 s59, s13, s14
    s_mul_i32 s59, s59, 30720
    s_add_u32 s59, s59, 20971520
    s_waitcnt vmcnt(0)
    s_cmp_eq_u32 s26, 0
    s_cbranch_scc1 kx_fused_kernel_slow26
    s_mov_b64 exec, 1
    buffer_store_dword v11, off, s[20:23], s60
    s_mov_b64 exec, -1
kx_fused_kernel_back27:
    s_setprio 1
    s_barrier
    ds_read_b128 v[208:211], v14 offset:0
    ds_read_b128 v[212:215], v14 offset:256
    ds_read_b128 v[216:219], v14 offset:512
    ds_read_b128 v[220:223], v14 offset:768
    ds_read_b128 v[224:227], v14 offset:1024
    ds_read_b128 v[228:231], v14 offset:1280
    ds_read_b128 v[232:235], v14 offset:1536
    ds_read_b128 v[236:239], v14 offset:1792
    s_waitcnt lgkmcnt(7)
    v_mfma_f32_16x16x32_bf16 v[176:179], v[16:19], v[208:211], 0
    v_mfma_f32_16x16x32_bf16 v[192:195], v[20:23], v[208:211], 0
    ds_read_b128 v[208:211], v14 offset:2048
    s_waitcnt lgkmcnt(7)
    v_mfma_f32_16x16x32_bf16 v[180:183], v[16:19], v[212:215], 0
    v_mfma_f32_16x16x32_bf16 v[196:199], v[20:23], v[212:215], 0
    ds_read_b128 v[212:215], v14 offset:2304
    s_waitcnt lgkmcnt(7)
    v_mfma_f32_16x16x32_bf16 v[184:187], v[16:19], v[216:219], 0
    v_mfma_f32_16x16x32_bf16 v[200:203], v[20:23], v[216:219], 0
    ds_read_b128 v[216:219], v14 offset:2560
    s_waitcnt lgkmcnt(7)
    v_mfma_f32_16x16x32_bf16 v[188:191], v[16:19], v[220:223], 0
    v_mfma_f32_16x16x32_bf16 v[204:207], v[20:23], v[220:223], 0
    ds_read_b128 v[220:223], v14 offset:2816
    s_waitcnt lgkmcnt(7)
    v_mfma_f32_16x16x32_bf16 v[176:179], v[24:27], v[224:227], v[176:179]
    v_mfma_f32_16x16x32_bf16 v[192:195], v[28:31], v[224:227], v[192:195]
    s_waitcnt lgkmcnt(6)
    v_mfma_f32_16x16x32_bf16 v[180:183], v[24:27], v[228:231], v[180:183]
    v_mfma_f32_16x16x32_bf16 v[196:199], v[28:31], v[228:231], v[196:199]
    s_waitcnt lgkmcnt(5)
    v_mfma_f32_16x16x32_bf16 v[184:187], v[24:27], v[232:235], v[184:187]
    v_mfma_f32_16x16x32_bf16 v[200:203], v[28:31], v[232:235], v[200:203]
    s_waitcnt lgkmcnt(4)
    v_mfma_f32_16x16x32_bf16 v[188:191], v[24:27], v[236:239], v[188:191]
    v_mfma_f32_16x16x32_bf16 v[204:207], v[28:31], v[236:239], v[204:207]
    s_waitcnt lgkmcnt(3)
    v_mfma_f32_16x16x32_bf16 v[176:179], v[32:35], v[208:211], v[176:179]
    v_mfma_f32_16x16x32_bf16 v[192:195], v[36:39], v[208:211], v[192:195]
    s_barrier
    s_waitcnt lgkmcnt(2)
    v_mfma_f32_16x16x32_bf16 v[180:183], v[32:35], v[212:215], v[180:183]
    ds_read_b128 v[224:227], v14 offset:3072
    v_mfma_f32_16x16x32_bf16 v[196:199], v[36:39], v[212:215], v[196:199]
    ds_read_b128 v[228:231], v14 offset:3328
    s_waitcnt lgkmcnt(3)
    v_mfma_f32_16x16x32_bf16 v[184:187], v[32:35], v[216:219], v[184:187]
    ds_read_b128 v[232:235], v14 offset:3584
    v_mfma_f32_16x16x32_bf16 v[200:203], v[36:39], v[216:219], v[200:203]
    ds_read_b128 v[236:239], v14 offset:3840
    s_waitcnt lgkmcnt(4)
    v_mfma_f32_16x16x32_bf16 v[188:191], v[32:35], v[220:223], v[188:191]
    ds_read_b128 v[208:211], v14 offset:4096
    v_mfma_f32_16x16x32_bf16 v[204:207], v[36:39], v[220:223], v[204:207]
    ds_read_b128 v[212:215], v14 offset:4352
    s_waitcnt lgkmcnt(5)
    v_mfma_f32_16x16x32_bf16 v[176:179], v[40:43], v[224:227], v[176:179]
    ds_read_b128 v[216:219], v14 offset:4608
    v_mfma_f32_16x16x32_bf16 v[192:195], v[44:47], v[224:227], v[192:195]
    ds_read_b128 v[220:223], v14 offset:4864
    s_waitcnt lgkmcnt(6)
    v_mfma_f32_16x16x32_bf16 v[180:183], v[40:43], v[228:231], v[180:183]
    ds_read_b128 v[224:227], v14 offset:5120
    v_mfma_f32_16x16x32_bf16 v[196:199], v[44:47], v[228:231], v[196:199]
    ds_read_b128 v[228:231], v14 offset:5376
    s_waitcnt lgkmcnt(7)
    v_mfma_f32_16x16x32_bf16 v[184:187], v[40:43], v[232:235], v[184:187]
    v_mfma_f32_16x16x32_bf16 v[200:203], v[44:47], v[232:235], v[200:203]
    ds_read_b128 v[232:235], v14 offset:5632
    s_waitcnt lgkmcnt(7)
    v_mfma_f32_16x16x32_bf16 v[188:191], v[40:43], v[236:239], v[188:191]
    v_mfma_f32_16x16x32_bf16 v[204:207], v[44:47], v[236:239], v[204:207]
    ds_read_b128 v[236:239], v14 offset:5888
    s_waitcnt lgkmcnt(7)
    v_mfma_f32_16x16x32_bf16 v[176:179], v[48:51], v[208:211], v[176:179]
    v_mfma_f32_16x16x32_bf16 v[192:195], v[52:55], v[208:211], v[192:195]
    ds_read_b128 v[208:211], v14 offset:6144
    s_waitcnt lgkmcnt(7)
    v_mfma_f32_16x16x32_bf16 v[180:183], v[48:51], v[212:215], v[180:183]
    v_mfma_f32_16x16x32_bf16 v[196:199], v[52:55], v[212:215], v[196:199]
    ds_read_b128 v[212:215], v14 offset:6400
    s_waitcnt lgkmcnt(7)
    v_mfma_f32_16x16x32_bf16 v[184:187], v[48:51], v[216:219], v[184:187]
    v_mfma_f32_16x16x32_bf16 v[200:203], v[52:55], v[216:219], v[200:203]
    ds_read_b128 v[216:219], v14 offset:6656
    s_waitcnt lgkmcnt(7)
    v_mfma_f32_16x16x32_bf16 v[188:191], v[48:51], v[220:223], v[188:191]
    v_mfma_f32_16x16x32_bf16 v[204:207], v[52:55], v[220:223], v[204:207]
    ds_read_b128 v[220:223], v14 offset:6912
    s_waitcnt lgkmcnt(7)
    v_mfma_f32_16x16x32_bf16 v[176:179], v[56:59], v[224:227], v[176:179]
    v_mfma_f32_16x16x32_bf16 v[192:195], v[60:63], v[224:227], v[192:195]
    ds_read_b128 v[224:227], v14 offset:7168
    s_waitcnt lgkmcnt(7)
    v_mfma_f32_16x16x32_bf16 v[180:183], v[56:59], v[228:231], v[180:183]
    v_mfma_f32_16x16x32_bf16 v[196:199], v[60:63], v[228:231], v[196:199]
    ds_read_b128 v[228:231], v14 offset:7424
    s_waitcnt lgkmcnt(7)
    v_mfma_f32_16x16x32_bf16 v[184:187], v[56:59], v[232:235], v[184:187]
    v_mfma_f32_16x16x32_bf16 v[200:203], v[60:63], v[232:235], v[200:203]
    ds_read_b128 v[232:235], v14 offset:7680
    s_waitcnt lgkmcnt(7)
    v_mfma_f32_16x16x32_bf16 v[188:191], v[56:59], v[236:239], v[188:191]
    v_mfma_f32_16x16x32_bf16 v[204:207], v[60:63], v[236:239], v[204:207]
    ds_read_b128 v[236:239], v14 offset:7936
    s_waitcnt lgkmcnt(7)
    v_mfma_f32_16x16x32_bf16 v[176:179], v[64:67], v[208:211], v[176:179]
    v_mfma_f32_16x16x32_bf16 v[192:195], v[68:71], v[208:211], v[192:195]
    ds_read_b128 v[208:211], v14 offset:8192
    s_waitcnt lgkmcnt(7)
    v_mfma_f32_16x16x32_bf16 v[180:183], v[64:67], v[212:215], v[180:183]
    v_mfma_f32_16x16x32_bf16 v[196:199], v[68:71], v[212:215], v[196:199]
    ds_read_b128 v[212:215], v14 offset:8448
    s_waitcnt lgkmcnt(7)
    v_mfma_f32_16x16x32_bf16 v[184:187], v[64:67], v[216:219], v[184:187]
    v_mfma_f32_16x16x32_bf16 v[200:203], v[68:71], v[216:219], v[200:203]
    ds_read_b128 v[216:219], v14 offset:8704
    s_waitcnt lgkmcnt(7)
    v_mfma_f32_16x16x32_bf16 v[188:191], v[64:67], v[220:223], v[188:191]
    v_mfma_f32_16x16x32_bf16 v[204:207], v[68:71], v[220:223], v[204:207]
    ds_read_b128 v[220:223], v14 offset:8960
    s_waitcnt lgkmcnt(7)
    v_mfma_f32_16x16x32_bf16 v[176:179], v[72:75], v[224:227], v[176:179]
    v_mfma_f32_16x16x32_bf16 v[192:195], v[76:79], v[224:227], v[192:195]
    ds_read_b128 v[224:227], v14 offset:9216
    s_waitcnt lgkmcnt(7)
    v_mfma_f32_16x16x32_bf16 v[180:183], v[72:75], v[228:231], v[180:183]
    v_mfma_f32_16x16x32_bf16 v[196:199], v[76:79], v[228:231], v[196:199]
    ds_read_b128 v[228:231], v14 offset:9472
    s_waitcnt lgkmcnt(7)
    v_mfma_f32_16x16x32_bf16 v[184:187], v[72:75], v[232:235], v[184:187]
    v_mfma_f32_16x16x32_bf16 v[200:203], v[76:79], v[232:235], v[200:203]
    ds_read_b128 v[232:235], v14 offset:9728
    s_waitcnt lgkmcnt(7)
    v_mfma_f32_16x16x32_bf16 v[188:191], v[72:75], v[236:239], v[188:191]
    v_mfma_f32_16x16x32_bf16 v[204:207], v[76:79], v[236:239], v[204:207]
    ds_read_b128 v[236:239], v14 offset:9984
    s_waitcnt lgkmcnt(7)
    v_mfma_f32_16x16x32_bf16 v[176:179], v[80:83], v[208:211], v[176:179]
    v_mfma_f32_16x16x32_bf16 v[192:195], v[84:87], v[208:211], v[192:195]
    s_waitcnt lgkmcnt(6)
    v_mfma_f32_16x16x32_bf16 v[180:183], v[80:83], v[212:215], v[180:183]
    v_mfma_f32_16x16x32_bf16 v[196:199], v[84:87], v[212:215], v[196:199]
    s_waitcnt lgkmcnt(5)
    v_mfma_f32_16x16x32_bf16 v[184:187], v[80:83], v[216:219], v[184:187]
    v_mfma_f32_16x16x32_bf16 v[200:203], v[84:87], v[216:219], v[200:203]
    s_waitcnt lgkmcnt(4)
    v_mfma_f32_16x16x32_bf16 v[188:191], v[80:83], v[220:223], v[188:191]
    v_mfma_f32_16x16x32_bf16 v[204:207], v[84:87], v[220:223], v[204:207]
    s_waitcnt lgkmcnt(3)
    v_mfma_f32_16x16x32_bf16 v[176:179], v[88:91], v[224:227], v[176:179]
    v_mfma_f32_16x16x32_bf16 v[192:195], v[92:95], v[224:227], v[192:195]
    s_barrier
    s_waitcnt lgkmcnt(2)
    v_mfma_f32_16x16x32_bf16 v[180:183], v[88:91], v[228:231], v[180:183]
    ds_read_b128 v[208:211], v14 offset:10240
    v_mfma_f32_16x16x32_bf16 v[196:199], v[92:95], v[228:231], v[196:199]
    ds_read_b128 v[212:215], v14 offset:10496
    s_waitcnt lgkmcnt(3)
    v_mfma_f32_16x16x32_bf16 v[184:187], v[88:91], v[232:235], v[184:187]
    ds_read_b128 v[216:219], v14 offset:10752
    v_mfma_f32_16x16x32_bf16 v[200:203], v[92:95], v[232:235], v[200:203]
    ds_read_b128 v[220:223], v14 offset:11008
    s_waitcnt lgkmcnt(4)
    v_mfma_f32_16x16x32_bf16 v[188:191], v[88:91], v[236:239], v[188:191]
    ds_read_b128 v[224:227], v14 offset:11264
    v_mfma_f32_16x16x32_bf16 v[204:207], v[92:95], v[236:239], v[204:207]
    ds_read_b128 v[228:231], v14 offset:11520
    s_waitcnt lgkmcnt(5)
    v_mfma_f32_16x16x32_bf16 v[176:179], v[96:99], v[208:211], v[176:179]
    ds_read_b128 v[232:235], v14 offset:11776
    v_mfma_f32_16x16x32_bf16 v[192:195], v[100:103], v[208:211], v[192:195]
    ds_read_b128 v[236:239], v14 offset:12032
    s_waitcnt lgkmcnt(6)
    v_mfma_f32_16x16x32_bf16 v[180:183], v[96:99], v[212:215], v[180:183]
    ds_read_b128 v[208:211], v14 offset:12288
    v_mfma_f32_16x16x32_bf16 v[196:199], v[100:103], v[212:215], v[196:199]
    ds_read_b128 v[212:215], v14 offset:12544
    s_waitcnt lgkmcnt(7)
    v_mfma_f32_16x16x32_bf16 v[184:187], v[96:99], v[216:219], v[184:187]
    v_mfma_f32_16x16x32_bf16 v[200:203], v[100:103], v[216:219], v[200:203]
    ds_read_b128 v[216:219], v14 offset:12800
    s_waitcnt lgkmcnt(7)
    v_mfma_f32_16x16x32_bf16 v[188:191], v[96:99], v[220:223], v[188:191]
    v_mfma_f32_16x16x32_bf16 v[204:207], v[100:103], v[220:223], v[204:207]
    ds_read_b128 v[220:223], v14 offset:13056
    s_waitcnt lgkmcnt(7)
    v_mfma_f32_16x16x32_bf16 v[176:179], v[104:107], v[224:227], v[176:179]
    v_mfma_f32_16x16x32_bf16 v[192:195], v[108:111], v[224:227], v[192:195]
    ds_read_b128 v[224:227], v14 offset:13312
    s_waitcnt lgkmcnt(7)
    v_mfma_f32_16x16x32_bf16 v[180:183], v[104:107], v[228:231], v[180:183]
    v_mfma_f32_16x16x32_bf16 v[196:199], v[108:111], v[228:231], v[196:199]
    ds_read_b128 v[228:231], v14 offset:13568
    s_waitcnt lgkmcnt(7)
    v_mfma_f32_16x16x32_bf16 v[184:187], v[104:107], v[232:235], v[184:187]
    v_mfma_f32_16x16x32_bf16 v[200:203], v[108:111], v[232:235], v[200:203]
    ds_read_b128 v[232:235], v14 offset:13824
    s_waitcnt lgkmcnt(7)
    v_mfma_f32_16x16x32_bf16 v[188:191], v[104:107], v[236:239], v[188:191]
    v_mfma_f32_16x16x32_bf16 v[204:207], v[108:111], v[236:239], v[204:207]
    ds_read_b128 v[236:239], v14 offset:14080
    s_waitcnt lgkmcnt(7)
    v_mfma_f32_16x16x32_bf16 v[176:179], v[112:115], v[208:211], v[176:179]
    s_barrier
    v_mfma_f32_16x16x32_bf16 v[192:195], v[116:119], v[208:211], v[192:195]
    ds_read_b128 v[208:211], v14 offset:14336
    s_waitcnt lgkmcnt(7)
    v_mfma_f32_16x16x32_bf16 v[180:183], v[112:115], v[212:215], v[180:183]
    v_mfma_f32_16x16x32_bf16 v[196:199], v[116:119], v[212:215], v[196:199]
    ds_read_b128 v[212:215], v14 offset:14592
    s_waitcnt lgkmcnt(7)
    v_mfma_f32_16x16x32_bf16 v[184:187], v[112:115], v[216:219], v[184:187]
    v_mfma_f32_16x16x32_bf16 v[200:203], v[116:119], v[216:219], v[200:203]
    ds_read_b128 v[216:219], v14 offset:14848
    s_waitcnt lgkmcnt(7)
    v_mfma_f32_16x16x32_bf16 v[188:191], v[112:115], v[220:223], v[188:191]
    v_mfma_f32_16x16x32_bf16 v[204:207], v[116:119], v[220:223], v[204:207]
    ds_read_b128 v[220:223], v14 offset:15104
    s_waitcnt lgkmcnt(7)
    v_mfma_f32_16x16x32_bf16 v[176:179], v[120:123], v[224:227], v[176:179]
    v_mfma_f32_16x16x32_bf16 v[192:195], v[124:127], v[224:227], v[192:195]
    ds_read_b128 v[224:227], v14 offset:15360
    s_waitcnt lgkmcnt(7)
    v_mfma_f32_16x16x32_bf16 v[180:183], v[120:123], v[228:231], v[180:183]
    v_mfma_f32_16x16x32_bf16 v[196:199], v[124:127], v[228:231], v[196:199]
    ds_read_b128 v[228:231], v14 offset:15616
    s_waitcnt lgkmcnt(7)
    v_mfma_f32_16x16x32_bf16 v[184:187], v[120:123], v[232:235], v[184:187]
    v_mfma_f32_16x16x32_bf16 v[200:203], v[124:127], v[232:235], v[200:203]
    ds_read_b128 v[232:235], v14 offset:15872
    s_waitcnt lgkmcnt(7)
    v_mfma_f32_16x16x32_bf16 v[188:191], v[120:123], v[236:239], v[188:191]
    v_mfma_f32_16x16x32_bf16 v[204:207], v[124:127], v[236:239], v[204:207]
    ds_read_b128 v[236:239], v14 offset:16128
    s_waitcnt lgkmcnt(7)
    v_mfma_f32_16x16x32_bf16 v[176:179], v[128:131], v[208:211], v[176:179]
    v_mfma_f32_16x16x32_bf16 v[192:195], v[132:135], v[208:211], v[192:195]
    ds_read_b128 v[208:211], v14 offset:16384
    s_waitcnt lgkmcnt(7)
    v_mfma_f32_16x16x32_bf16 v[180:183], v[128:131], v[212:215], v[180:183]
    v_mfma_f32_16x16x32_bf16 v[196:199], v[132:135], v[212:215], v[196:199]
    ds_read_b128 v[212:215], v14 offset:16640
    s_waitcnt lgkmcnt(7)
    v_mfma_f32_16x16x32_bf16 v[184:187], v[128:131], v[216:219], v[184:187]
    v_mfma_f32_16x16x32_bf16 v[200:203], v[132:135], v[216:219], v[200:203]
    ds_read_b128 v[216:219], v14 offset:16896
    s_waitcnt lgkmcnt(7)
    v_mfma_f32_16x16x32_bf16 v[188:191], v[128:131], v[220:223], v[188:191]
    v_mfma_f32_16x16x32_bf16 v[204:207], v[132:135], v[220:223], v[204:207]
    ds_read_b128 v[220:223], v14 offset:17152
    s_waitcnt lgkmcnt(7)
    v_mfma_f32_16x16x32_bf16 v[176:179], v[136:139], v[224:227], v[176:179]
    v_mfma_f32_16x16x32_bf16 v[192:195], v[140:143], v[224:227], v[192:195]
    ds_read_b128 v[224:227], v14 offset:17408
    s_waitcnt lgkmcnt(7)
    v_mfma_f32_16x16x32_bf16 v[180:183], v[136:139], v[228:231], v[180:183]
    v_mfma_f32_16x16x32_bf16 v[196:199], v[140:143], v[228:231], v[196:199]
    ds_read_b128 v[228:231], v14 offset:17664
    s_waitcnt lgkmcnt(7)
    v_mfma_f32_16x16x32_bf16 v[184:187], v[136:139], v[232:235], v[184:187]
    v_mfma_f32_16x16x32_bf16 v[200:203], v[140:143], v[232:235], v[200:203]
    ds_read_b128 v[232:235], v14 offset:17920
    s_waitcnt lgkmcnt(7)
    v_mfma_f32_16x16x32_bf16 v[188:191], v[136:139], v[236:239], v[188:191]
    v_mfma_f32_16x16x32_bf16 v[204:207], v[140:143], v[236:239], v[204:207]
    ds_read_b128 v[236:239], v14 offset:18176
    s_waitcnt lgkmcnt(7)
    v_mfma_f32_16x16x32_bf16 v[176:179], v[144:147], v[208:211], v[176:179]
    v_mfma_f32_16x16x32_bf16 v[192:195], v[148:151], v[208:211], v[192:195]
    ds_read_b128 v[208:211], v14 offset:18432
    s_waitcnt lgkmcnt(7)
    v_mfma_f32_16x16x32_bf16 v[180:183], v[144:147], v[212:215], v[180:183]
    v_mfma_f32_16x16x32_bf16 v[196:199], v[148:151], v[212:215], v[196:199]
    ds_read_b128 v[212:215], v14 offset:18688
    s_waitcnt lgkmcnt(7)
    v_mfma_f32_16x16x32_bf16 v[184:187], v[144:147], v[216:219], v[184:187]
    v_mfma_f32_16x16x32_bf16 v[200:203], v[148:151], v[216:219], v[200:203]
    ds_read_b128 v[216:219], v14 offset:18944
    s_waitcnt lgkmcnt(7)
    v_mfma_f32_16x16x32_bf16 v[188:191], v[144:147], v[220:223], v[188:191]
    v_mfma_f32_16x16x32_bf16 v[204:207], v[148:151], v[220:223], v[204:207]
    ds_read_b128 v[220:223], v14 offset:19200
    s_waitcnt lgkmcnt(7)
    v_mfma_f32_16x16x32_bf16 v[176:179], v[152:155], v[224:227], v[176:179]
    v_mfma_f32_16x16x32_bf16 v[192:195], v[156:159], v[224:227], v[192:195]
    ds_read_b128 v[224:227], v14 offset:19456
    s_waitcnt lgkmcnt(7)
    v_mfma_f32_16x16x32_bf16 v[180:183], v[152:155], v[228:231], v[180:183]
    v_mfma_f32_16x16x32_bf16 v[196:199], v[156:159], v[228:231], v[196:199]
    ds_read_b128 v[228:231], v14 offset:19712
    s_waitcnt lgkmcnt(7)
    v_mfma_f32_16x16x32_bf16 v[184:187], v[152:155], v[232:235], v[184:187]
    v_mfma_f32_16x16x32_bf16 v[200:203], v[156:159], v[232:235], v[200:203]
    ds_read_b128 v[232:235], v14 offset:19968
    s_waitcnt lgkmcnt(7)
    v_mfma_f32_16x16x32_bf16 v[188:191], v[152:155], v[236:239], v[188:191]
    v_mfma_f32_16x16x32_bf16 v[204:207], v[156:159], v[236:239], v[204:207]
    ds_read_b128 v[236:239], v14 offset:20224
    s_waitcnt lgkmcnt(7)
    v_mfma_f32_16x16x32_bf16 v[176:179], v[160:163], v[208:211], v[176:179]
    v_mfma_f32_16x16x32_bf16 v[192:195], v[164:167], v[208:211], v[192:195]
    s_waitcnt lgkmcnt(6)
    v_mfma_f32_16x16x32_bf16 v[180:183], v[160:163], v[212:215], v[180:183]
    v_mfma_f32_16x16x32_bf16 v[196:199], v[164:167], v[212:215], v[196:199]
    s_waitcnt lgkmcnt(5)
    v_mfma_f32_16x16x32_bf16 v[184:187], v[160:163], v[216:219], v[184:187]
    v_mfma_f32_16x16x32_bf16 v[200:203], v[164:167], v[216:219], v[200:203]
    s_waitcnt lgkmcnt(4)
    v_mfma_f32_16x16x32_bf16 v[188:191], v[160:163], v[220:223], v[188:191]
    v_mfma_f32_16x16x32_bf16 v[204:207], v[164:167], v[220:223], v[204:207]
    s_waitcnt lgkmcnt(3)
    v_mfma_f32_16x16x32_bf16 v[176:179], v[168:171], v[224:227], v[176:179]
    v_mfma_f32_16x16x32_bf16 v[192:195], v[172:175], v[224:227], v[192:195]
    s_waitcnt lgkmcnt(2)
    v_mfma_f32_16x16x32_bf16 v[180:183], v[168:171], v[228:231], v[180:183]
    v_mfma_f32_16x16x32_bf16 v[196:199], v[172:175], v[228:231], v[196:199]
    s_waitcnt lgkmcnt(1)
    v_mfma_f32_16x16x32_bf16 v[184:187], v[168:171], v[232:235], v[184:187]
    s_waitcnt lgkmcnt(0)
    s_barrier
    v_mfma_f32_16x16x32_bf16 v[200:203], v[172:175], v[232:235], v[200:203]
    v_mfma_f32_16x16x32_bf16 v[188:191], v[168:171], v[236:239], v[188:191]
    v_mfma_f32_16x16x32_bf16 v[204:207], v[172:175], v[236:239], v[204:207]
    s_setprio 0
    ds_read_b96 v[208:210], v12 offset:0
    ds_read_b96 v[212:214], v12 offset:256
    ds_read_b96 v[216:218], v12 offset:512
    ds_read_b96 v[220:222], v12 offset:768
    s_waitcnt lgkmcnt(3)
    v_fmac_f32 v176, v240, v209
    v_fmac_f32 v177, v241, v209
    v_fmac_f32 v178, v242, v209
    v_fmac_f32 v179, v243, v209
    s_waitcnt lgkmcnt(2)
    v_fmac_f32 v180, v240, v213
    v_fmac_f32 v181, v241, v213
    v_fmac_f32 v182, v242, v213
    v_fmac_f32 v183, v243, v213
    v_mul_f32 v248, v176, v208
    v_mul_f32 v249, v177, v208
    v_mul_f32 v250, v178, v208
    v_mul_f32 v251, v179, v208
    v_mul_f32 v252, v180, v212
    v_mul_f32 v253, v181, v212
    v_mul_f32 v254, v182, v212
    v_mul_f32 v255, v183, v212
    v_exp_f32 v248, v248
    v_fmac_f32 v192, v244, v209
    v_exp_f32 v249, v249
    v_fmac_f32 v193, v245, v209
    v_exp_f32 v250, v250
    v_fmac_f32 v194, v246, v209
    v_exp_f32 v251, v251
    v_fmac_f32 v195, v247, v209
    v_exp_f32 v252, v252
    v_fmac_f32 v196, v244, v213
    v_exp_f32 v253, v253
    v_fmac_f32 v197, v245, v213
    v_exp_f32 v254, v254
    v_fmac_f32 v198, v246, v213
    v_exp_f32 v255, v255
    v_fmac_f32 v199, v247, v213
    v_fma_f32 v248, v248, v210, v210
    v_fma_f32 v249, v249, v210, v210
    v_fma_f32 v250, v250, v210, v210
    v_fma_f32 v251, v251, v210, v210
    v_fma_f32 v252, v252, v214, v214
    v_fma_f32 v253, v253, v214, v214
    v_fma_f32 v254, v254, v214, v214
    v_fma_f32 v255, v255, v214, v214
    v_rcp_f32 v248, v248
    v_mul_f32 v176, v176, v192
    v_rcp_f32 v249, v249
    v_mul_f32 v177, v177, v193
    v_rcp_f32 v250, v250
    v_mul_f32 v178, v178, v194
    v_rcp_f32 v251, v251
    v_mul_f32 v179, v179, v195
    v_rcp_f32 v252, v252
    v_mul_f32 v180, v180, v196
    v_rcp_f32 v253, v253
    v_mul_f32 v181, v181, v197
    v_rcp_f32 v254, v254
    v_mul_f32 v182, v182, v198
    v_rcp_f32 v255, v255
    v_mul_f32 v183, v183, v199
    v_mul_f32 v176, v176, v248
    v_mul_f32 v177, v177, v249
    v_mul_f32 v178, v178, v250
    v_mul_f32 v179, v179, v251
    v_mul_f32 v180, v180, v252
    v_mul_f32 v181, v181, v253
    v_mul_f32 v182, v182, v254
    v_mul_f32 v183, v183, v255
    v_cvt_pk_bf16_f32 v192, v176, v177
    v_cvt_pk_bf16_f32 v194, v180, v181
    v_cvt_pk_bf16_f32 v193, v178, v179
    v_cvt_pk_bf16_f32 v195, v182, v183
    v_permlane32_swap_b32 v192, v194
    s_nop 0
    v_permlane32_swap_b32 v193, v195
    buffer_store_dwordx4 v[192:195], v13, s[20:23], s58 offen sc1
    s_add_u32 s58, s58, 98304
    s_waitcnt lgkmcnt(1)
    v_fmac_f32 v184, v240, v217
    v_fmac_f32 v185, v241, v217
    v_fmac_f32 v186, v242, v217
    v_fmac_f32 v187, v243, v217
    s_waitcnt lgkmcnt(0)
    v_fmac_f32 v188, v240, v221
    v_fmac_f32 v189, v241, v221
    v_fmac_f32 v190, v242, v221
    v_fmac_f32 v191, v243, v221
    v_mul_f32 v248, v184, v216
    v_mul_f32 v249, v185, v216
    v_mul_f32 v250, v186, v216
    v_mul_f32 v251, v187, v216
    v_mul_f32 v252, v188, v220
    v_mul_f32 v253, v189, v220
    v_mul_f32 v254, v190, v220
    v_mul_f32 v255, v191, v220
    v_exp_f32 v248, v248
    v_fmac_f32 v200, v244, v217
    v_exp_f32 v249, v249
    v_fmac_f32 v201, v245, v217
    v_exp_f32 v250, v250
    v_fmac_f32 v202, v246, v217
    v_exp_f32 v251, v251
    v_fmac_f32 v203, v247, v217
    v_exp_f32 v252, v252
    v_fmac_f32 v204, v244, v221
    v_exp_f32 v253, v253
    v_fmac_f32 v205, v245, v221
    v_exp_f32 v254, v254
    v_fmac_f32 v206, v246, v221
    v_exp_f32 v255, v255
    v_fmac_f32 v207, v247, v221
    v_fma_f32 v248, v248, v218, v218
    v_fma_f32 v249, v249, v218, v218
    v_fma_f32 v250, v250, v218, v218
    v_fma_f32 v251, v251, v218, v218
    v_fma_f32 v252, v252, v222, v222
    v_fma_f32 v253, v253, v222, v222
    v_fma_f32 v254, v254, v222, v222
    v_fma_f32 v255, v255, v222, v222
    v_rcp_f32 v248, v248
    v_mul_f32 v184, v184, v200
    v_rcp_f32 v249, v249
    v_mul_f32 v185, v185, v201
    v_rcp_f32 v250, v250
    v_mul_f32 v186, v186, v202
    v_rcp_f32 v251, v251
    v_mul_f32 v187, v187, v203
    v_rcp_f32 v252, v252
    v_mul_f32 v188, v188, v204
    v_rcp_f32 v253, v253
    v_mul_f32 v189, v189, v205
    v_rcp_f32 v254, v254
    v_mul_f32 v190, v190, v206
    v_rcp_f32 v255, v255
    v_mul_f32 v191, v191, v207
    v_mul_f32 v184, v184, v248
    v_mul_f32 v185, v185, v249
    v_mul_f32 v186, v186, v250
    v_mul_f32 v187, v187, v251
    v_mul_f32 v188, v188, v252
    v_mul_f32 v189, v189, v253
    v_mul_f32 v190, v190, v254
    v_mul_f32 v191, v191, v255
    v_cvt_pk_bf16_f32 v200, v184, v185
    v_cvt_pk_bf16_f32 v202, v188, v189
    v_cvt_pk_bf16_f32 v201, v186, v187
    v_cvt_pk_bf16_f32 v203, v190, v191
    v_permlane32_swap_b32 v200, v202
    s_nop 0
    v_permlane32_swap_b32 v201, v203
    buffer_store_dwordx4 v[200:203], v13, s[20:23], s58 offen sc1
    s_add_u32 s58, s58, 98304
    s_setprio 1
    ds_read_b128 v[208:211], v15 offset:0
    ds_read_b128 v[212:215], v15 offset:256
    ds_read_b128 v[216:219], v15 offset:512
    ds_read_b128 v[220:223], v15 offset:768
    ds_read_b128 v[224:227], v15 offset:1024
    ds_read_b128 v[228:231], v15 offset:1280
    ds_read_b128 v[232:235], v15 offset:1536
    ds_read_b128 v[236:239], v15 offset:1792
    s_waitcnt lgkmcnt(7)
    v_mfma_f32_16x16x32_bf16 v[176:179], v[16:19], v[208:211], 0
    v_mfma_f32_16x16x32_bf16 v[192:195], v[20:23], v[208:211], 0
    ds_read_b128 v[208:211], v15 offset:2048
    s_waitcnt lgkmcnt(7)
    v_mfma_f32_16x16x32_bf16 v[180:183], v[16:19], v[212:215], 0
    v_mfma_f32_16x16x32_bf16 v[196:199], v[20:23], v[212:215], 0
    ds_read_b128 v[212:215], v15 offset:2304
    s_waitcnt lgkmcnt(7)
    v_mfma_f32_16x16x32_bf16 v[184:187], v[16:19], v[216:219], 0
    v_mfma_f32_16x16x32_bf16 v[200:203], v[20:23], v[216:219], 0
    ds_read_b128 v[216:219], v15 offset:2560
    s_waitcnt lgkmcnt(7)
    v_mfma_f32_16x16x32_bf16 v[188:191], v[16:19], v[220:223], 0
    v_mfma_f32_16x16x32_bf16 v[204:207], v[20:23], v[220:223], 0
    ds_read_b128 v[220:223], v15 offset:2816
    s_waitcnt lgkmcnt(7)
    v_mfma_f32_16x16x32_bf16 v[176:179], v[24:27], v[224:227], v[176:179]
    v_mfma_f32_16x16x32_bf16 v[192:195], v[28:31], v[224:227], v[192:195]
    ds_read_b128 v[224:227], v15 offset:3072
    buffer_load_dwordx4 v[16:19], v5, s[20:23], s59 offen offset:0
    s_waitcnt lgkmcnt(7)
    v_mfma_f32_16x16x32_bf16 v[180:183], v[24:27], v[228:231], v[180:183]
    v_mfma_f32_16x16x32_bf16 v[196:199], v[28:31], v[228:231], v[196:199]
    ds_read_b128 v[228:231], v15 offset:3328
    s_waitcnt lgkmcnt(7)
    v_mfma_f32_16x16x32_bf16 v[184:187], v[24:27], v[232:235], v[184:187]
    v_mfma_f32_16x16x32_bf16 v[200:203], v[28:31], v[232:235], v[200:203]
    ds_read_b128 v[232:235], v15 offset:3584
    buffer_load_dwordx4 v[20:23], v5, s[20:23], s59 offen offset:1024
    s_waitcnt lgkmcnt(7)
    v_mfma_f32_16x16x32_bf16 v[188:191], v[24:27], v[236:239], v[188:191]
    v_mfma_f32_16x16x32_bf16 v[204:207], v[28:31], v[236:239], v[204:207]
    ds_read_b128 v[236:239], v15 offset:3840
    s_waitcnt lgkmcnt(7)
    v_mfma_f32_16x16x32_bf16 v[176:179], v[32:35], v[208:211], v[176:179]
    v_mfma_f32_16x16x32_bf16 v[192:195], v[36:39], v[208:211], v[192:195]
    ds_read_b128 v[208:211], v15 offset:4096
    buffer_load_dwordx4 v[24:27], v5, s[20:23], s59 offen offset:2048
    s_waitcnt lgkmcnt(7)
    v_mfma_f32_16x16x32_bf16 v[180:183], v[32:35], v[212:215], v[180:183]
    v_mfma_f32_16x16x32_bf16 v[196:199], v[36:39], v[212:215], v[196:199]
    ds_read_b128 v[212:215], v15 offset:4352
    s_waitcnt lgkmcnt(7)
    v_mfma_f32_16x16x32_bf16 v[184:187], v[32:35], v[216:219], v[184:187]
    v_mfma_f32_16x16x32_bf16 v[200:203], v[36:39], v[216:219], v[200:203]
    ds_read_b128 v[216:219], v15 offset:4608
    buffer_load_dwordx4 v[28:31], v5, s[20:23], s59 offen offset:3072
    s_add_u32 s59, s59, 4096
    s_waitcnt lgkmcnt(7)
    v_mfma_f32_16x16x32_bf16 v[188:191], v[32:35], v[220:223], v[188:191]
    v_mfma_f32_16x16x32_bf16 v[204:207], v[36:39], v[220:223], v[204:207]
    ds_read_b128 v[220:223], v15 offset:4864
    s_waitcnt lgkmcnt(7)
    v_mfma_f32_16x16x32_bf16 v[176:179], v[40:43], v[224:227], v[176:179]
    v_mfma_f32_16x16x32_bf16 v[192:195], v[44:47], v[224:227], v[192:195]
    ds_read_b128 v[224:227], v15 offset:5120
    buffer_load_dwordx4 v[32:35], v5, s[20:23], s59 offen offset:0
    s_waitcnt lgkmcnt(7)
    v_mfma_f32_16x16x32_bf16 v[180:183], v[40:43], v[228:231], v[180:183]
    v_mfma_f32_16x16x32_bf16 v[196:199], v[44:47], v[228:231], v[196:199]
    ds_read_b128 v[228:231], v15 offset:5376
    s_waitcnt lgkmcnt(7)
    v_mfma_f32_16x16x32_bf16 v[184:187], v[40:43], v[232:235], v[184:187]
    v_mfma_f32_16x16x32_bf16 v[200:203], v[44:47], v[232:235], v[200:203]
    ds_read_b128 v[232:235], v15 offset:5632
    buffer_load_dwordx4 v[36:39], v5, s[20:23], s59 offen offset:1024
    s_waitcnt lgkmcnt(7)
    v_mfma_f32_16x16x32_bf16 v[188:191], v[40:43], v[236:239], v[188:191]
    v_mfma_f32_16x16x32_bf16 v[204:207], v[44:47], v[236:239], v[204:207]
    ds_read_b128 v[236:239], v15 offset:5888
    s_waitcnt lgkmcnt(7)
    v_mfma_f32_16x16x32_bf16 v[176:179], v[48:51], v[208:211], v[176:179]
    v_mfma_f32_16x16x32_bf16 v[192:195], v[52:55], v[208:211], v[192:195]
    ds_read_b128 v[208:211], v15 offset:6144
    buffer_load_dwordx4 v[40:43], v5, s[20:23], s59 offen offset:2048
    s_waitcnt lgkmcnt(7)
    v_mfma_f32_16x16x32_bf16 v[180:183], v[48:51], v[212:215], v[180:183]
    v_mfma_f32_16x16x32_bf16 v[196:199], v[52:55], v[212:215], v[196:199]
    ds_read_b128 v[212:215], v15 offset:6400
    s_waitcnt lgkmcnt(7)
    v_mfma_f32_16x16x32_bf16 v[184:187], v[48:51], v[216:219], v[184:187]
    v_mfma_f32_16x16x32_bf16 v[200:203], v[52:55], v[216:219], v[200:203]
    ds_read_b128 v[216:219], v15 offset:6656
    buffer_load_dwordx4 v[44:47], v5, s[20:23], s59 offen offset:3072
    s_add_u32 s59, s59, 4096
    s_waitcnt lgkmcnt(7)
    v_mfma_f32_16x16x32_bf16 v[188:191], v[48:51], v[220:223], v[188:191]
    v_mfma_f32_16x16x32_bf16 v[204:207], v[52:55], v[220:223], v[204:207]
    ds_read_b128 v[220:223], v15 offset:6912
    s_waitcnt lgkmcnt(7)
    v_mfma_f32_16x16x32_bf16 v[176:179], v[56:59], v[224:227], v[176:179]
    v_mfma_f32_16x16x32_bf16 v[192:195], v[60:63], v[224:227], v[192:195]
    ds_read_b128 v[224:227], v15 offset:7168
    buffer_load_dwordx4 v[48:51], v5, s[20:23], s59 offen offset:0
    s_waitcnt lgkmcnt(7)
    v_mfma_f32_16x16x32_bf16 v[180:183], v[56:59], v[228:231], v[180:183]
    v_mfma_f32_16x16x32_bf16 v[196:199], v[60:63], v[228:231], v[196:199]
    ds_read_b128 v[228:231], v15 offset:7424
    s_waitcnt lgkmcnt(7)
    v_mfma_f32_16x16x32_bf16 v[184:187], v[56:59], v[232:235], v[184:187]
    v_mfma_f32_16x16x32_bf16 v[200:203], v[60:63], v[232:235], v[200:203]
    ds_read_b128 v[232:235], v15 offset:7680
    buffer_load_dwordx4 v[52:55], v5, s[20:23], s59 offen offset:1024
    s_waitcnt lgkmcnt(7)
    v_mfma_f32_16x16x32_bf16 v[188:191], v[56:59], v[236:239], v[188:191]
    v_mfma_f32_16x16x32_bf16 v[204:207], v[60:63], v[236:239], v[204:207]
    ds_read_b128 v[236:239], v15 offset:7936
    s_waitcnt lgkmcnt(7)
    v_mfma_f32_16x16x32_bf16 v[176:179], v[64:67], v[208:211], v[176:179]
    v_mfma_f32_16x16x32_bf16 v[192:195], v[68:71], v[208:211], v[192:195]
    ds_read_b128 v[208:211], v15 offset:8192
    buffer_load_dwordx4 v[56:59], v5, s[20:23], s59 offen offset:2048
    s_waitcnt lgkmcnt(7)
    v_mfma_f32_16x16x32_bf16 v[180:183], v[64:67], v[212:215], v[180:183]
    v_mfma_f32_16x16x32_bf16 v[196:199], v[68:71], v[212:215], v[196:199]
    ds_read_b128 v[212:215], v15 offset:8448
    s_waitcnt lgkmcnt(7)
    v_mfma_f32_16x16x32_bf16 v[184:187], v[64:67], v[216:219], v[184:187]
    v_mfma_f32_16x16x32_bf16 v[200:203], v[68:71], v[216:219], v[200:203]
    ds_read_b128 v[216:219], v15 offset:8704
    buffer_load_dwordx4 v[60:63], v5, s[20:23], s59 offen offset:3072
    s_add_u32 s59, s59, 4096
    s_waitcnt lgkmcnt(7)
    v_mfma_f32_16x16x32_bf16 v[188:191], v[64:67], v[220:223], v[188:191]
    v_mfma_f32_16x16x32_bf16 v[204:207], v[68:71], v[220:223], v[204:207]
    ds_read_b128 v[220:223], v15 offset:8960
    s_waitcnt lgkmcnt(7)
    v_mfma_f32_16x16x32_bf16 v[176:179], v[72:75], v[224:227], v[176:179]
    v_mfma_f32_16x16x32_bf16 v[192:195], v[76:79], v[224:227], v[192:195]
    ds_read_b128 v[224:227], v15 offset:9216
    buffer_load_dwordx4 v[64:67], v5, s[20:23], s59 offen offset:0
    s_waitcnt lgkmcnt(7)
    v_mfma_f32_16x16x32_bf16 v[180:183], v[72:75], v[228:231], v[180:183]
    v_mfma_f32_16x16x32_bf16 v[196:199], v[76:79], v[228:231], v[196:199]
    ds_read_b128 v[228:231], v15 offset:9472
    s_waitcnt lgkmcnt(7)
    v_mfma_f32_16x16x32_bf16 v[184:187], v[72:75], v[232:235], v[184:187]
    v_mfma_f32_16x16x32_bf16 v[200:203], v[76:79], v[232:235], v[200:203]
    ds_read_b128 v[232:235], v15 offset:9728
    buffer_load_dwordx4 v[68:71], v5, s[20:23], s59 offen offset:1024
    s_waitcnt lgkmcnt(7)
    v_mfma_f32_16x16x32_bf16 v[188:191], v[72:75], v[236:239], v[188:191]
    v_mfma_f32_16x16x32_bf16 v[204:207], v[76:79], v[236:239], v[204:207]
    ds_read_b128 v[236:239], v15 offset:9984
    s_waitcnt lgkmcnt(7)
    v_mfma_f32_16x16x32_bf16 v[176:179], v[80:83], v[208:211], v[176:179]
    v_mfma_f32_16x16x32_bf16 v[192:195], v[84:87], v[208:211], v[192:195]
    ds_read_b128 v[208:211], v15 offset:10240
    buffer_load_dwordx4 v[72:75], v5, s[20:23], s59 offen offset:2048
    s_waitcnt lgkmcnt(7)
    v_mfma_f32_16x16x32_bf16 v[180:183], v[80:83], v[212:215], v[180:183]
    v_mfma_f32_16x16x32_bf16 v[196:199], v[84:87], v[212:215], v[196:199]
    ds_read_b128 v[212:215], v15 offset:10496
    s_waitcnt lgkmcnt(7)
    v_mfma_f32_16x16x32_bf16 v[184:187], v[80:83], v[216:219], v[184:187]
    v_mfma_f32_16x16x32_bf16 v[200:203], v[84:87], v[216:219], v[200:203]
    ds_read_b128 v[216:219], v15 offset:10752
    buffer_load_dwordx4 v[76:79], v5, s[20:23], s59 offen offset:3072
    s_add_u32 s59, s59, 4096
    s_waitcnt lgkmcnt(7)
    v_mfma_f32_16x16x32_bf16 v[188:191], v[80:83], v[220:223], v[188:191]
    v_mfma_f32_16x16x32_bf16 v[204:207], v[84:87], v[220:223], v[204:207]
    ds_read_b128 v[220:223], v15 offset:11008
    s_waitcnt lgkmcnt(7)
    v_mfma_f32_16x16x32_bf16 v[176:179], v[88:91], v[224:227], v[176:179]
    v_mfma_f32_16x16x32_bf16 v[192:195], v[92:95], v[224:227], v[192:195]
    ds_read_b128 v[224:227], v15 offset:11264
    buffer_load_dwordx4 v[80:83], v5, s[20:23], s59 offen offset:0
    s_waitcnt lgkmcnt(7)
    v_mfma_f32_16x16x32_bf16 v[180:183], v[88:91], v[228:231], v[180:183]
    v_mfma_f32_16x16x32_bf16 v[196:199], v[92:95], v[228:231], v[196:199]
    ds_read_b128 v[228:231], v15 offset:11520
    s_waitcnt lgkmcnt(7)
    v_mfma_f32_16x16x32_bf16 v[184:187], v[88:91], v[232:235], v[184:187]
    v_mfma_f32_16x16x32_bf16 v[200:203], v[92:95], v[232:235], v[200:203]
    ds_read_b128 v[232:235], v15 offset:11776
    buffer_load_dwordx4 v[84:87], v5, s[20:23], s59 offen offset:1024
    s_waitcnt lgkmcnt(7)
    v_mfma_f32_16x16x32_bf16 v[188:191], v[88:91], v[236:239], v[188:191]
    v_mfma_f32_16x16x32_bf16 v[204:207], v[92:95], v[236:239], v[204:207]
    ds_read_b128 v[236:239], v15 offset:12032
    s_waitcnt lgkmcnt(7)
    v_mfma_f32_16x16x32_bf16 v[176:179], v[96:99], v[208:211], v[176:179]
    s_waitcnt vmcnt(18)
    s_cmp_eq_u32 s26, 0
    s_cbranch_scc1 kx_fused_kernel_slow28
    s_mov_b64 exec, 1
    buffer_store_dword v11, off, s[20:23], s71
    s_mov_b64 exec, -1
kx_fused_kernel_back29:
    v_mov_b32 v11, 2
    v_mfma_f32_16x16x32_bf16 v[192:195], v[100:103], v[208:211], v[192:195]
    ds_read_b128 v[208:211], v15 offset:12288
    buffer_load_dwordx4 v[88:91], v5, s[20:23], s59 offen offset:2048
    s_waitcnt lgkmcnt(7)
    v_mfma_f32_16x16x32_bf16 v[180:183], v[96:99], v[212:215], v[180:183]
    v_mfma_f32_16x16x32_bf16 v[196:199], v[100:103], v[212:215], v[196:199]
    ds_read_b128 v[212:215], v15 offset:12544
    s_waitcnt lgkmcnt(7)
    v_mfma_f32_16x16x32_bf16 v[184:187], v[96:99], v[216:219], v[184:187]
    v_mfma_f32_16x16x32_bf16 v[200:203], v[100:103], v[216:219], v[200:203]
    ds_read_b128 v[216:219], v15 offset:12800
    buffer_load_dwordx4 v[92:95], v5, s[20:23], s59 offen offset:3072
    s_add_u32 s59, s59, 4096
    s_waitcnt lgkmcnt(7)
    v_mfma_f32_16x16x32_bf16 v[188:191], v[96:99], v[220:223], v[188:191]
    v_mfma_f32_16x16x32_bf16 v[204:207], v[100:103], v[220:223], v[204:207]
    ds_read_b128 v[220:223], v15 offset:13056
    s_waitcnt lgkmcnt(7)
    v_mfma_f32_16x16x32_bf16 v[176:179], v[104:107], v[224:227], v[176:179]
    v_mfma_f32_16x16x32_bf16 v[192:195], v[108:111], v[224:227], v[192:195]
    ds_read_b128 v[224:227], v15 offset:13312
    buffer_load_dwordx4 v[96:99], v5, s[20:23], s59 offen offset:0
    s_waitcnt lgkmcnt(7)
    v_mfma_f32_16x16x32_bf16 v[180:183], v[104:107], v[228:231], v[180:183]
    v_mfma_f32_16x16x32_bf16 v[196:199], v[108:111], v[228:231], v[196:199]
    ds_read_b128 v[228:231], v15 offset:13568
    s_waitcnt lgkmcnt(7)
    v_mfma_f32_16x16x32_bf16 v[184:187], v[104:107], v[232:235], v[184:187]
    v_mfma_f32_16x16x32_bf16 v[200:203], v[108:111], v[232:235], v[200:203]
    ds_read_b128 v[232:235], v15 offset:13824
    buffer_load_dwordx4 v[100:103], v5, s[20:23], s59 offen offset:1024
    s_waitcnt lgkmcnt(7)
    v_mfma_f32_16x16x32_bf16 v[188:191], v[104:107], v[236:239], v[188:191]
    v_mfma_f32_16x16x32_bf16 v[204:207], v[108:111], v[236:239], v[204:207]
    ds_read_b128 v[236:239], v15 offset:14080
    s_waitcnt lgkmcnt(7)
    v_mfma_f32_16x16x32_bf16 v[176:179], v[112:115], v[208:211], v[176:179]
    v_mfma_f32_16x16x32_bf16 v[192:195], v[116:119], v[208:211], v[192:195]
    ds_read_b128 v[208:211], v15 offset:14336
    buffer_load_dwordx4 v[104:107], v5, s[20:23], s59 offen offset:2048
    s_waitcnt lgkmcnt(7)
    v_mfma_f32_16x16x32_bf16 v[180:183], v[112:115], v[212:215], v[180:183]
    v_mfma_f32_16x16x32_bf16 v[196:199], v[116:119], v[212:215], v[196:199]
    ds_read_b128 v[212:215], v15 offset:14592
    s_waitcnt lgkmcnt(7)
    v_mfma_f32_16x16x32_bf16 v[184:187], v[112:115], v[216:219], v[184:187]
    v_mfma_f32_16x16x32_bf16 v[200:203], v[116:119], v[216:219], v[200:203]
    ds_read_b128 v[216:219], v15 offset:14848
    buffer_load_dwordx4 v[108:111], v5, s[20:23], s59 offen offset:3072
    s_add_u32 s59, s59, 4096
    s_waitcnt lgkmcnt(7)
    v_mfma_f32_16x16x32_bf16 v[188:191], v[112:115], v[220:223], v[188:191]
    v_mfma_f32_16x16x32_bf16 v[204:207], v[116:119], v[220:223], v[204:207]
    ds_read_b128 v[220:223], v15 offset:15104
    s_waitcnt lgkmcnt(7)
    v_mfma_f32_16x16x32_bf16 v[176:179], v[120:123], v[224:227], v[176:179]
    v_mfma_f32_16x16x32_bf16 v[192:195], v[124:127], v[224:227], v[192:195]
    ds_read_b128 v[224:227], v15 offset:15360
    buffer_load_dwordx4 v[112:115], v5, s[20:23], s59 offen offset:0
    s_waitcnt lgkmcnt(7)
    v_mfma_f32_16x16x32_bf16 v[180:183], v[120:123], v[228:231], v[180:183]
    v_mfma_f32_16x16x32_bf16 v[196:199], v[124:127], v[228:231], v[196:199]
    ds_read_b128 v[228:231], v15 offset:15616
    s_waitcnt lgkmcnt(7)
    v_mfma_f32_16x16x32_bf16 v[184:187], v[120:123], v[232:235], v[184:187]
    v_mfma_f32_16x16x32_bf16 v[200:203], v[124:127], v[232:235], v[200:203]
    ds_read_b128 v[232:235], v15 offset:15872
    buffer_load_dwordx4 v[116:119], v5, s[20:23], s59 offen offset:1024
    s_waitcnt lgkmcnt(7)
    v_mfma_f32_16x16x32_bf16 v[188:191], v[120:123], v[236:239], v[188:191]
    v_mfma_f32_16x16x32_bf16 v[204:207], v[124:127], v[236:239], v[204:207]
    ds_read_b128 v[236:239], v15 offset:16128
    s_waitcnt lgkmcnt(7)
    v_mfma_f32_16x16x32_bf16 v[176:179], v[128:131], v[208:211], v[176:179]
    v_mfma_f32_16x16x32_bf16 v[192:195], v[132:135], v[208:211], v[192:195]
    ds_read_b128 v[208:211], v15 offset:16384
    buffer_load_dwordx4 v[120:123], v5, s[20:23], s59 offen offset:2048
    s_waitcnt lgkmcnt(7)
    v_mfma_f32_16x16x32_bf16 v[180:183], v[128:131], v[212:215], v[180:183]
    v_mfma_f32_16x16x32_bf16 v[196:199], v[132:135], v[212:215], v[196:199]
    ds_read_b128 v[212:215], v15 offset:16640
    s_waitcnt lgkmcnt(7)
    v_mfma_f32_16x16x32_bf16 v[184:187], v[128:131], v[216:219], v[184:187]
    v_mfma_f32_16x16x32_bf16 v[200:203], v[132:135], v[216:219], v[200:203]
    ds_read_b128 v[216:219], v15 offset:16896
    buffer_load_dwordx4 v[124:127], v5, s[20:23], s59 offen offset:3072
    s_add_u32 s59, s59, 4096
    s_waitcnt lgkmcnt(7)
    v_mfma_f32_16x16x32_bf16 v[188:191], v[128:131], v[220:223], v[188:191]
    v_mfma_f32_16x16x32_bf16 v[204:207], v[132:135], v[220:223], v[204:207]
    ds_read_b128 v[220:223], v15 offset:17152
    s_waitcnt lgkmcnt(7)
    v_mfma_f32_16x16x32_bf16 v[176:179], v[136:139], v[224:227], v[176:179]
    v_mfma_f32_16x16x32_bf16 v[192:195], v[140:143], v[224:227], v[192:195]
    ds_read_b128 v[224:227], v15 offset:17408
    buffer_load_dwordx4 v[128:131], v5, s[20:23], s59 offen offset:0
    s_waitcnt lgkmcnt(7)
    v_mfma_f32_16x16x32_bf16 v[180:183], v[136:139], v[228:231], v[180:183]
    v_mfma_f32_16x16x32_bf16 v[196:199], v[140:143], v[228:231], v[196:199]
    ds_read_b128 v[228:231], v15 offset:17664
    s_waitcnt lgkmcnt(7)
    v_mfma_f32_16x16x32_bf16 v[184:187], v[136:139], v[232:235], v[184:187]
    v_mfma_f32_16x16x32_bf16 v[200:203], v[140:143], v[232:235], v[200:203]
    ds_read_b128 v[232:235], v15 offset:17920
    buffer_load_dwordx4 v[132:135], v5, s[20:23], s59 offen offset:1024
    s_waitcnt lgkmcnt(7)
    v_mfma_f32_16x16x32_bf16 v[188:191], v[136:139], v[236:239], v[188:191]
    buffer_load_dword v4, v6, s[20:23], 0 offen sc1
    v_mfma_f32_16x16x32_bf16 v[204:207], v[140:143], v[236:239], v[204:207]
    ds_read_b128 v[236:239], v15 offset:18176
    s_waitcnt lgkmcnt(7)
    v_mfma_f32_16x16x32_bf16 v[176:179], v[144:147], v[208:211], v[176:179]
    v_mfma_f32_16x16x32_bf16 v[192:195], v[148:151], v[208:211], v[192:195]
    ds_read_b128 v[208:211], v15 offset:18432
    s_waitcnt lgkmcnt(7)
    v_mfma_f32_16x16x32_bf16 v[180:183], v[144:147], v[212:215], v[180:183]
    v_mfma_f32_16x16x32_bf16 v[196:199], v[148:151], v[212:215], v[196:199]
    ds_read_b128 v[212:215], v15 offset:18688
    s_waitcnt lgkmcnt(7)
    v_mfma_f32_16x16x32_bf16 v[184:187], v[144:147], v[216:219], v[184:187]
    v_mfma_f32_16x16x32_bf16 v[200:203], v[148:151], v[216:219], v[200:203]
    ds_read_b128 v[216:219], v15 offset:18944
    s_waitcnt lgkmcnt(7)
    v_mfma_f32_16x16x32_bf16 v[188:191], v[144:147], v[220:223], v[188:191]
    v_mfma_f32_16x16x32_bf16 v[204:207], v[148:151], v[220:223], v[204:207]
    ds_read_b128 v[220:223], v15 offset:19200
    s_waitcnt lgkmcnt(7)
    v_mfma_f32_16x16x32_bf16 v[176:179], v[152:155], v[224:227], v[176:179]
    v_mfma_f32_16x16x32_bf16 v[192:195], v[156:159], v[224:227], v[192:195]
    ds_read_b128 v[224:227], v15 offset:19456
    s_waitcnt lgkmcnt(7)
    v_mfma_f32_16x16x32_bf16 v[180:183], v[152:155], v[228:231], v[180:183]
    v_mfma_f32_16x16x32_bf16 v[196:199], v[156:159], v[228:231], v[196:199]
    ds_read_b128 v[228:231], v15 offset:19712
    s_waitcnt lgkmcnt(7)
    v_mfma_f32_16x16x32_bf16 v[184:187], v[152:155], v[232:235], v[184:187]
    v_mfma_f32_16x16x32_bf16 v[200:203], v[156:159], v[232:235], v[200:203]
    ds_read_b128 v[232:235], v15 offset:19968
    s_waitcnt lgkmcnt(7)
    v_mfma_f32_16x16x32_bf16 v[188:191], v[152:155], v[236:239], v[188:191]
    v_mfma_f32_16x16x32_bf16 v[204:207], v[156:159], v[236:239], v[204:207]
    ds_read_b128 v[236:239], v15 offset:20224
    s_waitcnt lgkmcnt(7)
    v_mfma_f32_16x16x32_bf16 v[176:179], v[160:163], v[208:211], v[176:179]
    v_mfma_f32_16x16x32_bf16 v[192:195], v[164:167], v[208:211], v[192:195]
    s_mov_b32 s27, 65536
    s_waitcnt vmcnt(0)
    s_branch kx_fused_kernel_pollc32
kx_fused_kernel_poll30:
    buffer_load_dword v4, v6, s[20:23], 0 offen sc1
    s_sub_u32 s27, s27, 1
    s_waitcnt vmcnt(0)
    s_cbranch_scc1 kx_fused_kernel_pollx31
kx_fused_kernel_pollc32:
    v_cmp_gt_u32 vcc, 1, v4
    s_cbranch_vccnz kx_fused_kernel_poll30
kx_fused_kernel_pollx31:
    s_waitcnt lgkmcnt(6)
    v_mfma_f32_16x16x32_bf16 v[180:183], v[160:163], v[212:215], v[180:183]
    v_mfma_f32_16x16x32_bf16 v[196:199], v[164:167], v[212:215], v[196:199]
    buffer_load_dwordx4 v[136:139], v5, s[20:23], s68 offen offset:0 sc1
    s_waitcnt lgkmcnt(5)
    v_mfma_f32_16x16x32_bf16 v[184:187], v[160:163], v[216:219], v[184:187]
    v_mfma_f32_16x16x32_bf16 v[200:203], v[164:167], v[216:219], v[200:203]
    buffer_load_dwordx4 v[140:143], v5, s[20:23], s68 offen offset:1024 sc1
    s_waitcnt lgkmcnt(4)
    v_mfma_f32_16x16x32_bf16 v[188:191], v[160:163], v[220:223], v[188:191]
    v_mfma_f32_16x16x32_bf16 v[204:207], v[164:167], v[220:223], v[204:207]
    buffer_load_dwordx4 v[144:147], v5, s[20:23], s68 offen offset:2048 sc1
    s_waitcnt lgkmcnt(3)
    v_mfma_f32_16x16x32_bf16 v[176:179], v[168:171], v[224:227], v[176:179]
    v_mfma_f32_16x16x32_bf16 v[192:195], v[172:175], v[224:227], v[192:195]
    buffer_load_dwordx4 v[148:151], v5, s[20:23], s68 offen offset:3072 sc1
    s_waitcnt lgkmcnt(2)
    v_mfma_f32_16x16x32_bf16 v[180:183], v[168:171], v[228:231], v[180:183]
    v_mfma_f32_16x16x32_bf16 v[196:199], v[172:175], v[228:231], v[196:199]
    s_add_u32 s68, s68, 4096
    buffer_load_dwordx4 v[152:155], v5, s[20:23], s68 offen offset:0 sc1
    s_waitcnt lgkmcnt(1)
    v_mfma_f32_16x16x32_bf16 v[184:187], v[168:171], v[232:235], v[184:187]
    v_mfma_f32_16x16x32_bf16 v[200:203], v[172:175], v[232:235], v[200:203]
    buffer_load_dwordx4 v[156:159], v5, s[20:23], s68 offen offset:1024 sc1
    s_waitcnt lgkmcnt(0)
    v_mfma_f32_16x16x32_bf16 v[188:191], v[168:171], v[236:239], v[188:191]
    v_mfma_f32_16x16x32_bf16 v[204:207], v[172:175], v[236:239], v[204:207]
    s_add_u32 s68, s68, 45056
    buffer_load_dwordx4 v[160:163], v5, s[20:23], s68 offen offset:0 sc1
    s_setprio 3
    ds_read_b96 v[208:210], v12 offset:1024
    ds_read_b96 v[212:214], v12 offset:1280
    ds_read_b96 v[216:218], v12 offset:1536
    ds_read_b96 v[220:222], v12 offset:1792
    s_waitcnt lgkmcnt(3)
    v_fmac_f32 v176, v240, v209
    v_fmac_f32 v177, v241, v209
    v_fmac_f32 v178, v242, v209
    v_fmac_f32 v179, v243, v209
    s_waitcnt lgkmcnt(2)
    v_fmac_f32 v180, v240, v213
    v_fmac_f32 v181, v241, v213
    v_fmac_f32 v182, v242, v213
    v_fmac_f32 v183, v243, v213
    v_mul_f32 v248, v176, v208
    v_mul_f32 v249, v177, v208
    v_mul_f32 v250, v178, v208
    v_mul_f32 v251, v179, v208
    v_mul_f32 v252, v180, v212
    v_mul_f32 v253, v181, v212
    v_mul_f32 v254, v182, v212
    v_mul_f32 v255, v183, v212
    v_exp_f32 v248, v248
    v_fmac_f32 v192, v244, v209
    v_exp_f32 v249, v249
    v_fmac_f32 v193, v245, v209
    v_exp_f32 v250, v250
    v_fmac_f32 v194, v246, v209
    v_exp_f32 v251, v251
    v_fmac_f32 v195, v247, v209
    v_exp_f32 v252, v252
    v_fmac_f32 v196, v244, v213
    v_exp_f32 v253, v253
    v_fmac_f32 v197, v245, v213
    v_exp_f32 v254, v254
    v_fmac_f32 v198, v246, v213
    v_exp_f32 v255, v255
    v_fmac_f32 v199, v247, v213
    v_fma_f32 v248, v248, v210, v210
    v_fma_f32 v249, v249, v210, v210
    v_fma_f32 v250, v250, v210, v210
    v_fma_f32 v251, v251, v210, v210
    v_fma_f32 v252, v252, v214, v214
    v_fma_f32 v253, v253, v214, v214
    v_fma_f32 v254, v254, v214, v214
    v_fma_f32 v255, v255, v214, v214
    v_rcp_f32 v248, v248
    v_mul_f32 v176, v176, v192
    v_rcp_f32 v249, v249
    v_mul_f32 v177, v177, v193
    v_rcp_f32 v250, v250
    v_mul_f32 v178, v178, v194
    v_rcp_f32 v251, v251
    v_mul_f32 v179, v179, v195
    v_rcp_f32 v252, v252
    v_mul_f32 v180, v180, v196
    v_rcp_f32 v253, v253
    v_mul_f32 v181, v181, v197
    v_rcp_f32 v254, v254
    v_mul_f32 v182, v182, v198
    v_rcp_f32 v255, v255
    v_mul_f32 v183, v183, v199
    v_mul_f32 v176, v176, v248
    v_mul_f32 v177, v177, v249
    v_mul_f32 v178, v178, v250
    v_mul_f32 v179, v179, v251
    v_mul_f32 v180, v180, v252
    v_mul_f32 v181, v181, v253
    v_mul_f32 v182, v182, v254
    v_mul_f32 v183, v183, v255
    v_cvt_pk_bf16_f32 v192, v176, v177
    v_cvt_pk_bf16_f32 v194, v180, v181
    v_cvt_pk_bf16_f32 v193, v178, v179
    v_cvt_pk_bf16_f32 v195, v182, v183
    v_permlane32_swap_b32 v192, v194
    s_nop 0
    v_permlane32_swap_b32 v193, v195
    s_cmp_eq_u32 s26, 0
    s_cbranch_scc1 kx_fused_kernel_slow33
    buffer_store_dwordx4 v[192:195], v13, s[20:23], s58 offen
kx_fused_kernel_back34:
    s_add_u32 s58, s58, 98304
    s_waitcnt lgkmcnt(1)
    v_fmac_f32 v184, v240, v217
    v_fmac_f32 v185, v241, v217
    v_fmac_f32 v186, v242, v217
    v_fmac_f32 v187, v243, v217
    s_waitcnt lgkmcnt(0)
    v_fmac_f32 v188, v240, v221
    v_fmac_f32 v189, v241, v221
    v_fmac_f32 v190, v242, v221
    v_fmac_f32 v191, v243, v221
    v_mul_f32 v248, v184, v216
    v_mul_f32 v249, v185, v216
    v_mul_f32 v250, v186, v216
    v_mul_f32 v251, v187, v216
    v_mul_f32 v252, v188, v220
    v_mul_f32 v253, v189, v220
    v_mul_f32 v254, v190, v220
    v_mul_f32 v255, v191, v220
    v_exp_f32 v248, v248
    v_fmac_f32 v200, v244, v217
    v_exp_f32 v249, v249
    v_fmac_f32 v201, v245, v217
    v_exp_f32 v250, v250
    v_fmac_f32 v202, v246, v217
    v_exp_f32 v251, v251
    v_fmac_f32 v203, v247, v217
    v_exp_f32 v252, v252
    v_fmac_f32 v204, v244, v221
    v_exp_f32 v253, v253
    v_fmac_f32 v205, v245, v221
    v_exp_f32 v254, v254
    v_fmac_f32 v206, v246, v221
    v_exp_f32 v255, v255
    v_fmac_f32 v207, v247, v221
    v_fma_f32 v248, v248, v218, v218
    v_fma_f32 v249, v249, v218, v218
    v_fma_f32 v250, v250, v218, v218
    v_fma_f32 v251, v251, v218, v218
    v_fma_f32 v252, v252, v222, v222
    v_fma_f32 v253, v253, v222, v222
    v_fma_f32 v254, v254, v222, v222
    v_fma_f32 v255, v255, v222, v222
    v_rcp_f32 v248, v248
    v_mul_f32 v184, v184, v200
    v_rcp_f32 v249, v249
    v_mul_f32 v185, v185, v201
    v_rcp_f32 v250, v250
    v_mul_f32 v186, v186, v202
    v_rcp_f32 v251, v251
    v_mul_f32 v187, v187, v203
    v_rcp_f32 v252, v252
    v_mul_f32 v188, v188, v204
    v_rcp_f32 v253, v253
    v_mul_f32 v189, v189, v205
    v_rcp_f32 v254, v254
    v_mul_f32 v190, v190, v206
    v_rcp_f32 v255, v255
    v_mul_f32 v191, v191, v207
    v_mul_f32 v184, v184, v248
    v_mul_f32 v185, v185, v249
    v_mul_f32 v186, v186, v250
    v_mul_f32 v187, v187, v251
    v_mul_f32 v188, v188, v252
    v_mul_f32 v189, v189, v253
    v_mul_f32 v190, v190, v254
    v_mul_f32 v191, v191, v255
    v_cvt_pk_bf16_f32 v200, v184, v185
    v_cvt_pk_bf16_f32 v202, v188, v189
    v_cvt_pk_bf16_f32 v201, v186, v187
    v_cvt_pk_bf16_f32 v203, v190, v191
    v_permlane32_swap_b32 v200, v202
    s_nop 0
    v_permlane32_swap_b32 v201, v203
    s_cmp_eq_u32 s26, 0
    s_cbranch_scc1 kx_fused_kernel_slow35
    buffer_store_dwordx4 v[200:203], v13, s[20:23], s58 offen
kx_fused_kernel_back36:
    s_add_u32 s58, s58, 98304
    s_setprio 1
    buffer_load_dwordx4 v[164:167], v5, s[20:23], s68 offen offset:1024 sc1
    buffer_load_dwordx4 v[168:171], v5, s[20:23], s68 offen offset:2048 sc1
    buffer_load_dwordx4 v[172:175], v5, s[20:23], s68 offen offset:3072 sc1
    s_add_u32 s68, s68, 4096
    buffer_load_dwordx4 v[224:227], v5, s[20:23], s68 offen offset:0 sc1
    buffer_load_dwordx4 v[228:231], v5, s[20:23], s68 offen offset:1024 sc1
    s_add_u32 s68, s68, 143360
    buffer_load_dwordx2 v[232:233], v9, s[20:23], s69 offen offset:0 sc1
    buffer_load_dwordx2 v[234:235], v9, s[20:23], s69 offen offset:256 sc1
    s_add_u32 s69, s69, 81920
    buffer_load_dwordx2 v[236:237], v9, s[20:23], s69 offen offset:0 sc1
    buffer_load_dwordx2 v[238:239], v9, s[20:23], s69 offen offset:256 sc1
    v_add_u32 v2, 120832, v7
    v_add_u32 v3, 120832, v8
    s_waitcnt vmcnt(17)
    v_mfma_f32_16x16x32_bf16 v[240:243], v[16:19], v[136:139], 0
    s_waitcnt vmcnt(16)
    v_mfma_f32_16x16x32_bf16 v[240:243], v[20:23], v[140:143], v[240:243]
    s_waitcnt vmcnt(15)
    v_mfma_f32_16x16x32_bf16 v[240:243], v[24:27], v[144:147], v[240:243]
    s_waitcnt vmcnt(14)
    v_mfma_f32_16x16x32_bf16 v[240:243], v[28:31], v[148:151], v[240:243]
    s_waitcnt vmcnt(13)
    v_mfma_f32_16x16x32_bf16 v[240:243], v[32:35], v[152:155], v[240:243]
    s_waitcnt vmcnt(9)
    s_cmp_eq_u32 s26, 0
    s_cbranch_scc1 kx_fused_kernel_slow37
    s_mov_b64 exec, 1
    buffer_store_dword v11, off, s[20:23], s71
    s_mov_b64 exec, -1
kx_fused_kernel_back38:
    v_mfma_f32_16x16x32_bf16 v[240:243], v[36:39], v[156:159], v[240:243]
    v_mfma_f32_16x16x32_bf16 v[244:247], v[40:43], v[136:139], 0
    v_mfma_f32_16x16x32_bf16 v[244:247], v[44:47], v[140:143], v[244:247]
    v_mfma_f32_16x16x32_bf16 v[244:247], v[48:51], v[144:147], v[244:247]
    v_mfma_f32_16x16x32_bf16 v[244:247], v[52:55], v[148:151], v[244:247]
    v_mfma_f32_16x16x32_bf16 v[244:247], v[56:59], v[152:155], v[244:247]
    v_mfma_f32_16x16x32_bf16 v[244:247], v[60:63], v[156:159], v[244:247]
    v_mfma_f32_16x16x32_bf16 v[248:251], v[64:67], v[136:139], 0
    v_mfma_f32_16x16x32_bf16 v[248:251], v[68:71], v[140:143], v[248:251]
    ds_write_b128 v2, v[240:243] offset:0
    v_mfma_f32_16x16x32_bf16 v[248:251], v[72:75], v[144:147], v[248:251]
    v_mfma_f32_16x16x32_bf16 v[248:251], v[76:79], v[148:151], v[248:251]
    v_mfma_f32_16x16x32_bf16 v[248:251], v[80:83], v[152:155], v[248:251]
    v_mfma_f32_16x16x32_bf16 v[248:251], v[84:87], v[156:159], v[248:251]
    v_mfma_f32_16x16x32_bf16 v[252:255], v[88:91], v[136:139], 0
    v_mfma_f32_16x16x32_bf16 v[252:255], v[92:95], v[140:143], v[252:255]
    ds_write_b128 v2, v[244:247] offset:64
    v_mfma_f32_16x16x32_bf16 v[252:255], v[96:99], v[144:147], v[252:255]
    v_mfma_f32_16x16x32_bf16 v[252:255], v[100:103], v[148:151], v[252:255]
    v_mfma_f32_16x16x32_bf16 v[252:255], v[104:107], v[152:155], v[252:255]
    v_mfma_f32_16x16x32_bf16 v[252:255], v[108:111], v[156:159], v[252:255]
    v_mfma_f32_16x16x32_bf16 v[12:15], v[112:115], v[136:139], 0
    v_mfma_f32_16x16x32_bf16 v[12:15], v[116:119], v[140:143], v[12:15]
    ds_write_b128 v2, v[248:251] offset:128
    v_mfma_f32_16x16x32_bf16 v[12:15], v[120:123], v[144:147], v[12:15]
    v_mfma_f32_16x16x32_bf16 v[12:15], v[124:127], v[148:151], v[12:15]
    v_mfma_f32_16x16x32_bf16 v[12:15], v[128:131], v[152:155], v[12:15]
    v_mfma_f32_16x16x32_bf16 v[12:15], v[132:135], v[156:159], v[12:15]
    v_mfma_f32_16x16x32_bf16 v[240:243], v[16:19], v[160:163], 0
    s_waitcnt vmcnt(9)
    v_mfma_f32_16x16x32_bf16 v[240:243], v[20:23], v[164:167], v[240:243]
    ds_write_b128 v2, v[252:255] offset:192
    s_waitcnt vmcnt(8)
    v_mfma_f32_16x16x32_bf16 v[240:243], v[24:27], v[168:171], v[240:243]
    s_waitcnt vmcnt(7)
    v_mfma_f32_16x16x32_bf16 v[240:243], v[28:31], v[172:175], v[240:243]
    s_waitcnt vmcnt(6)
    v_mfma_f32_16x16x32_bf16 v[240:243], v[32:35], v[224:227], v[240:243]
    s_waitcnt vmcnt(5)
    v_mfma_f32_16x16x32_bf16 v[240:243], v[36:39], v[228:231], v[240:243]
    v_mfma_f32_16x16x32_bf16 v[244:247], v[40:43], v[160:163], 0
    v_mfma_f32_16x16x32_bf16 v[244:247], v[44:47], v[164:167], v[244:247]
    ds_write_b128 v2, v[12:15] offset:256
    v_mfma_f32_16x16x32_bf16 v[244:247], v[48:51], v[168:171], v[244:247]
    v_mfma_f32_16x16x32_bf16 v[244:247], v[52:55], v[172:175], v[244:247]
    v_mfma_f32_16x16x32_bf16 v[244:247], v[56:59], v[224:227], v[244:247]
    s_waitcnt lgkmcnt(0)
    s_barrier
    ds_read_b128 v[136:139], v3 offset:0
    ds_read_b128 v[140:143], v3 offset:5376
    ds_read_b128 v[144:147], v3 offset:10752
    v_mfma_f32_16x16x32_bf16 v[244:247], v[60:63], v[228:231], v[244:247]
    ds_read_b128 v[148:151], v3 offset:16128
    ds_read_b128 v[152:155], v3 offset:21504
    ds_read_b128 v[156:159], v3 offset:26880
    v_mfma_f32_16x16x32_bf16 v[248:251], v[64:67], v[160:163], 0
    buffer_load_dword v4, v6, s[20:23], 0 offen sc1
    v_mfma_f32_16x16x32_bf16 v[248:251], v[68:71], v[164:167], v[248:251]
    ds_write_b128 v7, v[240:243] offset:0
    v_mfma_f32_16x16x32_bf16 v[248:251], v[72:75], v[168:171], v[248:251]
    v_mfma_f32_16x16x32_bf16 v[248:251], v[76:79], v[172:175], v[248:251]
    s_waitcnt lgkmcnt(5)
    v_add_f32 v136, v136, v140
    v_add_f32 v137, v137, v141
    v_add_f32 v138, v138, v142
    v_mfma_f32_16x16x32_bf16 v[248:251], v[80:83], v[224:227], v[248:251]
    v_add_f32 v139, v139, v143
    ds_read_b128 v[140:143], v3 offset:32256
    s_waitcnt lgkmcnt(4)
    v_add_f32 v144, v144, v148
    v_mfma_f32_16x16x32_bf16 v[248:251], v[84:87], v[228:231], v[248:251]
    v_add_f32 v145, v145, v149
    v_add_f32 v146, v146, v150
    v_add_f32 v147, v147, v151
    v_mfma_f32_16x16x32_bf16 v[252:255], v[88:91], v[160:163], 0
    ds_read_b128 v[148:151], v3 offset:37632
    s_waitcnt lgkmcnt(3)
    v_add_f32 v152, v152, v156
    v_add_f32 v153, v153, v157
    v_mfma_f32_16x16x32_bf16 v[252:255], v[92:95], v[164:167], v[252:255]
    ds_write_b128 v7, v[244:247] offset:64
    v_add_f32 v154, v154, v158
    v_add_f32 v155, v155, v159
    s_waitcnt vmcnt(5)
    v_lshlrev_b32 v156, 16, v232
    v_mfma_f32_16x16x32_bf16 v[252:255], v[96:99], v[168:171], v[252:255]
    v_and_b32 v157, 0xffff0000, v232
    v_lshlrev_b32 v158, 16, v233
    v_and_b32 v159, 0xffff0000, v233
    s_mov_b32 s27, 65536
    s_waitcnt vmcnt(0)
    s_branch kx_fused_kernel_pollc41
kx_fused_kernel_poll39:
    buffer_load_dword v4, v6, s[20:23], 0 offen sc1
    s_sub_u32 s27, s27, 1
    s_waitcnt vmcnt(0)
    s_cbranch_scc1 kx_fused_kernel_pollx40
kx_fused_kernel_pollc41:
    v_cmp_gt_u32 vcc, 2, v4
    s_cbranch_vccnz kx_fused_kernel_poll39
kx_fused_kernel_pollx40:
    buffer_load_dwordx4 v[176:179], v5, s[20:23], s68 offen offset:0 sc1
    buffer_load_dwordx4 v[180:183], v5, s[20:23], s68 offen offset:1024 sc1
    v_mfma_f32_16x16x32_bf16 v[252:255], v[100:103], v[172:175], v[252:255]
    v_add_f32 v136, v136, v144
    v_add_f32 v137, v137, v145
    v_add_f32 v138, v138, v146
    buffer_load_dwordx4 v[184:187], v5, s[20:23], s68 offen offset:2048 sc1
    buffer_load_dwordx4 v[188:191], v5, s[20:23], s68 offen offset:3072 sc1
    v_mfma_f32_16x16x32_bf16 v[252:255], v[104:107], v[224:227], v[252:255]
    v_add_f32 v139, v139, v147
    v_add_f32 v152, v152, v156
    v_add_f32 v153, v153, v157
    s_add_u32 s68, s68, 4096
    buffer_load_dwordx4 v[192:195], v5, s[20:23], s68 offen offset:0 sc1
    v_mfma_f32_16x16x32_bf16 v[252:255], v[108:111], v[228:231], v[252:255]
    v_add_f32 v154, v154, v158
    v_add_f32 v155, v155, v159
    v_add_f32 v136, v136, v152
    buffer_load_dwordx4 v[196:199], v5, s[20:23], s68 offen offset:1024 sc1
    s_add_u32 s68, s68, 45056
    v_mfma_f32_16x16x32_bf16 v[12:15], v[112:115], v[160:163], 0
    v_add_f32 v137, v137, v153
    v_add_f32 v138, v138, v154
    v_add_f32 v139, v139, v155
    v_mfma_f32_16x16x32_bf16 v[12:15], v[116:119], v[164:167], v[12:15]
    ds_write_b128 v7, v[248:251] offset:128
    s_waitcnt lgkmcnt(2)
    v_add_f32 v140, v140, v148
    v_add_f32 v141, v141, v149
    v_add_f32 v142, v142, v150
    v_mfma_f32_16x16x32_bf16 v[12:15], v[120:123], v[168:171], v[12:15]
    v_add_f32 v143, v143, v151
    v_add_f32 v136, v136, v140
    v_add_f32 v137, v137, v141
    v_mfma_f32_16x16x32_bf16 v[12:15], v[124:127], v[172:175], v[12:15]
    v_add_f32 v138, v138, v142
    v_add_f32 v139, v139, v143
    v_cvt_pk_bf16_f32 v232, v136, v137
    v_mfma_f32_16x16x32_bf16 v[12:15], v[128:131], v[224:227], v[12:15]
    v_cvt_pk_bf16_f32 v233, v138, v139
    v_mfma_f32_16x16x32_bf16 v[12:15], v[132:135], v[228:231], v[12:15]
    buffer_load_dwordx4 v[200:203], v5, s[20:23], s68 offen offset:0 sc1
    buffer_load_dwordx4 v[204:207], v5, s[20:23], s68 offen offset:1024 sc1
    buffer_load_dwordx4 v[208:211], v5, s[20:23], s68 offen offset:2048 sc1
    buffer_load_dwordx4 v[212:215], v5, s[20:23], s68 offen offset:3072 sc1
    s_add_u32 s68, s68, 4096
    buffer_load_dwordx4 v[216:219], v5, s[20:23], s68 offen offset:0 sc1
    buffer_load_dwordx4 v[220:223], v5, s[20:23], s68 offen offset:1024 sc1
    s_add_u32 s68, s68, 143360
    buffer_store_dwordx2 v[232:233], v10, s[64:67], s70 offen sc1
    s_add_u32 s70, s70, 20480
    s_waitcnt vmcnt(12)
    v_mfma_f32_16x16x32_bf16 v[240:243], v[16:19], v[176:179], 0
    s_waitcnt vmcnt(11)
    v_mfma_f32_16x16x32_bf16 v[240:243], v[20:23], v[180:183], v[240:243]
    ds_write_b128 v7, v[252:255] offset:192
    s_waitcnt vmcnt(10)
    v_mfma_f32_16x16x32_bf16 v[240:243], v[24:27], v[184:187], v[240:243]
    s_waitcnt vmcnt(9)
    v_mfma_f32_16x16x32_bf16 v[240:243], v[28:31], v[188:191], v[240:243]
    s_waitcnt vmcnt(8)
    v_mfma_f32_16x16x32_bf16 v[240:243], v[32:35], v[192:195], v[240:243]
    s_waitcnt vmcnt(7)
    v_mfma_f32_16x16x32_bf16 v[240:243], v[36:39], v[196:199], v[240:243]
    v_mfma_f32_16x16x32_bf16 v[244:247], v[40:43], v[176:179], 0
    v_mfma_f32_16x16x32_bf16 v[244:247], v[44:47], v[180:183], v[244:247]
    ds_write_b128 v7, v[12:15] offset:256
    v_mfma_f32_16x16x32_bf16 v[244:247], v[48:51], v[184:187], v[244:247]
    v_mfma_f32_16x16x32_bf16 v[244:247], v[52:55], v[188:191], v[244:247]
    v_mfma_f32_16x16x32_bf16 v[244:247], v[56:59], v[192:195], v[244:247]
    s_waitcnt lgkmcnt(0)
    s_barrier
    ds_read_b128 v[136:139], v8 offset:0
    ds_read_b128 v[140:143], v8 offset:5376
    ds_read_b128 v[144:147], v8 offset:10752
    v_mfma_f32_16x16x32_bf16 v[244:247], v[60:63], v[196:199], v[244:247]
    ds_read_b128 v[148:151], v8 offset:16128
    ds_read_b128 v[152:155], v8 offset:21504
    ds_read_b128 v[156:159], v8 offset:26880
    v_mfma_f32_16x16x32_bf16 v[248:251], v[64:67], v[176:179], 0
    ds_read_b128 v[160:163], v8 offset:32256
    ds_read_b128 v[164:167], v8 offset:37632
    v_mfma_f32_16x16x32_bf16 v[248:251], v[68:71], v[180:183], v[248:251]
    ds_write_b128 v7, v[240:243] offset:43008
    v_mfma_f32_16x16x32_bf16 v[248:251], v[72:75], v[184:187], v[248:251]
    v_mfma_f32_16x16x32_bf16 v[248:251], v[76:79], v[188:191], v[248:251]
    s_waitcnt lgkmcnt(7)
    v_add_f32 v136, v136, v140
    v_add_f32 v137, v137, v141
    v_add_f32 v138, v138, v142
    v_mfma_f32_16x16x32_bf16 v[248:251], v[80:83], v[192:195], v[248:251]
    v_add_f32 v139, v139, v143
    v_lshlrev_b32 v140, 16, v234
    v_and_b32 v141, 0xffff0000, v234
    v_mfma_f32_16x16x32_bf16 v[248:251], v[84:87], v[196:199], v[248:251]
    v_lshlrev_b32 v142, 16, v235
    v_and_b32 v143, 0xffff0000, v235
    v_add_f32 v136, v136, v140
    v_mfma_f32_16x16x32_bf16 v[252:255], v[88:91], v[176:179], 0
    v_add_f32 v137, v137, v141
    v_add_f32 v138, v138, v142
    v_add_f32 v139, v139, v143
    v_mfma_f32_16x16x32_bf16 v[252:255], v[92:95], v[180:183], v[252:255]
    ds_write_b128 v7, v[244:247] offset:43072
    s_waitcnt lgkmcnt(6)
    v_add_f32 v144, v144, v148
    v_add_f32 v145, v145, v149
    v_add_f32 v146, v146, v150
    v_mfma_f32_16x16x32_bf16 v[252:255], v[96:99], v[184:187], v[252:255]
    v_add_f32 v147, v147, v151
    v_add_f32 v136, v136, v144
    v_add_f32 v137, v137, v145
    v_mfma_f32_16x16x32_bf16 v[252:255], v[100:103], v[188:191], v[252:255]
    v_add_f32 v138, v138, v146
    v_add_f32 v139, v139, v147
    s_waitcnt lgkmcnt(4)
    v_add_f32 v152, v152, v156
    v_mfma_f32_16x16x32_bf16 v[252:255], v[104:107], v[192:195], v[252:255]
    v_add_f32 v153, v153, v157
    v_add_f32 v154, v154, v158
    v_add_f32 v155, v155, v159
    v_mfma_f32_16x16x32_bf16 v[252:255], v[108:111], v[196:199], v[252:255]
    v_add_f32 v136, v136, v152
    v_add_f32 v137, v137, v153
    v_add_f32 v138, v138, v154
    v_mfma_f32_16x16x32_bf16 v[12:15], v[112:115], v[176:179], 0
    v_add_f32 v139, v139, v155
    s_waitcnt lgkmcnt(2)
    v_add_f32 v160, v160, v164
    v_add_f32 v161, v161, v165
    v_mfma_f32_16x16x32_bf16 v[12:15], v[116:119], v[180:183], v[12:15]
    ds_write_b128 v7, v[248:251] offset:43136
    v_add_f32 v162, v162, v166
    v_add_f32 v163, v163, v167
    v_add_f32 v136, v136, v160
    v_mfma_f32_16x16x32_bf16 v[12:15], v[120:123], v[184:187], v[12:15]
    v_add_f32 v137, v137, v161
    v_add_f32 v138, v138, v162
    v_add_f32 v139, v139, v163
    v_mfma_f32_16x16x32_bf16 v[12:15], v[124:127], v[188:191], v[12:15]
    v_cvt_pk_bf16_f32 v234, v136, v137
    v_cvt_pk_bf16_f32 v235, v138, v139
    buffer_store_dwordx2 v[234:235], v10, s[64:67], s70 offen sc1
    v_mfma_f32_16x16x32_bf16 v[12:15], v[128:131], v[192:195], v[12:15]
    s_add_u32 s70, s70, 61440
    v_mfma_f32_16x16x32_bf16 v[12:15], v[132:135], v[196:199], v[12:15]
    s_waitcnt vmcnt(7)
    v_mfma_f32_16x16x32_bf16 v[240:243], v[16:19], v[200:203], 0
    s_waitcnt vmcnt(6)
    v_mfma_f32_16x16x32_bf16 v[240:243], v[20:23], v[204:207], v[240:243]
    ds_write_b128 v7, v[252:255] offset:43200
    s_waitcnt vmcnt(5)
    v_mfma_f32_16x16x32_bf16 v[240:243], v[24:27], v[208:211], v[240:243]
    s_waitcnt vmcnt(4)
    v_mfma_f32_16x16x32_bf16 v[240:243], v[28:31], v[212:215], v[240:243]
    s_waitcnt vmcnt(3)
    v_mfma_f32_16x16x32_bf16 v[240:243], v[32:35], v[216:219], v[240:243]
    s_waitcnt vmcnt(2)
    v_mfma_f32_16x16x32_bf16 v[240:243], v[36:39], v[220:223], v[240:243]
    v_mfma_f32_16x16x32_bf16 v[244:247], v[40:43], v[200:203], 0
    v_mfma_f32_16x16x32_bf16 v[244:247], v[44:47], v[204:207], v[244:247]
    ds_write_b128 v7, v[12:15] offset:43264
    v_mfma_f32_16x16x32_bf16 v[244:247], v[48:51], v[208:211], v[244:247]
    v_mfma_f32_16x16x32_bf16 v[244:247], v[52:55], v[212:215], v[244:247]
    v_mfma_f32_16x16x32_bf16 v[244:247], v[56:59], v[216:219], v[244:247]
    s_waitcnt lgkmcnt(0)
    s_barrier
    v_add_u32 v8, 43008, v8
    ds_read_b128 v[136:139], v8 offset:0
    ds_read_b128 v[140:143], v8 offset:5376
    v_mfma_f32_16x16x32_bf16 v[244:247], v[60:63], v[220:223], v[244:247]
    ds_read_b128 v[144:147], v8 offset:10752
    ds_read_b128 v[148:151], v8 offset:16128
    ds_read_b128 v[152:155], v8 offset:21504
    v_mfma_f32_16x16x32_bf16 v[248:251], v[64:67], v[200:203], 0
    ds_read_b128 v[156:159], v8 offset:26880
    ds_read_b128 v[160:163], v8 offset:32256
    ds_read_b128 v[164:167], v8 offset:37632
    v_mfma_f32_16x16x32_bf16 v[248:251], v[68:71], v[204:207], v[248:251]
    ds_write_b128 v2, v[240:243] offset:0
    v_mfma_f32_16x16x32_bf16 v[248:251], v[72:75], v[208:211], v[248:251]
    s_lshr_b32 s15, s2, 3
    s_lshl3_add_u32 s15, s15, s14
    s_cmp_lg_u32 s15, 0
    s_cbranch_scc1 kx_fused_kernel_nwb42
    buffer_wbl2 sc1
kx_fused_kernel_nwb42:
    v_mfma_f32_16x16x32_bf16 v[248:251], v[76:79], v[212:215], v[248:251]
    s_waitcnt lgkmcnt(7)
    v_add_f32 v136, v136, v140
    v_add_f32 v137, v137, v141
    v_add_f32 v138, v138, v142
    v_mfma_f32_16x16x32_bf16 v[248:251], v[80:83], v[216:219], v[248:251]
    v_add_f32 v139, v139, v143
    v_lshlrev_b32 v140, 16, v236
    v_and_b32 v141, 0xffff0000, v236
    v_mfma_f32_16x16x32_bf16 v[248:251], v[84:87], v[220:223], v[248:251]
    v_lshlrev_b32 v142, 16, v237
    v_and_b32 v143, 0xffff0000, v237
    v_add_f32 v136, v136, v140
    v_mfma_f32_16x16x32_bf16 v[252:255], v[88:91], v[200:203], 0
    v_add_f32 v137, v137, v141
    v_add_f32 v138, v138, v142
    v_add_f32 v139, v139, v143
    v_mfma_f32_16x16x32_bf16 v[252:255], v[92:95], v[204:207], v[252:255]
    ds_write_b128 v2, v[244:247] offset:64
    s_waitcnt lgkmcnt(6)
    v_add_f32 v144, v144, v148
    v_add_f32 v145, v145, v149
    v_add_f32 v146, v146, v150
    v_mfma_f32_16x16x32_bf16 v[252:255], v[96:99], v[208:211], v[252:255]
    v_add_f32 v147, v147, v151
    v_add_f32 v136, v136, v144
    v_add_f32 v137, v137, v145
    v_mfma_f32_16x16x32_bf16 v[252:255], v[100:103], v[212:215], v[252:255]
    v_add_f32 v138, v138, v146
    v_add_f32 v139, v139, v147
    s_waitcnt lgkmcnt(4)
    v_add_f32 v152, v152, v156
    v_mfma_f32_16x16x32_bf16 v[252:255], v[104:107], v[216:219], v[252:255]
    v_add_f32 v153, v153, v157
    v_add_f32 v154, v154, v158
    v_add_f32 v155, v155, v159
    v_mfma_f32_16x16x32_bf16 v[252:255], v[108:111], v[220:223], v[252:255]
    v_add_f32 v136, v136, v152
    v_add_f32 v137, v137, v153
    v_add_f32 v138, v138, v154
    v_mfma_f32_16x16x32_bf16 v[12:15], v[112:115], v[200:203], 0
    v_add_f32 v139, v139, v155
    s_waitcnt lgkmcnt(2)
    v_add_f32 v160, v160, v164
    v_add_f32 v161, v161, v165
    v_mfma_f32_16x16x32_bf16 v[12:15], v[116:119], v[204:207], v[12:15]
    ds_write_b128 v2, v[248:251] offset:128
    v_add_f32 v162, v162, v166
    v_add_f32 v163, v163, v167
    v_add_f32 v136, v136, v160
    v_mfma_f32_16x16x32_bf16 v[12:15], v[120:123], v[208:211], v[12:15]
    v_add_f32 v137, v137, v161
    v_add_f32 v138, v138, v162
    v_add_f32 v139, v139, v163
    v_mfma_f32_16x16x32_bf16 v[12:15], v[124:127], v[212:215], v[12:15]
    v_cvt_pk_bf16_f32 v236, v136, v137
    v_cvt_pk_bf16_f32 v237, v138, v139
    buffer_store_dwordx2 v[236:237], v10, s[64:67], s70 offen sc1
    v_mfma_f32_16x16x32_bf16 v[12:15], v[128:131], v[216:219], v[12:15]
    s_add_u32 s70, s70, 20480
    v_mfma_f32_16x16x32_bf16 v[12:15], v[132:135], v[220:223], v[12:15]
    ds_write_b128 v2, v[252:255] offset:192
    s_nop 6
    ds_write_b128 v2, v[12:15] offset:256
    s_waitcnt lgkmcnt(0)
    s_barrier
    ds_read_b128 v[136:139], v3 offset:0
    ds_read_b128 v[140:143], v3 offset:5376
    ds_read_b128 v[144:147], v3 offset:10752
    ds_read_b128 v[148:151], v3 offset:16128
    ds_read_b128 v[152:155], v3 offset:21504
    ds_read_b128 v[156:159], v3 offset:26880
    ds_read_b128 v[160:163], v3 offset:32256
    ds_read_b128 v[164:167], v3 offset:37632
    s_waitcnt lgkmcnt(6)
    v_pk_add_f32 v[136:137], v[136:137], v[140:141]
    v_pk_add_f32 v[138:139], v[138:139], v[142:143]
    v_lshlrev_b32 v140, 16, v238
    v_and_b32 v141, 0xffff0000, v238
    v_lshlrev_b32 v142, 16, v239
    v_and_b32 v143, 0xffff0000, v239
    v_pk_add_f32 v[136:137], v[136:137], v[140:141]
    v_pk_add_f32 v[138:139], v[138:139], v[142:143]
    s_waitcnt lgkmcnt(4)
    v_pk_add_f32 v[144:145], v[144:145], v[148:149]
    v_pk_add_f32 v[146:147], v[146:147], v[150:151]
    v_pk_add_f32 v[136:137], v[136:137], v[144:145]
    v_pk_add_f32 v[138:139], v[138:139], v[146:147]
    s_waitcnt lgkmcnt(2)
    v_pk_add_f32 v[152:153], v[152:153], v[156:157]
    v_pk_add_f32 v[154:155], v[154:155], v[158:159]
    v_pk_add_f32 v[136:137], v[136:137], v[152:153]
    v_pk_add_f32 v[138:139], v[138:139], v[154:155]
    s_waitcnt lgkmcnt(0)
    v_pk_add_f32 v[160:161], v[160:161], v[164:165]
    v_pk_add_f32 v[162:163], v[162:163], v[166:167]
    v_pk_add_f32 v[136:137], v[136:137], v[160:161]
    v_pk_add_f32 v[138:139], v[138:139], v[162:163]
    v_cvt_pk_bf16_f32 v238, v136, v137
    v_cvt_pk_bf16_f32 v239, v138, v139
    buffer_store_dwordx2 v[238:239], v10, s[64:67], s70 offen sc1
kx_fused_kernel_end1:
    s_endpgm
kx_fused_kernel_sp6:
    ds_read_b64_tr_b16 v[60:61], v78 offset:0
    ds_read_b64_tr_b16 v[62:63], v78 offset:512
    ds_read_b64_tr_b16 v[64:65], v79 offset:0
    ds_read_b64_tr_b16 v[66:67], v79 offset:512
    s_waitcnt lgkmcnt(2)
    v_mfma_f32_16x16x32_bf16 v[40:43], v[32:35], v[60:63], v[40:43]
    s_waitcnt lgkmcnt(0)
    v_mfma_f32_16x16x32_bf16 v[40:43], v[36:39], v[64:67], v[40:43]
    s_waitcnt vmcnt(6)
    s_barrier
    ds_read_b64_tr_b16 v[60:61], v76 offset:0
    ds_read_b64_tr_b16 v[62:63], v76 offset:512
    ds_read_b64_tr_b16 v[64:65], v77 offset:0
    ds_read_b64_tr_b16 v[66:67], v77 offset:512
    s_waitcnt lgkmcnt(2)
    v_mfma_f32_16x16x32_bf16 v[40:43], v[32:35], v[60:63], v[40:43]
    s_waitcnt lgkmcnt(0)
    v_mfma_f32_16x16x32_bf16 v[40:43], v[36:39], v[64:67], v[40:43]
    s_waitcnt vmcnt(0)
    s_barrier
    ds_read_b64_tr_b16 v[60:61], v76 offset:24576
    ds_read_b64_tr_b16 v[62:63], v76 offset:25088
    ds_read_b64_tr_b16 v[64:65], v77 offset:24576
    ds_read_b64_tr_b16 v[66:67], v77 offset:25088
    s_waitcnt lgkmcnt(2)
    v_mfma_f32_16x16x32_bf16 v[40:43], v[32:35], v[60:63], v[40:43]
    s_waitcnt lgkmcnt(0)
    v_mfma_f32_16x16x32_bf16 v[40:43], v[36:39], v[64:67], v[40:43]
    s_nop 7
    v_cvt_pk_bf16_f32 v42, v40, v40
    v_and_b32 v41, 0xffff0000, v42
    v_sub_f32 v40, v40, v41
    v_cvt_pk_bf16_f32 v43, v40, v40
    ds_write_b64 v80, v[42:43] offset:0
    s_waitcnt lgkmcnt(0)
    s_barrier
    s_barrier
    s_barrier
    s_branch kx_fused_kernel_hset4
kx_fused_kernel_comp2:
    s_setprio 2
    s_and_b32 s15, s24, 1
    s_lshl1_add_u32 s44, s28, s15
    s_lshl3_add_u32 s45, s13, s14
    v_mov_b32 v254, 0x3f803f80
    s_sub_u32 s58, s14, 4
    s_waitcnt lgkmcnt(0)
    s_mov_b32 s20, s6
    s_mov_b32 s21, s7
    v_lshrrev_b32 v5, 5, v1
    v_and_b32 v6, 31, v1
    v_lshl_add_u32 v2, s58, 5, v6
    v_bfe_u32 v3, v2, 1, 3
    v_xor_b32 v3, v3, v5
    v_lshlrev_b32 v3, 4, v3
    v_lshl_add_u32 v248, v2, 7, v3
    v_mul_u32_u24 v3, 2112, v5
    v_lshl_add_u32 v3, v2, 4, v3
    v_add_u32 v252, 93216, v3
    v_lshlrev_b32 v3, 4, v6
    v_lshl_add_u32 v240, v5, 15, v3
    v_lshlrev_b32 v241, 4, v1
    v_lshlrev_b32 v214, 2, v6
    v_xor_b32 v249, 32, v248
    v_xor_b32 v250, 64, v248
    v_xor_b32 v251, 96, v248
    v_add_u32 v192, 49152, v248
    v_add_u32 v193, 49152, v249
    v_add_u32 v194, 49152, v250
    v_add_u32 v195, 49152, v251
    v_bfe_u32 v2, v1, 2, 2
    v_bfe_u32 v3, v1, 4, 1
    v_and_b32 v4, 1, v1
    v_lshl_add_u32 v3, v3, 1, v4
    v_lshlrev_b32 v4, 1, v2
    v_and_b32 v4, 4, v4
    v_add_u32 v3, v3, v4
    v_lshlrev_b32 v3, 4, v3
    v_lshl_add_u32 v2, v5, 3, v2
    v_lshl_add_u32 v3, v2, 7, v3
    v_bfe_u32 v2, v1, 1, 1
    v_lshl_add_u32 v3, v2, 3, v3
    v_add_u32 v8, 16384, v3
    v_xor_b32 v9, 64, v8
    v_add_u32 v10, 73728, v8
    v_add_u32 v11, 73728, v9
    s_cmp_lt_u32 s13, 5
    s_cselect_b32 s43, 0x3ea52b5c, 1.0
    s_lshl_b32 s15, s58, 9
    s_add_u32 s15, s15, 93216
    v_lshrrev_b32 v3, 4, v1
    v_bfe_u32 v4, v1, 2, 2
    v_and_b32 v5, 1, v1
    v_lshl_add_u32 v6, v3, 1, v2
    v_mul_u32_u24 v6, 2112, v6
    v_lshl_add_u32 v6, v4, 4, v6
    v_lshl_add_u32 v6, v5, 3, v6
    v_add_u32 v242, s15, v6
    v_lshrrev_b32 v2, 1, v1
    v_mul_u32_u24 v6, 20, v2
    v_mad_u32_u24 v6, v5, 19, v6
    v_lshrrev_b32 v6, 6, v6
    v_lshlrev_b32 v7, 11, v2
    v_lshl_add_u32 v7, v5, 2, v7
    v_mov_b32 v4, 1073741824
    v_mov_b32 v12, 0
    v_mov_b32 v13, 0
    v_mov_b32 v14, 0
    v_mov_b32 v15, 0
    v_and_b32 v2, 31, v1
    v_lshrrev_b32 v3, 1, v2
    v_xor_b32 v3, v3, v2
    v_and_b32 v3, 4, v3
    v_mul_u32_u24 v3, 3, v3
    v_xor_b32 v2, v3, v2
    v_lshrrev_b32 v3, 5, v1
    v_lshlrev_b32 v3, 4, v3
    v_lshl_add_u32 v2, v2, 5, v3
    v_add_u32 v255, 159744, v2
    s_and_b32 s54, s24, 1
    s_lshr_b32 s55, s24, 1
    s_mul_i32 s55, s55, 5
    s_lshr_b32 s55, s55, 1
    s_add_u32 s55, s55, s13
    s_mul_i32 s15, s54, 5
    s_add_u32 s52, s15, s13
    s_lshl1_add_u32 s15, s15, s55
    s_add_u32 s15, s15, 5
    s_cmp_lt_u32 s13, 5
    s_cselect_b32 s52, s52, s15
    s_add_u32 s15, s55, 3
    s_sub_u32 s53, s15, 10
    s_min_u32 s15, s15, s53
    s_mul_i32 s53, s54, 10
    s_add_u32 s53, s53, s15
    s_add_u32 s53, s53, 10
    s_lshl_b32 s56, s52, 18
    s_lshl2_add_u32 s15, s28, s58
    s_lshl_b32 s16, s15, 9
    s_add_u32 s56, s56, s16
    s_mul_i32 s15, s15, 41472
    s_lshl_b32 s16, s52, 10
    s_add_u32 s15, s15, s16
    s_add_u32 s15, s15, 5222400
    s_cmp_ge_u32 s52, 20
    s_cselect_b32 s56, s15, s56
    s_cselect_b32 s54, 1, 0
    s_and_b32 s15, s58, 2
    s_add_u32 s15, s15, s54
    s_lshl4_add_u32 s15, s15, s28
    s_lshr_b32 s16, s58, 1
    s_lshl1_add_u32 s16, s28, s16
    s_add_u32 s16, s16, 64
    s_cmp_lt_u32 s52, 10
    s_cselect_b32 s15, s16, s15
    s_and_b32 s16, s58, 1
    s_lshl1_add_u32 s15, s15, s16
    s_lshl3_add_u32 s27, s15, 42532864
    s_sub_u32 s15, s52, 10
    s_min_u32 s15, s15, s52
    s_sub_u32 s16, s15, 10
    s_min_u32 s15, s15, s16
    v_cmp_eq_u32 vcc, s15, v6
    s_nop 1
    v_cndmask_b32 v253, v4, v7, vcc
    v_add_u32 v253, s27, v253
    s_lshl_b32 s57, s53, 18
    s_lshl2_add_u32 s15, s28, s58
    s_lshl_b32 s16, s15, 9
    s_add_u32 s57, s57, s16
    s_mul_i32 s15, s15, 41472
    s_lshl_b32 s16, s53, 10
    s_add_u32 s15, s15, s16
    s_add_u32 s15, s15, 5222400
    s_cmp_ge_u32 s53, 20
    s_cselect_b32 s57, s15, s57
    s_cselect_b32 s55, 1, 0
    s_and_b32 s15, s58, 2
    s_add_u32 s15, s15, s55
    s_lshl4_add_u32 s15, s15, s28
    s_lshr_b32 s16, s58, 1
    s_lshl1_add_u32 s16, s28, s16
    s_add_u32 s16, s16, 64
    s_cmp_lt_u32 s53, 10
    s_cselect_b32 s15, s16, s15
    s_and_b32 s16, s58, 1
    s_lshl1_add_u32 s15, s15, s16
    s_lshl3_add_u32 s27, s15, 42532864
    s_sub_u32 s15, s53, 10
    s_min_u32 s15, s15, s53
    s_sub_u32 s16, s15, 10
    s_min_u32 s15, s15, s16
    v_cmp_eq_u32 vcc, s15, v6
    s_nop 1
    v_cndmask_b32 v243, v4, v7, vcc
    v_add_u32 v243, s27, v243
    s_mov_b32 s48, s4
    s_mov_b32 s49, s5
    s_mov_b32 s50, 256
    s_mov_b32 s51, 0x20000
    s_cmp_lg_u32 s45, 60
    s_cbranch_scc1 kx_fused_kernel_nz43
    v_mov_b32 v16, 0
    v_mov_b32 v17, 0
    v_mov_b32 v18, 0
    v_mov_b32 v19, 0
    v_lshlrev_b32 v2, 7, v1
    v_lshlrev_b32 v3, 4, v1
    s_lshl_b32 s15, s44, 11
    s_add_u32 s15, s15, 42532864
    buffer_store_dwordx4 v[16:19], v3, s[20:23], s15 offen sc1
    buffer_store_dwordx4 v[16:19], v3, s[20:23], s15 offen offset:1024 sc1
    s_mul_i32 s15, s44, 17408
    s_add_u32 s15, s15, 41943040
    buffer_store_dword v16, v2, s[20:23], s15 offen sc1
    s_add_u32 s15, s15, 8192
    buffer_store_dword v16, v2, s[20:23], s15 offen sc1
    s_add_u32 s15, s15, 8192
    v_mul_u32_u24 v3, 10368, v1
    v_mov_b32 v20, v254
    v_mov_b32 v21, v254
    v_mov_b32 v22, v254
    v_mov_b32 v23, v254
    s_mul_i32 s16, s44, 82944
    s_add_u32 s16, s16, 5253120
    s_mov_b64 exec, 0xff
    buffer_store_dword v16, v2, s[20:23], s15 offen sc1
    buffer_store_dwordx4 v[20:23], v3, s[20:23], s16 offen sc1
    s_mov_b64 exec, -1
kx_fused_kernel_nz43:
    s_barrier
    ds_read_b64_tr_b16 v[216:217], v8 offset:0
    ds_read_b64_tr_b16 v[218:219], v8 offset:512
    ds_read_b128 v[196:199], v248 offset:0
    ds_read_b64_tr_b16 v[220:221], v9 offset:0
    ds_read_b64_tr_b16 v[222:223], v9 offset:512
    s_waitcnt lgkmcnt(2)
    v_mfma_f32_32x32x16_bf16 v[124:139], v[216:219], v[196:199], 0
    ds_read_b64_tr_b16 v[224:225], v8 offset:2048
    ds_read_b64_tr_b16 v[226:227], v8 offset:2560
    ds_read_b128 v[200:203], v249 offset:0
    s_waitcnt lgkmcnt(3)
    v_mfma_f32_32x32x16_bf16 v[140:155], v[220:223], v[196:199], 0
    ds_read_b64_tr_b16 v[228:229], v9 offset:2048
    ds_read_b64_tr_b16 v[230:231], v9 offset:2560
    s_waitcnt lgkmcnt(2)
    v_mfma_f32_32x32x16_bf16 v[124:139], v[224:227], v[200:203], v[124:139]
    ds_read_b64_tr_b16 v[216:217], v8 offset:4096
    ds_read_b64_tr_b16 v[218:219], v8 offset:4608
    ds_read_b128 v[204:207], v250 offset:0
    s_waitcnt lgkmcnt(3)
    v_mfma_f32_32x32x16_bf16 v[140:155], v[228:231], v[200:203], v[140:155]
    ds_read_b64_tr_b16 v[220:221], v9 offset:4096
    ds_read_b64_tr_b16 v[222:223], v9 offset:4608
    s_waitcnt lgkmcnt(2)
    v_mfma_f32_32x32x16_bf16 v[124:139], v[216:219], v[204:207], v[124:139]
    ds_read_b64_tr_b16 v[224:225], v8 offset:6144
    ds_read_b64_tr_b16 v[226:227], v8 offset:6656
    ds_read_b128 v[208:211], v251 offset:0
    s_waitcnt lgkmcnt(3)
    v_mfma_f32_32x32x16_bf16 v[140:155], v[220:223], v[204:207], v[140:155]
    ds_read_b64_tr_b16 v[228:229], v9 offset:6144
    ds_read_b64_tr_b16 v[230:231], v9 offset:6656
    s_waitcnt lgkmcnt(2)
    v_mfma_f32_32x32x16_bf16 v[124:139], v[224:227], v[208:211], v[124:139]
    s_waitcnt lgkmcnt(0)
    v_mfma_f32_32x32x16_bf16 v[140:155], v[228:231], v[208:211], v[140:155]
    s_barrier
    ds_read_b64_tr_b16 v[216:217], v8 offset:24576
    ds_read_b64_tr_b16 v[218:219], v8 offset:25088
    ds_read_b128 v[156:159], v248 offset:24576
    ds_read_b64_tr_b16 v[220:221], v9 offset:24576
    ds_read_b64_tr_b16 v[222:223], v9 offset:25088
    v_dot2c_f32_bf16 v12, v196, v254
    v_dot2c_f32_bf16 v14, v196, v196
    v_dot2c_f32_bf16 v13, v197, v254
    v_dot2c_f32_bf16 v15, v197, v197
    v_dot2c_f32_bf16 v12, v198, v254
    v_dot2c_f32_bf16 v14, v198, v198
    v_dot2c_f32_bf16 v13, v199, v254
    v_dot2c_f32_bf16 v15, v199, v199
    v_dot2c_f32_bf16 v12, v200, v254
    v_dot2c_f32_bf16 v14, v200, v200
    v_dot2c_f32_bf16 v13, v201, v254
    v_dot2c_f32_bf16 v15, v201, v201
    v_dot2c_f32_bf16 v12, v202, v254
    v_dot2c_f32_bf16 v14, v202, v202
    v_dot2c_f32_bf16 v13, v203, v254
    v_dot2c_f32_bf16 v15, v203, v203
    v_dot2c_f32_bf16 v12, v204, v254
    v_dot2c_f32_bf16 v14, v204, v204
    v_dot2c_f32_bf16 v13, v205, v254
    v_dot2c_f32_bf16 v15, v205, v205
    v_dot2c_f32_bf16 v12, v206, v254
    v_dot2c_f32_bf16 v14, v206, v206
    v_dot2c_f32_bf16 v13, v207, v254
    v_dot2c_f32_bf16 v15, v207, v207
    v_dot2c_f32_bf16 v12, v208, v254
    v_dot2c_f32_bf16 v14, v208, v208
    v_dot2c_f32_bf16 v13, v209, v254
    v_dot2c_f32_bf16 v15, v209, v209
    v_dot2c_f32_bf16 v12, v210, v254
    v_dot2c_f32_bf16 v14, v210, v210
    v_dot2c_f32_bf16 v13, v211, v254
    v_dot2c_f32_bf16 v15, v211, v211
    s_waitcnt lgkmcnt(2)
    v_mfma_f32_32x32x16_bf16 v[124:139], v[216:219], v[156:159], v[124:139]
    ds_read_b64_tr_b16 v[224:225], v8 offset:26624
    ds_read_b64_tr_b16 v[226:227], v8 offset:27136
    ds_read_b128 v[160:163], v249 offset:24576
    s_waitcnt lgkmcnt(3)
    v_mfma_f32_32x32x16_bf16 v[140:155], v[220:223], v[156:159], v[140:155]
    ds_read_b64_tr_b16 v[228:229], v9 offset:26624
    ds_read_b64_tr_b16 v[230:231], v9 offset:27136
    s_waitcnt lgkmcnt(2)
    v_mfma_f32_32x32x16_bf16 v[124:139], v[224:227], v[160:163], v[124:139]
    ds_read_b64_tr_b16 v[216:217], v8 offset:28672
    ds_read_b64_tr_b16 v[218:219], v8 offset:29184
    ds_read_b128 v[164:167], v250 offset:24576
    s_waitcnt lgkmcnt(3)
    v_mfma_f32_32x32x16_bf16 v[140:155], v[228:231], v[160:163], v[140:155]
    ds_read_b64_tr_b16 v[220:221], v9 offset:28672
    ds_read_b64_tr_b16 v[222:223], v9 offset:29184
    s_waitcnt lgkmcnt(2)
    v_mfma_f32_32x32x16_bf16 v[124:139], v[216:219], v[164:167], v[124:139]
    ds_read_b64_tr_b16 v[224:225], v8 offset:30720
    ds_read_b64_tr_b16 v[226:227], v8 offset:31232
    ds_read_b128 v[168:171], v251 offset:24576
    s_waitcnt lgkmcnt(3)
    v_mfma_f32_32x32x16_bf16 v[140:155], v[220:223], v[164:167], v[140:155]
    ds_read_b64_tr_b16 v[228:229], v9 offset:30720
    ds_read_b64_tr_b16 v[230:231], v9 offset:31232
    s_waitcnt lgkmcnt(2)
    v_mfma_f32_32x32x16_bf16 v[124:139], v[224:227], v[168:171], v[124:139]
    s_waitcnt lgkmcnt(0)
    v_mfma_f32_32x32x16_bf16 v[140:155], v[228:231], v[168:171], v[140:155]
    s_cmp_lg_u32 s45, 60
    s_cbranch_scc1 kx_fused_kernel_nz44
    s_lshl_b32 s15, s44, 2
    s_mov_b64 exec, 1
    s_waitcnt vmcnt(0)
    buffer_store_dword v254, off, s[48:51], s15 sc1
    s_mov_b64 exec, -1
kx_fused_kernel_nz44:
    s_barrier
    ds_read_b64_tr_b16 v[216:217], v8 offset:49152
    ds_read_b64_tr_b16 v[218:219], v8 offset:49664
    ds_read_b128 v[172:175], v192 offset:0
    ds_read_b64_tr_b16 v[220:221], v9 offset:49152
    ds_read_b64_tr_b16 v[222:223], v9 offset:49664
    v_dot2c_f32_bf16 v12, v156, v254
    v_dot2c_f32_bf16 v14, v156, v156
    v_dot2c_f32_bf16 v13, v157, v254
    v_dot2c_f32_bf16 v15, v157, v157
    v_dot2c_f32_bf16 v12, v158, v254
    v_dot2c_f32_bf16 v14, v158, v158
    v_dot2c_f32_bf16 v13, v159, v254
    v_dot2c_f32_bf16 v15, v159, v159
    v_dot2c_f32_bf16 v12, v160, v254
    v_dot2c_f32_bf16 v14, v160, v160
    v_dot2c_f32_bf16 v13, v161, v254
    v_dot2c_f32_bf16 v15, v161, v161
    v_dot2c_f32_bf16 v12, v162, v254
    v_dot2c_f32_bf16 v14, v162, v162
    v_dot2c_f32_bf16 v13, v163, v254
    v_dot2c_f32_bf16 v15, v163, v163
    v_dot2c_f32_bf16 v12, v164, v254
    v_dot2c_f32_bf16 v14, v164, v164
    v_dot2c_f32_bf16 v13, v165, v254
    v_dot2c_f32_bf16 v15, v165, v165
    v_dot2c_f32_bf16 v12, v166, v254
    v_dot2c_f32_bf16 v14, v166, v166
    v_dot2c_f32_bf16 v13, v167, v254
    v_dot2c_f32_bf16 v15, v167, v167
    v_dot2c_f32_bf16 v12, v168, v254
    v_dot2c_f32_bf16 v14, v168, v168
    v_dot2c_f32_bf16 v13, v169, v254
    v_dot2c_f32_bf16 v15, v169, v169
    v_dot2c_f32_bf16 v12, v170, v254
    v_dot2c_f32_bf16 v14, v170, v170
    v_dot2c_f32_bf16 v13, v171, v254
    v_dot2c_f32_bf16 v15, v171, v171
    s_waitcnt lgkmcnt(2)
    v_mfma_f32_32x32x16_bf16 v[124:139], v[216:219], v[172:175], v[124:139]
    ds_read_b64_tr_b16 v[224:225], v8 offset:51200
    ds_read_b64_tr_b16 v[226:227], v8 offset:51712
    ds_read_b128 v[176:179], v193 offset:0
    s_waitcnt lgkmcnt(3)
    v_mfma_f32_32x32x16_bf16 v[140:155], v[220:223], v[172:175], v[140:155]
    ds_read_b64_tr_b16 v[228:229], v9 offset:51200
    ds_read_b64_tr_b16 v[230:231], v9 offset:51712
    s_waitcnt lgkmcnt(2)
    v_mfma_f32_32x32x16_bf16 v[124:139], v[224:227], v[176:179], v[124:139]
    ds_read_b64_tr_b16 v[216:217], v8 offset:53248
    ds_read_b64_tr_b16 v[218:219], v8 offset:53760
    ds_read_b128 v[180:183], v194 offset:0
    s_waitcnt lgkmcnt(3)
    v_mfma_f32_32x32x16_bf16 v[140:155], v[228:231], v[176:179], v[140:155]
    ds_read_b64_tr_b16 v[220:221], v9 offset:53248
    ds_read_b64_tr_b16 v[222:223], v9 offset:53760
    s_waitcnt lgkmcnt(2)
    v_mfma_f32_32x32x16_bf16 v[124:139], v[216:219], v[180:183], v[124:139]
    ds_read_b64_tr_b16 v[224:225], v8 offset:55296
    ds_read_b64_tr_b16 v[226:227], v8 offset:55808
    ds_read_b128 v[184:187], v195 offset:0
    s_waitcnt lgkmcnt(3)
    v_mfma_f32_32x32x16_bf16 v[140:155], v[220:223], v[180:183], v[140:155]
    ds_read_b64_tr_b16 v[228:229], v9 offset:55296
    ds_read_b64_tr_b16 v[230:231], v9 offset:55808
    s_waitcnt lgkmcnt(2)
    v_mfma_f32_32x32x16_bf16 v[124:139], v[224:227], v[184:187], v[124:139]
    s_waitcnt lgkmcnt(0)
    v_mfma_f32_32x32x16_bf16 v[140:155], v[228:231], v[184:187], v[140:155]
    s_barrier
    ds_read_b64_tr_b16 v[216:217], v10 offset:0
    ds_read_b64_tr_b16 v[218:219], v10 offset:512
    ds_read_b128 v[24:27], v192 offset:24576
    ds_read_b64_tr_b16 v[220:221], v11 offset:0
    ds_read_b64_tr_b16 v[222:223], v11 offset:512
    v_dot2c_f32_bf16 v12, v172, v254
    v_dot2c_f32_bf16 v14, v172, v172
    v_dot2c_f32_bf16 v13, v173, v254
    v_dot2c_f32_bf16 v15, v173, v173
    v_dot2c_f32_bf16 v12, v174, v254
    v_dot2c_f32_bf16 v14, v174, v174
    v_dot2c_f32_bf16 v13, v175, v254
    v_dot2c_f32_bf16 v15, v175, v175
    v_dot2c_f32_bf16 v12, v176, v254
    v_dot2c_f32_bf16 v14, v176, v176
    v_dot2c_f32_bf16 v13, v177, v254
    v_dot2c_f32_bf16 v15, v177, v177
    v_dot2c_f32_bf16 v12, v178, v254
    v_dot2c_f32_bf16 v14, v178, v178
    v_dot2c_f32_bf16 v13, v179, v254
    v_dot2c_f32_bf16 v15, v179, v179
    v_dot2c_f32_bf16 v12, v180, v254
    v_dot2c_f32_bf16 v14, v180, v180
    v_dot2c_f32_bf16 v13, v181, v254
    v_dot2c_f32_bf16 v15, v181, v181
    v_dot2c_f32_bf16 v12, v182, v254
    v_dot2c_f32_bf16 v14, v182, v182
    v_dot2c_f32_bf16 v13, v183, v254
    v_dot2c_f32_bf16 v15, v183, v183
    v_dot2c_f32_bf16 v12, v184, v254
    v_dot2c_f32_bf16 v14, v184, v184
    v_dot2c_f32_bf16 v13, v185, v254
    v_dot2c_f32_bf16 v15, v185, v185
    v_dot2c_f32_bf16 v12, v186, v254
    v_dot2c_f32_bf16 v14, v186, v186
    v_dot2c_f32_bf16 v13, v187, v254
    v_dot2c_f32_bf16 v15, v187, v187
    s_waitcnt lgkmcnt(2)
    v_mfma_f32_32x32x16_bf16 v[124:139], v[216:219], v[24:27], v[124:139]
    ds_read_b64_tr_b16 v[224:225], v10 offset:2048
    ds_read_b64_tr_b16 v[226:227], v10 offset:2560
    ds_read_b128 v[28:31], v193 offset:24576
    s_waitcnt lgkmcnt(3)
    v_mfma_f32_32x32x16_bf16 v[140:155], v[220:223], v[24:27], v[140:155]
    ds_read_b64_tr_b16 v[228:229], v11 offset:2048
    ds_read_b64_tr_b16 v[230:231], v11 offset:2560
    s_waitcnt lgkmcnt(2)
    v_mfma_f32_32x32x16_bf16 v[124:139], v[224:227], v[28:31], v[124:139]
    ds_read_b64_tr_b16 v[216:217], v10 offset:4096
    ds_read_b64_tr_b16 v[218:219], v10 offset:4608
    ds_read_b128 v[32:35], v194 offset:24576
    s_waitcnt lgkmcnt(3)
    v_mfma_f32_32x32x16_bf16 v[140:155], v[228:231], v[28:31], v[140:155]
    ds_read_b64_tr_b16 v[220:221], v11 offset:4096
    ds_read_b64_tr_b16 v[222:223], v11 offset:4608
    s_waitcnt lgkmcnt(2)
    v_mfma_f32_32x32x16_bf16 v[124:139], v[216:219], v[32:35], v[124:139]
    ds_read_b64_tr_b16 v[224:225], v10 offset:6144
    ds_read_b64_tr_b16 v[226:227], v10 offset:6656
    ds_read_b128 v[36:39], v195 offset:24576
    s_waitcnt lgkmcnt(3)
    v_mfma_f32_32x32x16_bf16 v[140:155], v[220:223], v[32:35], v[140:155]
    ds_read_b64_tr_b16 v[228:229], v11 offset:6144
    ds_read_b64_tr_b16 v[230:231], v11 offset:6656
    s_waitcnt lgkmcnt(2)
    v_mfma_f32_32x32x16_bf16 v[124:139], v[224:227], v[36:39], v[124:139]
    s_waitcnt lgkmcnt(0)
    v_mfma_f32_32x32x16_bf16 v[140:155], v[228:231], v[36:39], v[140:155]
    s_barrier
    ds_read_b64_tr_b16 v[216:217], v8 offset:0
    ds_read_b64_tr_b16 v[218:219], v8 offset:512
    ds_read_b128 v[40:43], v248 offset:0
    ds_read_b64_tr_b16 v[220:221], v9 offset:0
    ds_read_b64_tr_b16 v[222:223], v9 offset:512
    v_dot2c_f32_bf16 v12, v24, v254
    v_dot2c_f32_bf16 v14, v24, v24
    v_dot2c_f32_bf16 v13, v25, v254
    v_dot2c_f32_bf16 v15, v25, v25
    v_dot2c_f32_bf16 v12, v26, v254
    v_dot2c_f32_bf16 v14, v26, v26
    v_dot2c_f32_bf16 v13, v27, v254
    v_dot2c_f32_bf16 v15, v27, v27
    v_dot2c_f32_bf16 v12, v28, v254
    v_dot2c_f32_bf16 v14, v28, v28
    v_dot2c_f32_bf16 v13, v29, v254
    v_dot2c_f32_bf16 v15, v29, v29
    v_dot2c_f32_bf16 v12, v30, v254
    v_dot2c_f32_bf16 v14, v30, v30
    v_dot2c_f32_bf16 v13, v31, v254
    v_dot2c_f32_bf16 v15, v31, v31
    v_dot2c_f32_bf16 v12, v32, v254
    v_dot2c_f32_bf16 v14, v32, v32
    v_dot2c_f32_bf16 v13, v33, v254
    v_dot2c_f32_bf16 v15, v33, v33
    v_dot2c_f32_bf16 v12, v34, v254
    v_dot2c_f32_bf16 v14, v34, v34
    v_dot2c_f32_bf16 v13, v35, v254
    v_dot2c_f32_bf16 v15, v35, v35
    v_dot2c_f32_bf16 v12, v36, v254
    v_dot2c_f32_bf16 v14, v36, v36
    v_dot2c_f32_bf16 v13, v37, v254
    v_dot2c_f32_bf16 v15, v37, v37
    v_dot2c_f32_bf16 v12, v38, v254
    v_dot2c_f32_bf16 v14, v38, v38
    v_dot2c_f32_bf16 v13, v39, v254
    v_dot2c_f32_bf16 v15, v39, v39
    s_waitcnt lgkmcnt(2)
    v_mfma_f32_32x32x16_bf16 v[124:139], v[216:219], v[40:43], v[124:139]
    ds_read_b64_tr_b16 v[224:225], v8 offset:2048
    ds_read_b64_tr_b16 v[226:227], v8 offset:2560
    ds_read_b128 v[68:71], v249 offset:0
    s_waitcnt lgkmcnt(3)
    v_mfma_f32_32x32x16_bf16 v[140:155], v[220:223], v[40:43], v[140:155]
    ds_read_b64_tr_b16 v[228:229], v9 offset:2048
    ds_read_b64_tr_b16 v[230:231], v9 offset:2560
    s_waitcnt lgkmcnt(2)
    v_mfma_f32_32x32x16_bf16 v[124:139], v[224:227], v[68:71], v[124:139]
    ds_read_b64_tr_b16 v[216:217], v8 offset:4096
    ds_read_b64_tr_b16 v[218:219], v8 offset:4608
    ds_read_b128 v[72:75], v250 offset:0
    s_waitcnt lgkmcnt(3)
    v_mfma_f32_32x32x16_bf16 v[140:155], v[228:231], v[68:71], v[140:155]
    ds_read_b64_tr_b16 v[220:221], v9 offset:4096
    ds_read_b64_tr_b16 v[222:223], v9 offset:4608
    s_waitcnt lgkmcnt(2)
    v_mfma_f32_32x32x16_bf16 v[124:139], v[216:219], v[72:75], v[124:139]
    ds_read_b64_tr_b16 v[224:225], v8 offset:6144
    ds_read_b64_tr_b16 v[226:227], v8 offset:6656
    ds_read_b128 v[116:119], v251 offset:0
    s_waitcnt lgkmcnt(3)
    v_mfma_f32_32x32x16_bf16 v[140:155], v[220:223], v[72:75], v[140:155]
    ds_read_b64_tr_b16 v[228:229], v9 offset:6144
    ds_read_b64_tr_b16 v[230:231], v9 offset:6656
    s_waitcnt lgkmcnt(2)
    v_mfma_f32_32x32x16_bf16 v[124:139], v[224:227], v[116:119], v[124:139]
    s_waitcnt lgkmcnt(0)
    v_mfma_f32_32x32x16_bf16 v[140:155], v[228:231], v[116:119], v[140:155]
    s_barrier
    ds_read_b64_tr_b16 v[216:217], v8 offset:24576
    ds_read_b64_tr_b16 v[218:219], v8 offset:25088
    ds_read_b128 v[120:123], v248 offset:24576
    ds_read_b64_tr_b16 v[220:221], v9 offset:24576
    ds_read_b64_tr_b16 v[222:223], v9 offset:25088
    v_dot2c_f32_bf16 v12, v40, v254
    v_dot2c_f32_bf16 v14, v40, v40
    v_dot2c_f32_bf16 v13, v41, v254
    v_dot2c_f32_bf16 v15, v41, v41
    v_dot2c_f32_bf16 v12, v42, v254
    v_dot2c_f32_bf16 v14, v42, v42
    v_dot2c_f32_bf16 v13, v43, v254
    v_dot2c_f32_bf16 v15, v43, v43
    v_dot2c_f32_bf16 v12, v68, v254
    v_dot2c_f32_bf16 v14, v68, v68
    v_dot2c_f32_bf16 v13, v69, v254
    v_dot2c_f32_bf16 v15, v69, v69
    v_dot2c_f32_bf16 v12, v70, v254
    v_dot2c_f32_bf16 v14, v70, v70
    v_dot2c_f32_bf16 v13, v71, v254
    v_dot2c_f32_bf16 v15, v71, v71
    v_dot2c_f32_bf16 v12, v72, v254
    v_dot2c_f32_bf16 v14, v72, v72
    v_dot2c_f32_bf16 v13, v73, v254
    v_dot2c_f32_bf16 v15, v73, v73
    v_dot2c_f32_bf16 v12, v74, v254
    v_dot2c_f32_bf16 v14, v74, v74
    v_dot2c_f32_bf16 v13, v75, v254
    v_dot2c_f32_bf16 v15, v75, v75
    v_dot2c_f32_bf16 v12, v116, v254
    v_dot2c_f32_bf16 v14, v116, v116
    v_dot2c_f32_bf16 v13, v117, v254
    v_dot2c_f32_bf16 v15, v117, v117
    v_dot2c_f32_bf16 v12, v118, v254
    v_dot2c_f32_bf16 v14, v118, v118
    v_dot2c_f32_bf16 v13, v119, v254
    v_dot2c_f32_bf16 v15, v119, v119
    s_waitcnt lgkmcnt(2)
    v_mfma_f32_32x32x16_bf16 v[124:139], v[216:219], v[120:123], v[124:139]
    ds_read_b64_tr_b16 v[224:225], v8 offset:26624
    ds_read_b64_tr_b16 v[226:227], v8 offset:27136
    ds_read_b128 v[16:19], v249 offset:24576
    s_waitcnt lgkmcnt(3)
    v_mfma_f32_32x32x16_bf16 v[140:155], v[220:223], v[120:123], v[140:155]
    ds_read_b64_tr_b16 v[228:229], v9 offset:26624
    ds_read_b64_tr_b16 v[230:231], v9 offset:27136
    s_waitcnt lgkmcnt(2)
    v_mfma_f32_32x32x16_bf16 v[124:139], v[224:227], v[16:19], v[124:139]
    ds_read_b64_tr_b16 v[216:217], v8 offset:28672
    ds_read_b64_tr_b16 v[218:219], v8 offset:29184
    ds_read_b128 v[20:23], v250 offset:24576
    s_waitcnt lgkmcnt(3)
    v_mfma_f32_32x32x16_bf16 v[140:155], v[228:231], v[16:19], v[140:155]
    ds_read_b64_tr_b16 v[220:221], v9 offset:28672
    ds_read_b64_tr_b16 v[222:223], v9 offset:29184
    s_waitcnt lgkmcnt(2)
    v_mfma_f32_32x32x16_bf16 v[124:139], v[216:219], v[20:23], v[124:139]
    ds_read_b64_tr_b16 v[224:225], v8 offset:30720
    ds_read_b64_tr_b16 v[226:227], v8 offset:31232
    ds_read_b128 v[44:47], v251 offset:24576
    s_waitcnt lgkmcnt(3)
    v_mfma_f32_32x32x16_bf16 v[140:155], v[220:223], v[20:23], v[140:155]
    ds_read_b64_tr_b16 v[228:229], v9 offset:30720
    ds_read_b64_tr_b16 v[230:231], v9 offset:31232
    s_waitcnt lgkmcnt(2)
    v_mfma_f32_32x32x16_bf16 v[124:139], v[224:227], v[44:47], v[124:139]
    s_waitcnt lgkmcnt(0)
    v_mfma_f32_32x32x16_bf16 v[140:155], v[228:231], v[44:47], v[140:155]
    s_barrier
    ds_read_b64_tr_b16 v[216:217], v8 offset:49152
    ds_read_b64_tr_b16 v[218:219], v8 offset:49664
    ds_read_b128 v[48:51], v192 offset:0
    ds_read_b64_tr_b16 v[220:221], v9 offset:49152
    ds_read_b64_tr_b16 v[222:223], v9 offset:49664
    v_dot2c_f32_bf16 v12, v120, v254
    v_dot2c_f32_bf16 v14, v120, v120
    v_dot2c_f32_bf16 v13, v121, v254
    v_dot2c_f32_bf16 v15, v121, v121
    v_dot2c_f32_bf16 v12, v122, v254
    v_dot2c_f32_bf16 v14, v122, v122
    v_dot2c_f32_bf16 v13, v123, v254
    v_dot2c_f32_bf16 v15, v123, v123
    v_dot2c_f32_bf16 v12, v16, v254
    v_dot2c_f32_bf16 v14, v16, v16
    v_dot2c_f32_bf16 v13, v17, v254
    v_dot2c_f32_bf16 v15, v17, v17
    v_dot2c_f32_bf16 v12, v18, v254
    v_dot2c_f32_bf16 v14, v18, v18
    v_dot2c_f32_bf16 v13, v19, v254
    v_dot2c_f32_bf16 v15, v19, v19
    v_dot2c_f32_bf16 v12, v20, v254
    v_dot2c_f32_bf16 v14, v20, v20
    v_dot2c_f32_bf16 v13, v21, v254
    v_dot2c_f32_bf16 v15, v21, v21
    v_dot2c_f32_bf16 v12, v22, v254
    v_dot2c_f32_bf16 v14, v22, v22
    v_dot2c_f32_bf16 v13, v23, v254
    v_dot2c_f32_bf16 v15, v23, v23
    v_dot2c_f32_bf16 v12, v44, v254
    v_dot2c_f32_bf16 v14, v44, v44
    v_dot2c_f32_bf16 v13, v45, v254
    v_dot2c_f32_bf16 v15, v45, v45
    v_dot2c_f32_bf16 v12, v46, v254
    v_dot2c_f32_bf16 v14, v46, v46
    v_dot2c_f32_bf16 v13, v47, v254
    v_dot2c_f32_bf16 v15, v47, v47
    s_waitcnt lgkmcnt(2)
    v_mfma_f32_32x32x16_bf16 v[124:139], v[216:219], v[48:51], v[124:139]
    ds_read_b64_tr_b16 v[224:225], v8 offset:51200
    ds_read_b64_tr_b16 v[226:227], v8 offset:51712
    ds_read_b128 v[52:55], v193 offset:0
    s_waitcnt lgkmcnt(3)
    v_mfma_f32_32x32x16_bf16 v[140:155], v[220:223], v[48:51], v[140:155]
    ds_read_b64_tr_b16 v[228:229], v9 offset:51200
    ds_read_b64_tr_b16 v[230:231], v9 offset:51712
    s_waitcnt lgkmcnt(2)
    v_mfma_f32_32x32x16_bf16 v[124:139], v[224:227], v[52:55], v[124:139]
    ds_read_b64_tr_b16 v[216:217], v8 offset:53248
    ds_read_b64_tr_b16 v[218:219], v8 offset:53760
    ds_read_b128 v[56:59], v194 offset:0
    s_waitcnt lgkmcnt(3)
    v_mfma_f32_32x32x16_bf16 v[140:155], v[228:231], v[52:55], v[140:155]
    ds_read_b64_tr_b16 v[220:221], v9 offset:53248
    ds_read_b64_tr_b16 v[222:223], v9 offset:53760
    s_waitcnt lgkmcnt(2)
    v_mfma_f32_32x32x16_bf16 v[124:139], v[216:219], v[56:59], v[124:139]
    ds_read_b64_tr_b16 v[224:225], v8 offset:55296
    ds_read_b64_tr_b16 v[226:227], v8 offset:55808
    ds_read_b128 v[60:63], v195 offset:0
    s_waitcnt lgkmcnt(3)
    v_mfma_f32_32x32x16_bf16 v[140:155], v[220:223], v[56:59], v[140:155]
    ds_read_b64_tr_b16 v[228:229], v9 offset:55296
    ds_read_b64_tr_b16 v[230:231], v9 offset:55808
    s_waitcnt lgkmcnt(2)
    v_mfma_f32_32x32x16_bf16 v[124:139], v[224:227], v[60:63], v[124:139]
    s_waitcnt lgkmcnt(0)
    v_mfma_f32_32x32x16_bf16 v[140:155], v[228:231], v[60:63], v[140:155]
    s_barrier
    ds_read_b64_tr_b16 v[216:217], v10 offset:0
    ds_read_b64_tr_b16 v[218:219], v10 offset:512
    ds_read_b128 v[64:67], v192 offset:24576
    ds_read_b64_tr_b16 v[220:221], v11 offset:0
    ds_read_b64_tr_b16 v[222:223], v11 offset:512
    v_dot2c_f32_bf16 v12, v48, v254
    v_dot2c_f32_bf16 v14, v48, v48
    v_dot2c_f32_bf16 v13, v49, v254
    v_dot2c_f32_bf16 v15, v49, v49
    v_dot2c_f32_bf16 v12, v50, v254
    v_dot2c_f32_bf16 v14, v50, v50
    v_dot2c_f32_bf16 v13, v51, v254
    v_dot2c_f32_bf16 v15, v51, v51
    v_dot2c_f32_bf16 v12, v52, v254
    v_dot2c_f32_bf16 v14, v52, v52
    v_dot2c_f32_bf16 v13, v53, v254
    v_dot2c_f32_bf16 v15, v53, v53
    v_dot2c_f32_bf16 v12, v54, v254
    v_dot2c_f32_bf16 v14, v54, v54
    v_dot2c_f32_bf16 v13, v55, v254
    v_dot2c_f32_bf16 v15, v55, v55
    v_dot2c_f32_bf16 v12, v56, v254
    v_dot2c_f32_bf16 v14, v56, v56
    v_dot2c_f32_bf16 v13, v57, v254
    v_dot2c_f32_bf16 v15, v57, v57
    v_dot2c_f32_bf16 v12, v58, v254
    v_dot2c_f32_bf16 v14, v58, v58
    v_dot2c_f32_bf16 v13, v59, v254
    v_dot2c_f32_bf16 v15, v59, v59
    v_dot2c_f32_bf16 v12, v60, v254
    v_dot2c_f32_bf16 v14, v60, v60
    v_dot2c_f32_bf16 v13, v61, v254
    v_dot2c_f32_bf16 v15, v61, v61
    v_dot2c_f32_bf16 v12, v62, v254
    v_dot2c_f32_bf16 v14, v62, v62
    v_dot2c_f32_bf16 v13, v63, v254
    v_dot2c_f32_bf16 v15, v63, v63
    s_waitcnt lgkmcnt(2)
    v_mfma_f32_32x32x16_bf16 v[124:139], v[216:219], v[64:67], v[124:139]
    ds_read_b64_tr_b16 v[224:225], v10 offset:2048
    ds_read_b64_tr_b16 v[226:227], v10 offset:2560
    ds_read_b128 v[76:79], v193 offset:24576
    s_waitcnt lgkmcnt(3)
    v_mfma_f32_32x32x16_bf16 v[140:155], v[220:223], v[64:67], v[140:155]
    ds_read_b64_tr_b16 v[228:229], v11 offset:2048
    ds_read_b64_tr_b16 v[230:231], v11 offset:2560
    s_waitcnt lgkmcnt(2)
    v_mfma_f32_32x32x16_bf16 v[124:139], v[224:227], v[76:79], v[124:139]
    ds_read_b64_tr_b16 v[216:217], v10 offset:4096
    ds_read_b64_tr_b16 v[218:219], v10 offset:4608
    ds_read_b128 v[80:83], v194 offset:24576
    s_waitcnt lgkmcnt(3)
    v_mfma_f32_32x32x16_bf16 v[140:155], v[228:231], v[76:79], v[140:155]
    ds_read_b64_tr_b16 v[220:221], v11 offset:4096
    ds_read_b64_tr_b16 v[222:223], v11 offset:4608
    s_waitcnt lgkmcnt(2)
    v_mfma_f32_32x32x16_bf16 v[124:139], v[216:219], v[80:83], v[124:139]
    ds_read_b64_tr_b16 v[224:225], v10 offset:6144
    ds_read_b64_tr_b16 v[226:227], v10 offset:6656
    ds_read_b128 v[84:87], v195 offset:24576
    s_waitcnt lgkmcnt(3)
    v_mfma_f32_32x32x16_bf16 v[140:155], v[220:223], v[80:83], v[140:155]
    ds_read_b64_tr_b16 v[228:229], v11 offset:6144
    ds_read_b64_tr_b16 v[230:231], v11 offset:6656
    s_waitcnt lgkmcnt(2)
    v_mfma_f32_32x32x16_bf16 v[124:139], v[224:227], v[84:87], v[124:139]
    s_waitcnt lgkmcnt(0)
    v_mfma_f32_32x32x16_bf16 v[140:155], v[228:231], v[84:87], v[140:155]
    s_barrier
    ds_read_b64_tr_b16 v[216:217], v8 offset:0
    ds_read_b64_tr_b16 v[218:219], v8 offset:512
    ds_read_b128 v[88:91], v248 offset:0
    ds_read_b64_tr_b16 v[220:221], v9 offset:0
    ds_read_b64_tr_b16 v[222:223], v9 offset:512
    v_dot2c_f32_bf16 v12, v64, v254
    v_dot2c_f32_bf16 v14, v64, v64
    v_dot2c_f32_bf16 v13, v65, v254
    v_dot2c_f32_bf16 v15, v65, v65
    v_dot2c_f32_bf16 v12, v66, v254
    v_dot2c_f32_bf16 v14, v66, v66
    v_dot2c_f32_bf16 v13, v67, v254
    v_dot2c_f32_bf16 v15, v67, v67
    v_dot2c_f32_bf16 v12, v76, v254
    v_dot2c_f32_bf16 v14, v76, v76
    v_dot2c_f32_bf16 v13, v77, v254
    v_dot2c_f32_bf16 v15, v77, v77
    v_dot2c_f32_bf16 v12, v78, v254
    v_dot2c_f32_bf16 v14, v78, v78
    v_dot2c_f32_bf16 v13, v79, v254
    v_dot2c_f32_bf16 v15, v79, v79
    v_dot2c_f32_bf16 v12, v80, v254
    v_dot2c_f32_bf16 v14, v80, v80
    v_dot2c_f32_bf16 v13, v81, v254
    v_dot2c_f32_bf16 v15, v81, v81
    v_dot2c_f32_bf16 v12, v82, v254
    v_dot2c_f32_bf16 v14, v82, v82
    v_dot2c_f32_bf16 v13, v83, v254
    v_dot2c_f32_bf16 v15, v83, v83
    v_dot2c_f32_bf16 v12, v84, v254
    v_dot2c_f32_bf16 v14, v84, v84
    v_dot2c_f32_bf16 v13, v85, v254
    v_dot2c_f32_bf16 v15, v85, v85
    v_dot2c_f32_bf16 v12, v86, v254
    v_dot2c_f32_bf16 v14, v86, v86
    v_dot2c_f32_bf16 v13, v87, v254
    v_dot2c_f32_bf16 v15, v87, v87
    s_waitcnt lgkmcnt(2)
    v_mfma_f32_32x32x16_bf16 v[124:139], v[216:219], v[88:91], v[124:139]
    ds_read_b64_tr_b16 v[224:225], v8 offset:2048
    ds_read_b64_tr_b16 v[226:227], v8 offset:2560
    ds_read_b128 v[92:95], v249 offset:0
    s_waitcnt lgkmcnt(3)
    v_mfma_f32_32x32x16_bf16 v[140:155], v[220:223], v[88:91], v[140:155]
    ds_read_b64_tr_b16 v[228:229], v9 offset:2048
    ds_read_b64_tr_b16 v[230:231], v9 offset:2560
    s_waitcnt lgkmcnt(2)
    v_mfma_f32_32x32x16_bf16 v[124:139], v[224:227], v[92:95], v[124:139]
    ds_read_b64_tr_b16 v[216:217], v8 offset:4096
    ds_read_b64_tr_b16 v[218:219], v8 offset:4608
    ds_read_b128 v[96:99], v250 offset:0
    s_waitcnt lgkmcnt(3)
    v_mfma_f32_32x32x16_bf16 v[140:155], v[228:231], v[92:95], v[140:155]
    ds_read_b64_tr_b16 v[220:221], v9 offset:4096
    ds_read_b64_tr_b16 v[222:223], v9 offset:4608
    buffer_load_dword v215, v214, s[48:51], 0 offen
    s_waitcnt lgkmcnt(2)
    v_mfma_f32_32x32x16_bf16 v[124:139], v[216:219], v[96:99], v[124:139]
    ds_read_b64_tr_b16 v[224:225], v8 offset:6144
    ds_read_b64_tr_b16 v[226:227], v8 offset:6656
    ds_read_b128 v[100:103], v251 offset:0
    s_waitcnt lgkmcnt(3)
    v_mfma_f32_32x32x16_bf16 v[140:155], v[220:223], v[96:99], v[140:155]
    ds_read_b64_tr_b16 v[228:229], v9 offset:6144
    ds_read_b64_tr_b16 v[230:231], v9 offset:6656
    s_waitcnt lgkmcnt(2)
    v_mfma_f32_32x32x16_bf16 v[124:139], v[224:227], v[100:103], v[124:139]
    s_waitcnt lgkmcnt(0)
    v_mfma_f32_32x32x16_bf16 v[140:155], v[228:231], v[100:103], v[140:155]
    s_barrier
    ds_read_b128 v[104:107], v248 offset:24576
    ds_read_b128 v[108:111], v249 offset:24576
    ds_read_b128 v[112:115], v250 offset:24576
    ds_read_b128 v[188:191], v251 offset:24576
    ds_read_b64_tr_b16 v[216:217], v8 offset:24576
    ds_read_b64_tr_b16 v[218:219], v8 offset:25088
    ds_read_b64_tr_b16 v[220:221], v9 offset:24576
    ds_read_b64_tr_b16 v[222:223], v9 offset:25088
    v_dot2c_f32_bf16 v12, v88, v254
    v_dot2c_f32_bf16 v14, v88, v88
    v_dot2c_f32_bf16 v13, v89, v254
    v_dot2c_f32_bf16 v15, v89, v89
    v_dot2c_f32_bf16 v12, v90, v254
    v_dot2c_f32_bf16 v14, v90, v90
    v_dot2c_f32_bf16 v13, v91, v254
    v_dot2c_f32_bf16 v15, v91, v91
    v_dot2c_f32_bf16 v12, v92, v254
    v_dot2c_f32_bf16 v14, v92, v92
    v_dot2c_f32_bf16 v13, v93, v254
    v_dot2c_f32_bf16 v15, v93, v93
    v_dot2c_f32_bf16 v12, v94, v254
    v_dot2c_f32_bf16 v14, v94, v94
    v_dot2c_f32_bf16 v13, v95, v254
    v_dot2c_f32_bf16 v15, v95, v95
    v_dot2c_f32_bf16 v12, v96, v254
    v_dot2c_f32_bf16 v14, v96, v96
    v_dot2c_f32_bf16 v13, v97, v254
    v_dot2c_f32_bf16 v15, v97, v97
    v_dot2c_f32_bf16 v12, v98, v254
    v_dot2c_f32_bf16 v14, v98, v98
    v_dot2c_f32_bf16 v13, v99, v254
    v_dot2c_f32_bf16 v15, v99, v99
    v_dot2c_f32_bf16 v12, v100, v254
    v_dot2c_f32_bf16 v14, v100, v100
    v_dot2c_f32_bf16 v13, v101, v254
    v_dot2c_f32_bf16 v15, v101, v101
    v_dot2c_f32_bf16 v12, v102, v254
    v_dot2c_f32_bf16 v14, v102, v102
    v_dot2c_f32_bf16 v13, v103, v254
    v_dot2c_f32_bf16 v15, v103, v103
    s_waitcnt lgkmcnt(7)
    v_dot2c_f32_bf16 v12, v104, v254
    v_dot2c_f32_bf16 v14, v104, v104
    v_dot2c_f32_bf16 v13, v105, v254
    v_dot2c_f32_bf16 v15, v105, v105
    v_dot2c_f32_bf16 v12, v106, v254
    v_dot2c_f32_bf16 v14, v106, v106
    v_dot2c_f32_bf16 v13, v107, v254
    v_dot2c_f32_bf16 v15, v107, v107
    s_waitcnt lgkmcnt(6)
    v_dot2c_f32_bf16 v12, v108, v254
    v_dot2c_f32_bf16 v14, v108, v108
    v_dot2c_f32_bf16 v13, v109, v254
    v_dot2c_f32_bf16 v15, v109, v109
    v_dot2c_f32_bf16 v12, v110, v254
    v_dot2c_f32_bf16 v14, v110, v110
    v_dot2c_f32_bf16 v13, v111, v254
    v_dot2c_f32_bf16 v15, v111, v111
    s_waitcnt lgkmcnt(5)
    v_dot2c_f32_bf16 v12, v112, v254
    v_dot2c_f32_bf16 v14, v112, v112
    v_dot2c_f32_bf16 v13, v113, v254
    v_dot2c_f32_bf16 v15, v113, v113
    v_dot2c_f32_bf16 v12, v114, v254
    v_dot2c_f32_bf16 v14, v114, v114
    v_dot2c_f32_bf16 v13, v115, v254
    v_dot2c_f32_bf16 v15, v115, v115
    s_waitcnt lgkmcnt(4)
    v_dot2c_f32_bf16 v12, v188, v254
    v_dot2c_f32_bf16 v14, v188, v188
    v_dot2c_f32_bf16 v13, v189, v254
    v_dot2c_f32_bf16 v15, v189, v189
    v_dot2c_f32_bf16 v12, v190, v254
    v_dot2c_f32_bf16 v14, v190, v190
    v_dot2c_f32_bf16 v13, v191, v254
    v_dot2c_f32_bf16 v15, v191, v191
    s_waitcnt lgkmcnt(2)
    v_mfma_f32_32x32x16_bf16 v[124:139], v[216:219], v[104:107], v[124:139]
    ds_read_b64_tr_b16 v[224:225], v8 offset:26624
    ds_read_b64_tr_b16 v[226:227], v8 offset:27136
    v_add_f32 v12, v12, v13
    v_add_f32 v14, v14, v15
    v_mov_b32 v13, v12
    v_mov_b32 v15, v14
    s_waitcnt lgkmcnt(2)
    v_mfma_f32_32x32x16_bf16 v[140:155], v[220:223], v[104:107], v[140:155]
    ds_read_b64_tr_b16 v[228:229], v9 offset:26624
    ds_read_b64_tr_b16 v[230:231], v9 offset:27136
    v_add_u32 v10, 94208, v8
    v_add_u32 v11, 94208, v9
    v_permlane32_swap_b32 v12, v13
    v_permlane32_swap_b32 v14, v15
    s_waitcnt lgkmcnt(2)
    v_mfma_f32_32x32x16_bf16 v[124:139], v[224:227], v[108:111], v[124:139]
    ds_read_b64_tr_b16 v[216:217], v8 offset:28672
    ds_read_b64_tr_b16 v[218:219], v8 offset:29184
    v_add_f32 v12, v12, v13
    v_add_f32 v14, v14, v15
    v_mul_f32 v13, 0xbacccccd, v12
    v_mul_f32 v14, 0x3acccccd, v14
    s_waitcnt lgkmcnt(2)
    v_mfma_f32_32x32x16_bf16 v[140:155], v[228:231], v[108:111], v[140:155]
    ds_read_b64_tr_b16 v[220:221], v9 offset:28672
    ds_read_b64_tr_b16 v[222:223], v9 offset:29184
    v_cvt_pk_bf16_f32 v244, v13, v13
    v_fma_f32 v14, -v13, v13, v14
    v_and_b32 v244, 0xffff0000, v244
    v_max_f32 v14, 0, v14
    s_waitcnt lgkmcnt(2)
    v_mfma_f32_32x32x16_bf16 v[124:139], v[216:219], v[112:115], v[124:139]
    ds_read_b64_tr_b16 v[224:225], v8 offset:30720
    ds_read_b64_tr_b16 v[226:227], v8 offset:31232
    v_sub_f32 v244, v13, v244
    v_add_f32 v14, 0x3727c5ac, v14
    v_cvt_pk_bf16_f32 v244, v13, v244
    v_rsq_f32 v14, v14
    s_waitcnt lgkmcnt(2)
    v_mfma_f32_32x32x16_bf16 v[140:155], v[220:223], v[112:115], v[140:155]
    ds_read_b64_tr_b16 v[228:229], v9 offset:30720
    ds_read_b64_tr_b16 v[230:231], v9 offset:31232
    v_mov_b32 v245, v244
    v_mov_b32 v246, v244
    v_mov_b32 v247, v244
    v_mul_f32 v12, s43, v14
    s_barrier
    ds_read_b128 v[216:219], v255 offset:0
    ds_read_b128 v[220:223], v255 offset:1024
    s_waitcnt lgkmcnt(4)
    v_mfma_f32_32x32x16_bf16 v[124:139], v[224:227], v[188:191], v[124:139]
    s_waitcnt lgkmcnt(2)
    v_mfma_f32_32x32x16_bf16 v[140:155], v[228:231], v[188:191], v[140:155]
    s_cmp_lg_u32 s54, 0
    s_waitcnt lgkmcnt(1)
    v_mfma_f32_32x32x16_bf16 v[124:139], v[216:219], v[244:247], v[124:139]
    s_waitcnt lgkmcnt(0)
    v_mfma_f32_32x32x16_bf16 v[140:155], v[220:223], v[244:247], v[140:155]
    s_cbranch_scc1 kx_fused_kernel_pv45
    s_nop 8
    v_pk_mul_f32 v[124:125], v[124:125], v[12:13] op_sel:[0,0] op_sel_hi:[1,0]
    v_pk_mul_f32 v[126:127], v[126:127], v[12:13] op_sel:[0,0] op_sel_hi:[1,0]
    v_pk_mul_f32 v[128:129], v[128:129], v[12:13] op_sel:[0,0] op_sel_hi:[1,0]
    v_pk_mul_f32 v[130:131], v[130:131], v[12:13] op_sel:[0,0] op_sel_hi:[1,0]
    v_cvt_pk_bf16_f32 v124, v124, v125
    v_cvt_pk_bf16_f32 v125, v126, v127
    v_cvt_pk_bf16_f32 v126, v128, v129
    v_cvt_pk_bf16_f32 v127, v130, v131
    buffer_store_dwordx4 v[124:127], v240, s[20:23], s56 offen sc1
    s_add_u32 s56, s56, 65536
    v_pk_mul_f32 v[132:133], v[132:133], v[12:13] op_sel:[0,0] op_sel_hi:[1,0]
    v_pk_mul_f32 v[134:135], v[134:135], v[12:13] op_sel:[0,0] op_sel_hi:[1,0]
    v_pk_mul_f32 v[136:137], v[136:137], v[12:13] op_sel:[0,0] op_sel_hi:[1,0]
    v_pk_mul_f32 v[138:139], v[138:139], v[12:13] op_sel:[0,0] op_sel_hi:[1,0]
    v_cvt_pk_bf16_f32 v132, v132, v133
    v_cvt_pk_bf16_f32 v133, v134, v135
    v_cvt_pk_bf16_f32 v134, v136, v137
    v_cvt_pk_bf16_f32 v135, v138, v139
    buffer_store_dwordx4 v[132:135], v240, s[20:23], s56 offen sc1
    s_add_u32 s56, s56, 65536
    v_pk_mul_f32 v[140:141], v[140:141], v[12:13] op_sel:[0,0] op_sel_hi:[1,0]
    v_pk_mul_f32 v[142:143], v[142:143], v[12:13] op_sel:[0,0] op_sel_hi:[1,0]
    v_pk_mul_f32 v[144:145], v[144:145], v[12:13] op_sel:[0,0] op_sel_hi:[1,0]
    v_pk_mul_f32 v[146:147], v[146:147], v[12:13] op_sel:[0,0] op_sel_hi:[1,0]
    v_cvt_pk_bf16_f32 v140, v140, v141
    v_cvt_pk_bf16_f32 v141, v142, v143
    v_cvt_pk_bf16_f32 v142, v144, v145
    v_cvt_pk_bf16_f32 v143, v146, v147
    buffer_store_dwordx4 v[140:143], v240, s[20:23], s56 offen sc1
    s_add_u32 s56, s56, 65536
    v_pk_mul_f32 v[148:149], v[148:149], v[12:13] op_sel:[0,0] op_sel_hi:[1,0]
    v_pk_mul_f32 v[150:151], v[150:151], v[12:13] op_sel:[0,0] op_sel_hi:[1,0]
    v_pk_mul_f32 v[152:153], v[152:153], v[12:13] op_sel:[0,0] op_sel_hi:[1,0]
    v_pk_mul_f32 v[154:155], v[154:155], v[12:13] op_sel:[0,0] op_sel_hi:[1,0]
    v_cvt_pk_bf16_f32 v148, v148, v149
    v_cvt_pk_bf16_f32 v149, v150, v151
    v_cvt_pk_bf16_f32 v150, v152, v153
    v_cvt_pk_bf16_f32 v151, v154, v155
    buffer_store_dwordx4 v[148:151], v240, s[20:23], s56 offen sc1
    s_branch kx_fused_kernel_px46
kx_fused_kernel_pv45:
    s_nop 8
    v_pk_mul_f32 v[124:125], v[124:125], v[12:13] op_sel:[0,0] op_sel_hi:[1,0]
    v_pk_mul_f32 v[126:127], v[126:127], v[12:13] op_sel:[0,0] op_sel_hi:[1,0]
    v_pk_mul_f32 v[128:129], v[128:129], v[12:13] op_sel:[0,0] op_sel_hi:[1,0]
    v_pk_mul_f32 v[130:131], v[130:131], v[12:13] op_sel:[0,0] op_sel_hi:[1,0]
    v_cvt_pk_bf16_f32 v124, v124, v125
    v_cvt_pk_bf16_f32 v125, v126, v127
    v_cvt_pk_bf16_f32 v126, v128, v129
    v_cvt_pk_bf16_f32 v127, v130, v131
    ds_write_b128 v252, v[124:127] offset:0
    v_pk_mul_f32 v[132:133], v[132:133], v[12:13] op_sel:[0,0] op_sel_hi:[1,0]
    v_pk_mul_f32 v[134:135], v[134:135], v[12:13] op_sel:[0,0] op_sel_hi:[1,0]
    v_pk_mul_f32 v[136:137], v[136:137], v[12:13] op_sel:[0,0] op_sel_hi:[1,0]
    v_pk_mul_f32 v[138:139], v[138:139], v[12:13] op_sel:[0,0] op_sel_hi:[1,0]
    v_cvt_pk_bf16_f32 v132, v132, v133
    v_cvt_pk_bf16_f32 v133, v134, v135
    v_cvt_pk_bf16_f32 v134, v136, v137
    v_cvt_pk_bf16_f32 v135, v138, v139
    ds_write_b128 v252, v[132:135] offset:4224
    v_pk_mul_f32 v[140:141], v[140:141], v[12:13] op_sel:[0,0] op_sel_hi:[1,0]
    v_pk_mul_f32 v[142:143], v[142:143], v[12:13] op_sel:[0,0] op_sel_hi:[1,0]
    v_pk_mul_f32 v[144:145], v[144:145], v[12:13] op_sel:[0,0] op_sel_hi:[1,0]
    v_pk_mul_f32 v[146:147], v[146:147], v[12:13] op_sel:[0,0] op_sel_hi:[1,0]
    v_cvt_pk_bf16_f32 v140, v140, v141
    v_cvt_pk_bf16_f32 v141, v142, v143
    v_cvt_pk_bf16_f32 v142, v144, v145
    v_cvt_pk_bf16_f32 v143, v146, v147
    ds_write_b128 v252, v[140:143] offset:8448
    v_pk_mul_f32 v[148:149], v[148:149], v[12:13] op_sel:[0,0] op_sel_hi:[1,0]
    v_pk_mul_f32 v[150:151], v[150:151], v[12:13] op_sel:[0,0] op_sel_hi:[1,0]
    v_pk_mul_f32 v[152:153], v[152:153], v[12:13] op_sel:[0,0] op_sel_hi:[1,0]
    v_pk_mul_f32 v[154:155], v[154:155], v[12:13] op_sel:[0,0] op_sel_hi:[1,0]
    v_cvt_pk_bf16_f32 v148, v148, v149
    v_cvt_pk_bf16_f32 v149, v150, v151
    v_cvt_pk_bf16_f32 v150, v152, v153
    v_cvt_pk_bf16_f32 v151, v154, v155
    ds_write_b128 v252, v[148:151] offset:12672
    ds_read_b64_tr_b16 v[124:125], v242 offset:0
    ds_read_b64_tr_b16 v[126:127], v242 offset:64
    ds_read_b64_tr_b16 v[128:129], v242 offset:128
    ds_read_b64_tr_b16 v[130:131], v242 offset:192
    ds_read_b64_tr_b16 v[132:133], v242 offset:256
    ds_read_b64_tr_b16 v[134:135], v242 offset:320
    ds_read_b64_tr_b16 v[136:137], v242 offset:384
    ds_read_b64_tr_b16 v[138:139], v242 offset:448
    s_waitcnt lgkmcnt(6)
    buffer_store_dwordx4 v[124:127], v241, s[20:23], s56 offen sc1
    s_add_u32 s56, s56, 10368
    s_waitcnt lgkmcnt(4)
    buffer_store_dwordx4 v[128:131], v241, s[20:23], s56 offen sc1
    s_add_u32 s56, s56, 10368
    s_waitcnt lgkmcnt(2)
    buffer_store_dwordx4 v[132:135], v241, s[20:23], s56 offen sc1
    s_add_u32 s56, s56, 10368
    s_waitcnt lgkmcnt(0)
    buffer_store_dwordx4 v[136:139], v241, s[20:23], s56 offen sc1
kx_fused_kernel_px46:
    s_cmp_eq_u32 s13, 7
    s_barrier
    s_cbranch_scc1 kx_fused_kernel_tsp47
    ds_read_b64_tr_b16 v[216:217], v10 offset:0
    ds_read_b64_tr_b16 v[218:219], v10 offset:512
    ds_read_b64_tr_b16 v[220:221], v11 offset:0
    ds_read_b64_tr_b16 v[222:223], v11 offset:512
    s_waitcnt lgkmcnt(2)
    v_mfma_f32_32x32x16_bf16 v[124:139], v[216:219], v[196:199], 0
    ds_read_b64_tr_b16 v[224:225], v10 offset:2048
    ds_read_b64_tr_b16 v[226:227], v10 offset:2560
    s_waitcnt lgkmcnt(2)
    v_mfma_f32_32x32x16_bf16 v[140:155], v[220:223], v[196:199], 0
    ds_read_b64_tr_b16 v[228:229], v11 offset:2048
    ds_read_b64_tr_b16 v[230:231], v11 offset:2560
    s_waitcnt lgkmcnt(2)
    v_mfma_f32_32x32x16_bf16 v[124:139], v[224:227], v[200:203], v[124:139]
    ds_read_b64_tr_b16 v[216:217], v10 offset:4096
    ds_read_b64_tr_b16 v[218:219], v10 offset:4608
    s_waitcnt lgkmcnt(2)
    v_mfma_f32_32x32x16_bf16 v[140:155], v[228:231], v[200:203], v[140:155]
    ds_read_b64_tr_b16 v[220:221], v11 offset:4096
    ds_read_b64_tr_b16 v[222:223], v11 offset:4608
    s_waitcnt lgkmcnt(2)
    v_mfma_f32_32x32x16_bf16 v[124:139], v[216:219], v[204:207], v[124:139]
    ds_read_b64_tr_b16 v[224:225], v10 offset:6144
    ds_read_b64_tr_b16 v[226:227], v10 offset:6656
    s_waitcnt lgkmcnt(2)
    v_mfma_f32_32x32x16_bf16 v[140:155], v[220:223], v[204:207], v[140:155]
    ds_read_b64_tr_b16 v[228:229], v11 offset:6144
    ds_read_b64_tr_b16 v[230:231], v11 offset:6656
    s_waitcnt lgkmcnt(2)
    v_mfma_f32_32x32x16_bf16 v[124:139], v[224:227], v[208:211], v[124:139]
    ds_read_b64_tr_b16 v[216:217], v10 offset:8192
    ds_read_b64_tr_b16 v[218:219], v10 offset:8704
    s_waitcnt lgkmcnt(2)
    v_mfma_f32_32x32x16_bf16 v[140:155], v[228:231], v[208:211], v[140:155]
    ds_read_b64_tr_b16 v[220:221], v11 offset:8192
    ds_read_b64_tr_b16 v[222:223], v11 offset:8704
    s_waitcnt lgkmcnt(2)
    v_mfma_f32_32x32x16_bf16 v[124:139], v[216:219], v[156:159], v[124:139]
    ds_read_b64_tr_b16 v[224:225], v10 offset:10240
    ds_read_b64_tr_b16 v[226:227], v10 offset:10752
    s_waitcnt lgkmcnt(2)
    v_mfma_f32_32x32x16_bf16 v[140:155], v[220:223], v[156:159], v[140:155]
    ds_read_b64_tr_b16 v[228:229], v11 offset:10240
    ds_read_b64_tr_b16 v[230:231], v11 offset:10752
    s_waitcnt lgkmcnt(2)
    v_mfma_f32_32x32x16_bf16 v[124:139], v[224:227], v[160:163], v[124:139]
    ds_read_b64_tr_b16 v[216:217], v10 offset:12288
    ds_read_b64_tr_b16 v[218:219], v10 offset:12800
    s_waitcnt lgkmcnt(2)
    v_mfma_f32_32x32x16_bf16 v[140:155], v[228:231], v[160:163], v[140:155]
    ds_read_b64_tr_b16 v[220:221], v11 offset:12288
    ds_read_b64_tr_b16 v[222:223], v11 offset:12800
    s_waitcnt lgkmcnt(2)
    v_mfma_f32_32x32x16_bf16 v[124:139], v[216:219], v[164:167], v[124:139]
    ds_read_b64_tr_b16 v[224:225], v10 offset:14336
    ds_read_b64_tr_b16 v[226:227], v10 offset:14848
    s_waitcnt lgkmcnt(2)
    v_mfma_f32_32x32x16_bf16 v[140:155], v[220:223], v[164:167], v[140:155]
    ds_read_b64_tr_b16 v[228:229], v11 offset:14336
    ds_read_b64_tr_b16 v[230:231], v11 offset:14848
    s_waitcnt lgkmcnt(2)
    v_mfma_f32_32x32x16_bf16 v[124:139], v[224:227], v[168:171], v[124:139]
    s_mov_b32 s27, 65536
    s_waitcnt vmcnt(0)
    s_branch kx_fused_kernel_pollc50
kx_fused_kernel_poll48:
    buffer_load_dword v215, v214, s[48:51], 0 offen sc1
    s_sub_u32 s27, s27, 1
    s_waitcnt vmcnt(0)
    s_cbranch_scc1 kx_fused_kernel_pollx49
kx_fused_kernel_pollc50:
    v_cmp_eq_u32 vcc, 0, v215
    s_cbranch_vccnz kx_fused_kernel_poll48
kx_fused_kernel_pollx49:
    buffer_store_dword v254, v253, s[20:23], 0 offen sc1
    ds_read_b64_tr_b16 v[216:217], v10 offset:16384
    ds_read_b64_tr_b16 v[218:219], v10 offset:16896
    s_waitcnt lgkmcnt(2)
    v_mfma_f32_32x32x16_bf16 v[140:155], v[228:231], v[168:171], v[140:155]
    ds_read_b64_tr_b16 v[220:221], v11 offset:16384
    ds_read_b64_tr_b16 v[222:223], v11 offset:16896
    s_waitcnt lgkmcnt(2)
    v_mfma_f32_32x32x16_bf16 v[124:139], v[216:219], v[172:175], v[124:139]
    ds_read_b64_tr_b16 v[224:225], v10 offset:18432
    ds_read_b64_tr_b16 v[226:227], v10 offset:18944
    s_waitcnt lgkmcnt(2)
    v_mfma_f32_32x32x16_bf16 v[140:155], v[220:223], v[172:175], v[140:155]
    ds_read_b64_tr_b16 v[228:229], v11 offset:18432
    ds_read_b64_tr_b16 v[230:231], v11 offset:18944
    s_waitcnt lgkmcnt(2)
    v_mfma_f32_32x32x16_bf16 v[124:139], v[224:227], v[176:179], v[124:139]
    ds_read_b64_tr_b16 v[216:217], v10 offset:20480
    ds_read_b64_tr_b16 v[218:219], v10 offset:20992
    s_waitcnt lgkmcnt(2)
    v_mfma_f32_32x32x16_bf16 v[140:155], v[228:231], v[176:179], v[140:155]
    ds_read_b64_tr_b16 v[220:221], v11 offset:20480
    ds_read_b64_tr_b16 v[222:223], v11 offset:20992
    s_waitcnt lgkmcnt(2)
    v_mfma_f32_32x32x16_bf16 v[124:139], v[216:219], v[180:183], v[124:139]
    ds_read_b64_tr_b16 v[224:225], v10 offset:22528
    ds_read_b64_tr_b16 v[226:227], v10 offset:23040
    s_waitcnt lgkmcnt(2)
    v_mfma_f32_32x32x16_bf16 v[140:155], v[220:223], v[180:183], v[140:155]
    ds_read_b64_tr_b16 v[228:229], v11 offset:22528
    ds_read_b64_tr_b16 v[230:231], v11 offset:23040
    s_waitcnt lgkmcnt(2)
    v_mfma_f32_32x32x16_bf16 v[124:139], v[224:227], v[184:187], v[124:139]
    ds_read_b64_tr_b16 v[216:217], v10 offset:24576
    ds_read_b64_tr_b16 v[218:219], v10 offset:25088
    s_waitcnt lgkmcnt(2)
    v_mfma_f32_32x32x16_bf16 v[140:155], v[228:231], v[184:187], v[140:155]
    ds_read_b64_tr_b16 v[220:221], v11 offset:24576
    ds_read_b64_tr_b16 v[222:223], v11 offset:25088
    s_waitcnt lgkmcnt(2)
    v_mfma_f32_32x32x16_bf16 v[124:139], v[216:219], v[24:27], v[124:139]
    ds_read_b64_tr_b16 v[224:225], v10 offset:26624
    ds_read_b64_tr_b16 v[226:227], v10 offset:27136
    s_waitcnt lgkmcnt(2)
    v_mfma_f32_32x32x16_bf16 v[140:155], v[220:223], v[24:27], v[140:155]
    ds_read_b64_tr_b16 v[228:229], v11 offset:26624
    ds_read_b64_tr_b16 v[230:231], v11 offset:27136
    s_waitcnt lgkmcnt(2)
    v_mfma_f32_32x32x16_bf16 v[124:139], v[224:227], v[28:31], v[124:139]
    ds_read_b64_tr_b16 v[216:217], v10 offset:28672
    ds_read_b64_tr_b16 v[218:219], v10 offset:29184
    s_waitcnt lgkmcnt(2)
    v_mfma_f32_32x32x16_bf16 v[140:155], v[228:231], v[28:31], v[140:155]
    ds_read_b64_tr_b16 v[220:221], v11 offset:28672
    ds_read_b64_tr_b16 v[222:223], v11 offset:29184
    s_waitcnt lgkmcnt(2)
    v_mfma_f32_32x32x16_bf16 v[124:139], v[216:219], v[32:35], v[124:139]
    ds_read_b64_tr_b16 v[224:225], v10 offset:30720
    ds_read_b64_tr_b16 v[226:227], v10 offset:31232
    s_waitcnt lgkmcnt(2)
    v_mfma_f32_32x32x16_bf16 v[140:155], v[220:223], v[32:35], v[140:155]
    ds_read_b64_tr_b16 v[228:229], v11 offset:30720
    ds_read_b64_tr_b16 v[230:231], v11 offset:31232
    s_waitcnt lgkmcnt(2)
    v_mfma_f32_32x32x16_bf16 v[124:139], v[224:227], v[36:39], v[124:139]
    ds_read_b64_tr_b16 v[216:217], v10 offset:32768
    ds_read_b64_tr_b16 v[218:219], v10 offset:33280
    s_waitcnt lgkmcnt(2)
    v_mfma_f32_32x32x16_bf16 v[140:155], v[228:231], v[36:39], v[140:155]
    ds_read_b64_tr_b16 v[220:221], v11 offset:32768
    ds_read_b64_tr_b16 v[222:223], v11 offset:33280
    s_waitcnt lgkmcnt(2)
    v_mfma_f32_32x32x16_bf16 v[124:139], v[216:219], v[40:43], v[124:139]
    ds_read_b64_tr_b16 v[224:225], v10 offset:34816
    ds_read_b64_tr_b16 v[226:227], v10 offset:35328
    s_waitcnt lgkmcnt(2)
    v_mfma_f32_32x32x16_bf16 v[140:155], v[220:223], v[40:43], v[140:155]
    ds_read_b64_tr_b16 v[228:229], v11 offset:34816
    ds_read_b64_tr_b16 v[230:231], v11 offset:35328
    s_waitcnt lgkmcnt(2)
    v_mfma_f32_32x32x16_bf16 v[124:139], v[224:227], v[68:71], v[124:139]
    ds_read_b64_tr_b16 v[216:217], v10 offset:36864
    ds_read_b64_tr_b16 v[218:219], v10 offset:37376
    s_waitcnt lgkmcnt(2)
    v_mfma_f32_32x32x16_bf16 v[140:155], v[228:231], v[68:71], v[140:155]
    ds_read_b64_tr_b16 v[220:221], v11 offset:36864
    ds_read_b64_tr_b16 v[222:223], v11 offset:37376
    s_waitcnt lgkmcnt(2)
    v_mfma_f32_32x32x16_bf16 v[124:139], v[216:219], v[72:75], v[124:139]
    ds_read_b64_tr_b16 v[224:225], v10 offset:38912
    ds_read_b64_tr_b16 v[226:227], v10 offset:39424
    s_waitcnt lgkmcnt(2)
    v_mfma_f32_32x32x16_bf16 v[140:155], v[220:223], v[72:75], v[140:155]
    ds_read_b64_tr_b16 v[228:229], v11 offset:38912
    ds_read_b64_tr_b16 v[230:231], v11 offset:39424
    s_waitcnt lgkmcnt(2)
    v_mfma_f32_32x32x16_bf16 v[124:139], v[224:227], v[116:119], v[124:139]
    ds_read_b64_tr_b16 v[216:217], v10 offset:40960
    ds_read_b64_tr_b16 v[218:219], v10 offset:41472
    s_waitcnt lgkmcnt(2)
    v_mfma_f32_32x32x16_bf16 v[140:155], v[228:231], v[116:119], v[140:155]
    ds_read_b64_tr_b16 v[220:221], v11 offset:40960
    ds_read_b64_tr_b16 v[222:223], v11 offset:41472
    s_waitcnt lgkmcnt(2)
    v_mfma_f32_32x32x16_bf16 v[124:139], v[216:219], v[120:123], v[124:139]
    ds_read_b64_tr_b16 v[224:225], v10 offset:43008
    ds_read_b64_tr_b16 v[226:227], v10 offset:43520
    s_waitcnt lgkmcnt(2)
    v_mfma_f32_32x32x16_bf16 v[140:155], v[220:223], v[120:123], v[140:155]
    ds_read_b64_tr_b16 v[228:229], v11 offset:43008
    ds_read_b64_tr_b16 v[230:231], v11 offset:43520
    s_waitcnt lgkmcnt(2)
    v_mfma_f32_32x32x16_bf16 v[124:139], v[224:227], v[16:19], v[124:139]
    ds_read_b64_tr_b16 v[216:217], v10 offset:45056
    ds_read_b64_tr_b16 v[218:219], v10 offset:45568
    s_waitcnt lgkmcnt(2)
    v_mfma_f32_32x32x16_bf16 v[140:155], v[228:231], v[16:19], v[140:155]
    ds_read_b64_tr_b16 v[220:221], v11 offset:45056
    ds_read_b64_tr_b16 v[222:223], v11 offset:45568
    s_waitcnt lgkmcnt(2)
    v_mfma_f32_32x32x16_bf16 v[124:139], v[216:219], v[20:23], v[124:139]
    ds_read_b64_tr_b16 v[224:225], v10 offset:47104
    ds_read_b64_tr_b16 v[226:227], v10 offset:47616
    s_waitcnt lgkmcnt(2)
    v_mfma_f32_32x32x16_bf16 v[140:155], v[220:223], v[20:23], v[140:155]
    ds_read_b64_tr_b16 v[228:229], v11 offset:47104
    ds_read_b64_tr_b16 v[230:231], v11 offset:47616
    s_waitcnt lgkmcnt(2)
    v_mfma_f32_32x32x16_bf16 v[124:139], v[224:227], v[44:47], v[124:139]
    s_barrier
    ds_read_b64_tr_b16 v[216:217], v8 offset:32768
    ds_read_b64_tr_b16 v[218:219], v8 offset:33280
    v_lshrrev_b32 v196, 5, v1
    v_and_b32 v197, 31, v1
    s_lshl2_add_u32 s41, s13, s14
    s_sub_u32 s41, s41, 4
    s_waitcnt lgkmcnt(2)
    v_mfma_f32_32x32x16_bf16 v[140:155], v[228:231], v[44:47], v[140:155]
    ds_read_b64_tr_b16 v[220:221], v9 offset:32768
    ds_read_b64_tr_b16 v[222:223], v9 offset:33280
    s_lshl_b32 s15, s41, 10
    s_lshl3_add_u32 s19, s17, s19
    s_mul_i32 s15, s14, 3072
    s_add_u32 s15, s15, 24576
    s_waitcnt lgkmcnt(2)
    v_mfma_f32_32x32x16_bf16 v[124:139], v[216:219], v[48:51], v[124:139]
    ds_read_b64_tr_b16 v[224:225], v8 offset:34816
    ds_read_b64_tr_b16 v[226:227], v8 offset:35328
    v_lshl_add_u32 v2, v197, 4, s15
    v_lshl_add_u32 v199, v196, 10, v2
    v_lshl_add_u32 v200, s17, 3, v2
    v_lshl_add_u32 v200, v196, 9, v200
    s_waitcnt lgkmcnt(2)
    v_mfma_f32_32x32x16_bf16 v[140:155], v[220:223], v[48:51], v[140:155]
    ds_read_b64_tr_b16 v[228:229], v9 offset:34816
    ds_read_b64_tr_b16 v[230:231], v9 offset:35328
    s_setprio 2
    s_and_b32 s28, s12, 3
    s_lshl2_add_u32 s28, s24, s28
    s_lshl_b32 s29, s17, 1
    s_waitcnt lgkmcnt(2)
    v_mfma_f32_32x32x16_bf16 v[124:139], v[224:227], v[52:55], v[124:139]
    ds_read_b64_tr_b16 v[216:217], v8 offset:36864
    ds_read_b64_tr_b16 v[218:219], v8 offset:37376
    s_lshl2_add_u32 s29, s24, s29
    s_lshr_b32 s30, s2, 4
    s_getreg_b32 s31, hwreg(HW_REG_XCC_ID)
    s_add_u32 s31, s31, 1
    s_waitcnt lgkmcnt(2)
    v_mfma_f32_32x32x16_bf16 v[140:155], v[228:231], v[52:55], v[140:155]
    ds_read_b64_tr_b16 v[220:221], v9 offset:36864
    ds_read_b64_tr_b16 v[222:223], v9 offset:37376
    v_lshrrev_b32 v2, 1, v197
    v_xor_b32 v2, v2, v197
    v_and_b32 v2, 4, v2
    v_mul_u32_u24 v2, 3, v2
    s_waitcnt lgkmcnt(2)
    v_mfma_f32_32x32x16_bf16 v[124:139], v[216:219], v[56:59], v[124:139]
    ds_read_b64_tr_b16 v[224:225], v8 offset:38912
    ds_read_b64_tr_b16 v[226:227], v8 offset:39424
    v_xor_b32 v198, v2, v197
    v_lshlrev_b32 v2, 4, v198
    v_lshl_add_u32 v202, v196, 10, v2
    v_mul_u32_u24 v203, 6144, v196
    s_waitcnt lgkmcnt(2)
    v_mfma_f32_32x32x16_bf16 v[140:155], v[220:223], v[56:59], v[140:155]
    ds_read_b64_tr_b16 v[228:229], v9 offset:38912
    ds_read_b64_tr_b16 v[230:231], v9 offset:39424
    s_lshl_b32 s15, s17, 3
    s_add_u32 s15, s15, 2048
    v_add3_u32 v203, v203, v2, s15
    v_min_u32 v2, 20, v197
    s_waitcnt lgkmcnt(2)
    v_mfma_f32_32x32x16_bf16 v[124:139], v[224:227], v[60:63], v[124:139]
    ds_read_b64_tr_b16 v[216:217], v8 offset:40960
    ds_read_b64_tr_b16 v[218:219], v8 offset:41472
    v_mul_u32_u24 v204, 336, v196
    v_lshl_add_u32 v204, v2, 4, v204
    s_mov_b32 exec_lo, 0xeef00000
    s_mov_b32 exec_hi, 0xeef00000
    s_waitcnt lgkmcnt(2)
    v_mfma_f32_32x32x16_bf16 v[140:155], v[228:231], v[60:63], v[140:155]
    ds_read_b64_tr_b16 v[220:221], v9 offset:40960
    ds_read_b64_tr_b16 v[222:223], v9 offset:41472
    v_add_u32 v204, 0x40000, v204
    s_mov_b64 exec, -1
    v_mov_b32 v205, v202
    v_mov_b32 v206, v203
    s_waitcnt lgkmcnt(2)
    v_mfma_f32_32x32x16_bf16 v[124:139], v[216:219], v[64:67], v[124:139]
    ds_read_b64_tr_b16 v[224:225], v8 offset:43008
    ds_read_b64_tr_b16 v[226:227], v8 offset:43520
    v_mov_b32 v207, v204
    s_mov_b32 s32, 0
    s_mov_b32 s27, 8
    v_lshlrev_b32 v212, 4, v197
    s_waitcnt lgkmcnt(2)
    v_mfma_f32_32x32x16_bf16 v[140:155], v[220:223], v[64:67], v[140:155]
    ds_read_b64_tr_b16 v[228:229], v9 offset:43008
    ds_read_b64_tr_b16 v[230:231], v9 offset:43520
    v_lshl_add_u32 v212, v196, 10, v212
    v_lshlrev_b32 v213, 3, v197
    v_lshl_add_u32 v213, v196, 30, v213
    v_lshlrev_b32 v5, 4, v1
    s_waitcnt lgkmcnt(2)
    v_mfma_f32_32x32x16_bf16 v[124:139], v[224:227], v[76:79], v[124:139]
    ds_read_b64_tr_b16 v[216:217], v8 offset:45056
    ds_read_b64_tr_b16 v[218:219], v8 offset:45568
    s_lshl_b32 s41, s41, 5
    s_add_u32 s41, s41, s12
    s_lshl3_add_u32 s42, s13, s14
    s_waitcnt lgkmcnt(2)
    v_mfma_f32_32x32x16_bf16 v[140:155], v[228:231], v[76:79], v[140:155]
    ds_read_b64_tr_b16 v[220:221], v9 offset:45056
    ds_read_b64_tr_b16 v[222:223], v9 offset:45568
    s_mul_i32 s42, s42, 30720
    s_add_u32 s42, s42, 20971520
    s_mul_i32 s15, s14, 25632
    s_waitcnt lgkmcnt(2)
    v_mfma_f32_32x32x16_bf16 v[124:139], v[216:219], v[80:83], v[124:139]
    ds_read_b64_tr_b16 v[224:225], v8 offset:47104
    ds_read_b64_tr_b16 v[226:227], v8 offset:47616
    s_add_u32 s15, s15, -53376
    v_and_b32 v3, 3, v1
    v_lshl_add_u32 v3, v3, 3, s15
    s_waitcnt lgkmcnt(2)
    v_mfma_f32_32x32x16_bf16 v[140:155], v[220:223], v[80:83], v[140:155]
    ds_read_b64_tr_b16 v[228:229], v9 offset:47104
    ds_read_b64_tr_b16 v[230:231], v9 offset:47616
    v_bfe_u32 v4, v1, 2, 4
    v_mad_u32_u24 v2, v196, 12, v4
    v_mul_u32_u24 v2, 160, v2
    s_waitcnt lgkmcnt(2)
    v_mfma_f32_32x32x16_bf16 v[124:139], v[224:227], v[84:87], v[124:139]
    ds_read_b64_tr_b16 v[216:217], v8 offset:49152
    ds_read_b64_tr_b16 v[218:219], v8 offset:49664
    v_add_u32 v6, v2, v3
    v_and_b32 v2, 48, v1
    v_add_u32 v2, v2, v4
    s_waitcnt lgkmcnt(2)
    v_mfma_f32_32x32x16_bf16 v[140:155], v[228:231], v[84:87], v[140:155]
    ds_read_b64_tr_b16 v[220:221], v9 offset:49152
    ds_read_b64_tr_b16 v[222:223], v9 offset:49664
    v_mul_u32_u24 v2, 160, v2
    v_add_u32 v7, v2, v3
    v_mov_b32 v156, 0
    s_waitcnt lgkmcnt(2)
    v_mfma_f32_32x32x16_bf16 v[124:139], v[216:219], v[88:91], v[124:139]
    ds_read_b64_tr_b16 v[224:225], v8 offset:51200
    ds_read_b64_tr_b16 v[226:227], v8 offset:51712
    v_mov_b32 v157, 0
    v_mov_b32 v158, 0
    v_mov_b32 v159, 0
    s_waitcnt lgkmcnt(2)
    v_mfma_f32_32x32x16_bf16 v[140:155], v[220:223], v[88:91], v[140:155]
    ds_read_b64_tr_b16 v[228:229], v9 offset:51200
    ds_read_b64_tr_b16 v[230:231], v9 offset:51712
    v_mov_b32 v160, 0
    v_mov_b32 v161, 0
    v_mov_b32 v162, 0
    s_waitcnt lgkmcnt(2)
    v_mfma_f32_32x32x16_bf16 v[124:139], v[224:227], v[92:95], v[124:139]
    ds_read_b64_tr_b16 v[216:217], v8 offset:53248
    ds_read_b64_tr_b16 v[218:219], v8 offset:53760
    v_mov_b32 v163, 0
    v_mov_b32 v164, 0
    v_mov_b32 v165, 0
    s_waitcnt lgkmcnt(2)
    v_mfma_f32_32x32x16_bf16 v[140:155], v[228:231], v[92:95], v[140:155]
    ds_read_b64_tr_b16 v[220:221], v9 offset:53248
    ds_read_b64_tr_b16 v[222:223], v9 offset:53760
    v_mov_b32 v166, 0
    v_mov_b32 v167, 0
    v_mov_b32 v168, 0
    s_waitcnt lgkmcnt(2)
    v_mfma_f32_32x32x16_bf16 v[124:139], v[216:219], v[96:99], v[124:139]
    ds_read_b64_tr_b16 v[224:225], v8 offset:55296
    ds_read_b64_tr_b16 v[226:227], v8 offset:55808
    v_mov_b32 v169, 0
    v_mov_b32 v170, 0
    v_mov_b32 v171, 0
    s_waitcnt lgkmcnt(2)
    v_mfma_f32_32x32x16_bf16 v[140:155], v[220:223], v[96:99], v[140:155]
    ds_read_b64_tr_b16 v[228:229], v9 offset:55296
    ds_read_b64_tr_b16 v[230:231], v9 offset:55808
    v_mov_b32 v172, 0
    v_mov_b32 v173, 0
    v_mov_b32 v174, 0
    s_waitcnt lgkmcnt(2)
    v_mfma_f32_32x32x16_bf16 v[124:139], v[224:227], v[100:103], v[124:139]
    ds_read_b64_tr_b16 v[216:217], v8 offset:57344
    ds_read_b64_tr_b16 v[218:219], v8 offset:57856
    v_mov_b32 v175, 0
    v_mov_b32 v176, 0
    v_mov_b32 v177, 0
    s_waitcnt lgkmcnt(2)
    v_mfma_f32_32x32x16_bf16 v[140:155], v[228:231], v[100:103], v[140:155]
    ds_read_b64_tr_b16 v[220:221], v9 offset:57344
    ds_read_b64_tr_b16 v[222:223], v9 offset:57856
    v_mov_b32 v178, 0
    v_mov_b32 v179, 0
    v_mov_b32 v180, 0
    s_waitcnt lgkmcnt(2)
    v_mfma_f32_32x32x16_bf16 v[124:139], v[216:219], v[104:107], v[124:139]
    ds_read_b64_tr_b16 v[224:225], v8 offset:59392
    ds_read_b64_tr_b16 v[226:227], v8 offset:59904
    v_mov_b32 v181, 0
    v_mov_b32 v182, 0
    v_mov_b32 v183, 0
    s_waitcnt lgkmcnt(2)
    v_mfma_f32_32x32x16_bf16 v[140:155], v[220:223], v[104:107], v[140:155]
    ds_read_b64_tr_b16 v[228:229], v9 offset:59392
    ds_read_b64_tr_b16 v[230:231], v9 offset:59904
    v_mov_b32 v184, 0
    v_mov_b32 v185, 0
    v_mov_b32 v186, 0
    s_waitcnt lgkmcnt(2)
    v_mfma_f32_32x32x16_bf16 v[124:139], v[224:227], v[108:111], v[124:139]
    ds_read_b64_tr_b16 v[216:217], v8 offset:61440
    ds_read_b64_tr_b16 v[218:219], v8 offset:61952
    v_mov_b32 v187, 0
    v_mov_b32 v116, 0
    v_mov_b32 v68, 0
    s_waitcnt lgkmcnt(2)
    v_mfma_f32_32x32x16_bf16 v[140:155], v[228:231], v[108:111], v[140:155]
    ds_read_b64_tr_b16 v[220:221], v9 offset:61440
    ds_read_b64_tr_b16 v[222:223], v9 offset:61952
    v_mov_b32 v117, 0
    v_mov_b32 v69, 0
    v_mov_b32 v118, 0
    s_waitcnt lgkmcnt(2)
    v_mfma_f32_32x32x16_bf16 v[124:139], v[216:219], v[112:115], v[124:139]
    ds_read_b64_tr_b16 v[224:225], v8 offset:63488
    ds_read_b64_tr_b16 v[226:227], v8 offset:64000
    v_mov_b32 v70, 0
    v_mov_b32 v119, 0
    v_mov_b32 v71, 0
    s_waitcnt lgkmcnt(2)
    v_mfma_f32_32x32x16_bf16 v[140:155], v[220:223], v[112:115], v[140:155]
    ds_read_b64_tr_b16 v[228:229], v9 offset:63488
    ds_read_b64_tr_b16 v[230:231], v9 offset:64000
    v_mov_b32 v120, 0
    v_mov_b32 v72, 0
    v_mov_b32 v121, 0
    s_waitcnt lgkmcnt(2)
    v_mfma_f32_32x32x16_bf16 v[124:139], v[224:227], v[188:191], v[124:139]
    ds_read_b128 v[216:219], v255 offset:2048
    ds_read_b128 v[220:223], v255 offset:3072
    v_mov_b32 v73, 0
    v_mov_b32 v122, 0
    v_mov_b32 v74, 0
    s_waitcnt lgkmcnt(2)
    v_mfma_f32_32x32x16_bf16 v[140:155], v[228:231], v[188:191], v[140:155]
    v_mov_b32 v123, 0
    v_mov_b32 v75, 0
    s_cmp_lg_u32 s55, 0
    s_waitcnt lgkmcnt(1)
    v_mfma_f32_32x32x16_bf16 v[124:139], v[216:219], v[244:247], v[124:139]
    s_waitcnt lgkmcnt(0)
    v_mfma_f32_32x32x16_bf16 v[140:155], v[220:223], v[244:247], v[140:155]
    s_cbranch_scc1 kx_fused_kernel_pv51
    s_nop 8
    v_pk_mul_f32 v[124:125], v[124:125], v[14:15] op_sel:[0,0] op_sel_hi:[1,0]
    v_pk_mul_f32 v[126:127], v[126:127], v[14:15] op_sel:[0,0] op_sel_hi:[1,0]
    v_pk_mul_f32 v[128:129], v[128:129], v[14:15] op_sel:[0,0] op_sel_hi:[1,0]
    v_pk_mul_f32 v[130:131], v[130:131], v[14:15] op_sel:[0,0] op_sel_hi:[1,0]
    v_cvt_pk_bf16_f32 v124, v124, v125
    v_cvt_pk_bf16_f32 v125, v126, v127
    v_cvt_pk_bf16_f32 v126, v128, v129
    v_cvt_pk_bf16_f32 v127, v130, v131
    buffer_store_dwordx4 v[124:127], v240, s[20:23], s57 offen sc1
    s_add_u32 s57, s57, 65536
    v_pk_mul_f32 v[132:133], v[132:133], v[14:15] op_sel:[0,0] op_sel_hi:[1,0]
    v_pk_mul_f32 v[134:135], v[134:135], v[14:15] op_sel:[0,0] op_sel_hi:[1,0]
    v_pk_mul_f32 v[136:137], v[136:137], v[14:15] op_sel:[0,0] op_sel_hi:[1,0]
    v_pk_mul_f32 v[138:139], v[138:139], v[14:15] op_sel:[0,0] op_sel_hi:[1,0]
    v_cvt_pk_bf16_f32 v132, v132, v133
    v_cvt_pk_bf16_f32 v133, v134, v135
    v_cvt_pk_bf16_f32 v134, v136, v137
    v_cvt_pk_bf16_f32 v135, v138, v139
    buffer_store_dwordx4 v[132:135], v240, s[20:23], s57 offen sc1
    s_add_u32 s57, s57, 65536
    v_pk_mul_f32 v[140:141], v[140:141], v[14:15] op_sel:[0,0] op_sel_hi:[1,0]
    v_pk_mul_f32 v[142:143], v[142:143], v[14:15] op_sel:[0,0] op_sel_hi:[1,0]
    v_pk_mul_f32 v[144:145], v[144:145], v[14:15] op_sel:[0,0] op_sel_hi:[1,0]
    v_pk_mul_f32 v[146:147], v[146:147], v[14:15] op_sel:[0,0] op_sel_hi:[1,0]
    v_cvt_pk_bf16_f32 v140, v140, v141
    v_cvt_pk_bf16_f32 v141, v142, v143
    v_cvt_pk_bf16_f32 v142, v144, v145
    v_cvt_pk_bf16_f32 v143, v146, v147
    buffer_store_dwordx4 v[140:143], v240, s[20:23], s57 offen sc1
    s_add_u32 s57, s57, 65536
    v_pk_mul_f32 v[148:149], v[148:149], v[14:15] op_sel:[0,0] op_sel_hi:[1,0]
    v_pk_mul_f32 v[150:151], v[150:151], v[14:15] op_sel:[0,0] op_sel_hi:[1,0]
    v_pk_mul_f32 v[152:153], v[152:153], v[14:15] op_sel:[0,0] op_sel_hi:[1,0]
    v_pk_mul_f32 v[154:155], v[154:155], v[14:15] op_sel:[0,0] op_sel_hi:[1,0]
    v_cvt_pk_bf16_f32 v148, v148, v149
    v_cvt_pk_bf16_f32 v149, v150, v151
    v_cvt_pk_bf16_f32 v150, v152, v153
    v_cvt_pk_bf16_f32 v151, v154, v155
    buffer_store_dwordx4 v[148:151], v240, s[20:23], s57 offen sc1
    s_branch kx_fused_kernel_px52
kx_fused_kernel_fl253:
    s_waitcnt vmcnt(0)
    buffer_store_dword v254, v28, s[20:23], 0 offen sc1
    s_branch kx_fused_kernel_fl2b54
kx_fused_kernel_pv51:
    s_nop 8
    v_pk_mul_f32 v[124:125], v[124:125], v[14:15] op_sel:[0,0] op_sel_hi:[1,0]
    v_pk_mul_f32 v[126:127], v[126:127], v[14:15] op_sel:[0,0] op_sel_hi:[1,0]
    v_pk_mul_f32 v[128:129], v[128:129], v[14:15] op_sel:[0,0] op_sel_hi:[1,0]
    v_pk_mul_f32 v[130:131], v[130:131], v[14:15] op_sel:[0,0] op_sel_hi:[1,0]
    v_cvt_pk_bf16_f32 v124, v124, v125
    v_cvt_pk_bf16_f32 v125, v126, v127
    v_cvt_pk_bf16_f32 v126, v128, v129
    v_cvt_pk_bf16_f32 v127, v130, v131
    ds_write_b128 v252, v[124:127] offset:0
    v_pk_mul_f32 v[132:133], v[132:133], v[14:15] op_sel:[0,0] op_sel_hi:[1,0]
    v_pk_mul_f32 v[134:135], v[134:135], v[14:15] op_sel:[0,0] op_sel_hi:[1,0]
    v_pk_mul_f32 v[136:137], v[136:137], v[14:15] op_sel:[0,0] op_sel_hi:[1,0]
    v_pk_mul_f32 v[138:139], v[138:139], v[14:15] op_sel:[0,0] op_sel_hi:[1,0]
    v_cvt_pk_bf16_f32 v132, v132, v133
    v_cvt_pk_bf16_f32 v133, v134, v135
    v_cvt_pk_bf16_f32 v134, v136, v137
    v_cvt_pk_bf16_f32 v135, v138, v139
    ds_write_b128 v252, v[132:135] offset:4224
    v_pk_mul_f32 v[140:141], v[140:141], v[14:15] op_sel:[0,0] op_sel_hi:[1,0]
    v_pk_mul_f32 v[142:143], v[142:143], v[14:15] op_sel:[0,0] op_sel_hi:[1,0]
    v_pk_mul_f32 v[144:145], v[144:145], v[14:15] op_sel:[0,0] op_sel_hi:[1,0]
    v_pk_mul_f32 v[146:147], v[146:147], v[14:15] op_sel:[0,0] op_sel_hi:[1,0]
    v_cvt_pk_bf16_f32 v140, v140, v141
    v_cvt_pk_bf16_f32 v141, v142, v143
    v_cvt_pk_bf16_f32 v142, v144, v145
    v_cvt_pk_bf16_f32 v143, v146, v147
    ds_write_b128 v252, v[140:143] offset:8448
    v_pk_mul_f32 v[148:149], v[148:149], v[14:15] op_sel:[0,0] op_sel_hi:[1,0]
    v_pk_mul_f32 v[150:151], v[150:151], v[14:15] op_sel:[0,0] op_sel_hi:[1,0]
    v_pk_mul_f32 v[152:153], v[152:153], v[14:15] op_sel:[0,0] op_sel_hi:[1,0]
    v_pk_mul_f32 v[154:155], v[154:155], v[14:15] op_sel:[0,0] op_sel_hi:[1,0]
    v_cvt_pk_bf16_f32 v148, v148, v149
    v_cvt_pk_bf16_f32 v149, v150, v151
    v_cvt_pk_bf16_f32 v150, v152, v153
    v_cvt_pk_bf16_f32 v151, v154, v155
    ds_write_b128 v252, v[148:151] offset:12672
    ds_read_b64_tr_b16 v[124:125], v242 offset:0
    ds_read_b64_tr_b16 v[126:127], v242 offset:64
    ds_read_b64_tr_b16 v[128:129], v242 offset:128
    ds_read_b64_tr_b16 v[130:131], v242 offset:192
    ds_read_b64_tr_b16 v[132:133], v242 offset:256
    ds_read_b64_tr_b16 v[134:135], v242 offset:320
    ds_read_b64_tr_b16 v[136:137], v242 offset:384
    ds_read_b64_tr_b16 v[138:139], v242 offset:448
    s_waitcnt lgkmcnt(6)
    buffer_store_dwordx4 v[124:127], v241, s[20:23], s57 offen sc1
    s_add_u32 s57, s57, 10368
    s_waitcnt lgkmcnt(4)
    buffer_store_dwordx4 v[128:131], v241, s[20:23], s57 offen sc1
    s_add_u32 s57, s57, 10368
    s_waitcnt lgkmcnt(2)
    buffer_store_dwordx4 v[132:135], v241, s[20:23], s57 offen sc1
    s_add_u32 s57, s57, 10368
    s_waitcnt lgkmcnt(0)
    buffer_store_dwordx4 v[136:139], v241, s[20:23], s57 offen sc1
kx_fused_kernel_px52:
kx_fused_kernel_tset5:
    v_mov_b32 v28, v243
    s_barrier
    ds_read_b64 v[24:25], v200 offset:2048
    ds_read2st64_b64 v[52:55], v206 offset0:0 offset1:1
    ds_read_b128 v[44:47], v205 offset:0
    ds_read_b128 v[16:19], v199
    ds_read_b128 v[20:23], v199 offset:512
    ds_read_b128 v[48:51], v205 offset:512
    ds_read_b128 v[60:63], v207 offset:3072
    ds_read_b128 v[64:67], v207 offset:3744
    s_waitcnt lgkmcnt(6)
    v_mfma_f32_32x32x4_2b_bf16 v[76:107], v[52:53], v[24:25], 0 cbsz:1 abid:0
    s_waitcnt lgkmcnt(3)
    s_nop 15
    s_nop 0
    v_mfma_f32_32x32x16_bf16 v[76:91], v[44:47], v[16:19], v[76:91]
    v_mfma_f32_32x32x16_bf16 v[92:107], v[44:47], v[20:23], v[92:107]
    s_nop 10
    v_max3_f32 v208, v76, v77, v78
    v_max3_f32 v208, v208, v79, v80
    v_max3_f32 v208, v208, v81, v82
    v_max3_f32 v208, v208, v83, v84
    v_max3_f32 v208, v208, v85, v86
    v_max3_f32 v208, v208, v87, v88
    v_max3_f32 v208, v208, v89, v90
    v_max_f32 v208, v208, v91
    v_max3_f32 v209, v92, v93, v94
    v_max3_f32 v209, v209, v95, v96
    v_max3_f32 v209, v209, v97, v98
    v_max3_f32 v209, v209, v99, v100
    v_max3_f32 v209, v209, v101, v102
    v_max3_f32 v209, v209, v103, v104
    v_max3_f32 v209, v209, v105, v106
    v_max_f32 v209, v209, v107
    v_mov_b32 v210, v208
    v_mov_b32 v211, v209
    s_nop 0
    v_permlane32_swap_b32 v208, v210
    v_permlane32_swap_b32 v209, v211
    v_min_f32_e64 v124, -v208, -v210
    v_min_f32_e64 v140, -v209, -v211
    v_min_f32_e64 v125, -v208, -v210
    v_min_f32_e64 v141, -v209, -v211
    v_pk_mov_b32 v[126:127], v[124:125], v[124:125]
    v_pk_mov_b32 v[128:129], v[124:125], v[124:125]
    v_pk_mov_b32 v[130:131], v[124:125], v[124:125]
    v_pk_mov_b32 v[132:133], v[124:125], v[124:125]
    v_pk_mov_b32 v[134:135], v[124:125], v[124:125]
    v_pk_mov_b32 v[136:137], v[124:125], v[124:125]
    v_pk_mov_b32 v[138:139], v[124:125], v[124:125]
    v_pk_mov_b32 v[142:143], v[140:141], v[140:141]
    v_pk_mov_b32 v[144:145], v[140:141], v[140:141]
    v_pk_mov_b32 v[146:147], v[140:141], v[140:141]
    v_pk_mov_b32 v[148:149], v[140:141], v[140:141]
    v_pk_mov_b32 v[150:151], v[140:141], v[140:141]
    v_pk_mov_b32 v[152:153], v[140:141], v[140:141]
    v_pk_mov_b32 v[154:155], v[140:141], v[140:141]
    v_pk_add_f32 v[76:77], v[76:77], v[124:125]
    v_pk_add_f32 v[78:79], v[78:79], v[124:125]
    v_pk_add_f32 v[80:81], v[80:81], v[124:125]
    v_pk_add_f32 v[82:83], v[82:83], v[124:125]
    v_pk_add_f32 v[84:85], v[84:85], v[124:125]
    v_pk_add_f32 v[86:87], v[86:87], v[124:125]
    v_pk_add_f32 v[88:89], v[88:89], v[124:125]
    v_pk_add_f32 v[90:91], v[90:91], v[124:125]
    v_pk_add_f32 v[92:93], v[92:93], v[140:141]
    v_pk_add_f32 v[94:95], v[94:95], v[140:141]
    v_pk_add_f32 v[96:97], v[96:97], v[140:141]
    v_pk_add_f32 v[98:99], v[98:99], v[140:141]
    v_pk_add_f32 v[100:101], v[100:101], v[140:141]
    v_pk_add_f32 v[102:103], v[102:103], v[140:141]
    v_pk_add_f32 v[104:105], v[104:105], v[140:141]
    v_pk_add_f32 v[106:107], v[106:107], v[140:141]
.p2align 6
kx_fused_kernel_loop56:
    v_mfma_f32_32x32x4_2b_bf16 v[216:247], v[54:55], v[24:25], v[124:155] cbsz:1 abid:0
    v_exp_f32 v76, v76
    v_exp_f32 v77, v77
    v_exp_f32 v78, v78
    v_exp_f32 v79, v79
    v_cvt_pk_bf16_f32 v108, v76, v77
    v_cvt_pk_bf16_f32 v109, v78, v79
    v_exp_f32 v80, v80
    v_exp_f32 v81, v81
    v_exp_f32 v82, v82
    v_exp_f32 v83, v83
    v_cvt_pk_bf16_f32 v110, v80, v81
    v_cvt_pk_bf16_f32 v111, v82, v83
    v_mfma_f32_32x32x16_bf16 v[172:187], v[68:71], v[116:119], v[172:187]
    v_exp_f32 v84, v84
    v_exp_f32 v85, v85
    v_exp_f32 v86, v86
    v_exp_f32 v87, v87
    v_cvt_pk_bf16_f32 v112, v84, v85
    v_cvt_pk_bf16_f32 v113, v86, v87
    v_mfma_f32_32x32x16_bf16 v[172:187], v[72:75], v[120:123], v[172:187]
    v_exp_f32 v88, v88
    v_exp_f32 v89, v89
    v_exp_f32 v90, v90
    v_exp_f32 v91, v91
    v_cvt_pk_bf16_f32 v114, v88, v89
    v_cvt_pk_bf16_f32 v115, v90, v91
    s_waitcnt lgkmcnt(0)
    v_mfma_f32_32x32x16_bf16 v[216:231], v[48:51], v[16:19], v[216:231]
    ds_read_b128 v[68:71], v207 offset:4416
    v_exp_f32 v92, v92
    v_exp_f32 v93, v93
    v_exp_f32 v94, v94
    v_exp_f32 v95, v95
    v_cvt_pk_bf16_f32 v116, v92, v93
    v_cvt_pk_bf16_f32 v117, v94, v95
    v_mfma_f32_32x32x16_bf16 v[156:171], v[60:63], v[108:111], v[156:171]
    ds_read_b128 v[72:75], v207 offset:5088
    v_exp_f32 v96, v96
    v_exp_f32 v97, v97
    v_exp_f32 v98, v98
    v_exp_f32 v99, v99
    v_cvt_pk_bf16_f32 v118, v96, v97
    v_cvt_pk_bf16_f32 v119, v98, v99
    v_mfma_f32_32x32x16_bf16 v[232:247], v[48:51], v[20:23], v[232:247]
    ds_read_b128 v[44:47], v205 offset:6144
    v_exp_f32 v100, v100
    v_exp_f32 v101, v101
    v_exp_f32 v102, v102
    v_exp_f32 v103, v103
    v_cvt_pk_bf16_f32 v120, v100, v101
    v_cvt_pk_bf16_f32 v121, v102, v103
    v_mfma_f32_32x32x16_bf16 v[156:171], v[64:67], v[112:115], v[156:171]
    v_exp_f32 v104, v104
    v_exp_f32 v105, v105
    v_exp_f32 v106, v106
    v_exp_f32 v107, v107
    v_cvt_pk_bf16_f32 v122, v104, v105
    v_cvt_pk_bf16_f32 v123, v106, v107
    v_mfma_f32_32x32x4_2b_bf16 v[76:107], v[52:53], v[24:25], v[124:155] cbsz:1 abid:1
    s_cmp_eq_u32 s27, 8
    v_exp_f32 v216, v216
    v_exp_f32 v217, v217
    v_exp_f32 v218, v218
    v_exp_f32 v219, v219
    v_cvt_pk_bf16_f32 v108, v216, v217
    v_cvt_pk_bf16_f32 v109, v218, v219
    s_cbranch_scc1 kx_fused_kernel_fl253
kx_fused_kernel_fl2b54:
    v_exp_f32 v220, v220
    v_exp_f32 v221, v221
    v_exp_f32 v222, v222
    v_exp_f32 v223, v223
    v_cvt_pk_bf16_f32 v110, v220, v221
    v_cvt_pk_bf16_f32 v111, v222, v223
    v_mfma_f32_32x32x16_bf16 v[172:187], v[60:63], v[116:119], v[172:187]
    v_exp_f32 v224, v224
    v_exp_f32 v225, v225
    v_exp_f32 v226, v226
    v_exp_f32 v227, v227
    v_cvt_pk_bf16_f32 v112, v224, v225
    v_cvt_pk_bf16_f32 v113, v226, v227
    v_mfma_f32_32x32x16_bf16 v[172:187], v[64:67], v[120:123], v[172:187]
    v_exp_f32 v228, v228
    v_exp_f32 v229, v229
    v_exp_f32 v230, v230
    v_exp_f32 v231, v231
    v_cvt_pk_bf16_f32 v114, v228, v229
    v_cvt_pk_bf16_f32 v115, v230, v231
    s_waitcnt lgkmcnt(0)
    v_mfma_f32_32x32x16_bf16 v[76:91], v[44:47], v[16:19], v[76:91]
    ds_read_b128 v[60:63], v207 offset:9216
    v_exp_f32 v232, v232
    v_exp_f32 v233, v233
    v_exp_f32 v234, v234
    v_exp_f32 v235, v235
    v_cvt_pk_bf16_f32 v116, v232, v233
    v_cvt_pk_bf16_f32 v117, v234, v235
    v_mfma_f32_32x32x16_bf16 v[156:171], v[68:71], v[108:111], v[156:171]
    ds_read_b128 v[64:67], v207 offset:9888
    v_exp_f32 v236, v236
    v_exp_f32 v237, v237
    v_exp_f32 v238, v238
    v_exp_f32 v239, v239
    v_cvt_pk_bf16_f32 v118, v236, v237
    v_cvt_pk_bf16_f32 v119, v238, v239
    v_mfma_f32_32x32x16_bf16 v[92:107], v[44:47], v[20:23], v[92:107]
    ds_read_b128 v[48:51], v205 offset:6656
    v_exp_f32 v240, v240
    v_exp_f32 v241, v241
    v_exp_f32 v242, v242
    v_exp_f32 v243, v243
    v_cvt_pk_bf16_f32 v120, v240, v241
    v_cvt_pk_bf16_f32 v121, v242, v243
    v_mfma_f32_32x32x16_bf16 v[156:171], v[72:75], v[112:115], v[156:171]
    v_exp_f32 v244, v244
    v_exp_f32 v245, v245
    v_exp_f32 v246, v246
    v_exp_f32 v247, v247
    v_cvt_pk_bf16_f32 v122, v244, v245
    v_cvt_pk_bf16_f32 v123, v246, v247
    v_mfma_f32_32x32x4_2b_bf16 v[216:247], v[54:55], v[24:25], v[124:155] cbsz:1 abid:1
    v_exp_f32 v76, v76
    v_exp_f32 v77, v77
    v_exp_f32 v78, v78
    v_exp_f32 v79, v79
    v_cvt_pk_bf16_f32 v108, v76, v77
    v_cvt_pk_bf16_f32 v109, v78, v79
    v_exp_f32 v80, v80
    v_exp_f32 v81, v81
    v_exp_f32 v82, v82
    v_exp_f32 v83, v83
    v_cvt_pk_bf16_f32 v110, v80, v81
    v_cvt_pk_bf16_f32 v111, v82, v83
    v_mfma_f32_32x32x16_bf16 v[172:187], v[68:71], v[116:119], v[172:187]
    v_exp_f32 v84, v84
    v_exp_f32 v85, v85
    v_exp_f32 v86, v86
    v_exp_f32 v87, v87
    v_cvt_pk_bf16_f32 v112, v84, v85
    v_cvt_pk_bf16_f32 v113, v86, v87
    v_mfma_f32_32x32x16_bf16 v[172:187], v[72:75], v[120:123], v[172:187]
    v_exp_f32 v88, v88
    v_exp_f32 v89, v89
    v_exp_f32 v90, v90
    v_exp_f32 v91, v91
    v_cvt_pk_bf16_f32 v114, v88, v89
    v_cvt_pk_bf16_f32 v115, v90, v91
    s_waitcnt lgkmcnt(0)
    v_mfma_f32_32x32x16_bf16 v[216:231], v[48:51], v[16:19], v[216:231]
    ds_read_b128 v[68:71], v207 offset:10560
    v_exp_f32 v92, v92
    v_exp_f32 v93, v93
    v_exp_f32 v94, v94
    v_exp_f32 v95, v95
    v_cvt_pk_bf16_f32 v116, v92, v93
    v_cvt_pk_bf16_f32 v117, v94, v95
    v_mfma_f32_32x32x16_bf16 v[156:171], v[60:63], v[108:111], v[156:171]
    ds_read_b128 v[72:75], v207 offset:11232
    v_exp_f32 v96, v96
    v_exp_f32 v97, v97
    v_exp_f32 v98, v98
    v_exp_f32 v99, v99
    v_cvt_pk_bf16_f32 v118, v96, v97
    v_cvt_pk_bf16_f32 v119, v98, v99
    v_mfma_f32_32x32x16_bf16 v[232:247], v[48:51], v[20:23], v[232:247]
    s_barrier
    ds_read2st64_b64 v[56:59], v206 offset0:24 offset1:25
    v_exp_f32 v100, v100
    v_exp_f32 v101, v101
    v_exp_f32 v102, v102
    v_exp_f32 v103, v103
    v_cvt_pk_bf16_f32 v120, v100, v101
    v_cvt_pk_bf16_f32 v121, v102, v103
    v_mfma_f32_32x32x16_bf16 v[156:171], v[64:67], v[112:115], v[156:171]
    ds_read_b128 v[44:47], v205 offset:12288
    v_exp_f32 v104, v104
    v_exp_f32 v105, v105
    v_exp_f32 v106, v106
    v_exp_f32 v107, v107
    v_cvt_pk_bf16_f32 v122, v104, v105
    v_cvt_pk_bf16_f32 v123, v106, v107
    s_waitcnt lgkmcnt(1)
    v_mfma_f32_32x32x4_2b_bf16 v[76:107], v[56:57], v[24:25], v[124:155] cbsz:1 abid:0
    v_exp_f32 v216, v216
    v_exp_f32 v217, v217
    v_exp_f32 v218, v218
    v_exp_f32 v219, v219
    v_cvt_pk_bf16_f32 v108, v216, v217
    v_cvt_pk_bf16_f32 v109, v218, v219
    v_exp_f32 v220, v220
    v_exp_f32 v221, v221
    v_exp_f32 v222, v222
    v_exp_f32 v223, v223
    v_cvt_pk_bf16_f32 v110, v220, v221
    v_cvt_pk_bf16_f32 v111, v222, v223
    v_mfma_f32_32x32x16_bf16 v[172:187], v[60:63], v[116:119], v[172:187]
    v_exp_f32 v224, v224
    v_exp_f32 v225, v225
    v_exp_f32 v226, v226
    v_exp_f32 v227, v227
    v_cvt_pk_bf16_f32 v112, v224, v225
    v_cvt_pk_bf16_f32 v113, v226, v227
    v_mfma_f32_32x32x16_bf16 v[172:187], v[64:67], v[120:123], v[172:187]
    v_exp_f32 v228, v228
    v_exp_f32 v229, v229
    v_exp_f32 v230, v230
    v_exp_f32 v231, v231
    v_cvt_pk_bf16_f32 v114, v228, v229
    v_cvt_pk_bf16_f32 v115, v230, v231
    s_waitcnt lgkmcnt(0)
    v_mfma_f32_32x32x16_bf16 v[76:91], v[44:47], v[16:19], v[76:91]
    ds_read_b128 v[60:63], v207 offset:15360
    v_exp_f32 v232, v232
    v_exp_f32 v233, v233
    v_exp_f32 v234, v234
    v_exp_f32 v235, v235
    v_cvt_pk_bf16_f32 v116, v232, v233
    v_cvt_pk_bf16_f32 v117, v234, v235
    v_mfma_f32_32x32x16_bf16 v[156:171], v[68:71], v[108:111], v[156:171]
    ds_read_b128 v[64:67], v207 offset:16032
    v_exp_f32 v236, v236
    v_exp_f32 v237, v237
    v_exp_f32 v238, v238
    v_exp_f32 v239, v239
    v_cvt_pk_bf16_f32 v118, v236, v237
    v_cvt_pk_bf16_f32 v119, v238, v239
    v_mfma_f32_32x32x16_bf16 v[92:107], v[44:47], v[20:23], v[92:107]
    ds_read_b128 v[48:51], v205 offset:12800
    v_exp_f32 v240, v240
    v_exp_f32 v241, v241
    v_exp_f32 v242, v242
    v_exp_f32 v243, v243
    v_cvt_pk_bf16_f32 v120, v240, v241
    v_cvt_pk_bf16_f32 v121, v242, v243
    v_mfma_f32_32x32x16_bf16 v[156:171], v[72:75], v[112:115], v[156:171]
    v_exp_f32 v244, v244
    v_exp_f32 v245, v245
    v_exp_f32 v246, v246
    v_exp_f32 v247, v247
    v_cvt_pk_bf16_f32 v122, v244, v245
    v_cvt_pk_bf16_f32 v123, v246, v247
    v_mfma_f32_32x32x4_2b_bf16 v[216:247], v[58:59], v[24:25], v[124:155] cbsz:1 abid:0
    v_exp_f32 v76, v76
    v_exp_f32 v77, v77
    v_exp_f32 v78, v78
    v_exp_f32 v79, v79
    v_cvt_pk_bf16_f32 v108, v76, v77
    v_cvt_pk_bf16_f32 v109, v78, v79
    v_exp_f32 v80, v80
    v_exp_f32 v81, v81
    v_exp_f32 v82, v82
    v_exp_f32 v83, v83
    v_cvt_pk_bf16_f32 v110, v80, v81
    v_cvt_pk_bf16_f32 v111, v82, v83
    v_mfma_f32_32x32x16_bf16 v[172:187], v[68:71], v[116:119], v[172:187]
    v_exp_f32 v84, v84
    v_exp_f32 v85, v85
    v_exp_f32 v86, v86
    v_exp_f32 v87, v87
    v_cvt_pk_bf16_f32 v112, v84, v85
    v_cvt_pk_bf16_f32 v113, v86, v87
    v_mfma_f32_32x32x16_bf16 v[172:187], v[72:75], v[120:123], v[172:187]
    v_exp_f32 v88, v88
    v_exp_f32 v89, v89
    v_exp_f32 v90, v90
    v_exp_f32 v91, v91
    v_cvt_pk_bf16_f32 v114, v88, v89
    v_cvt_pk_bf16_f32 v115, v90, v91
    s_waitcnt lgkmcnt(0)
    v_mfma_f32_32x32x16_bf16 v[216:231], v[48:51], v[16:19], v[216:231]
    ds_read_b128 v[68:71], v207 offset:16704
    v_exp_f32 v92, v92
    v_exp_f32 v93, v93
    v_exp_f32 v94, v94
    v_exp_f32 v95, v95
    v_cvt_pk_bf16_f32 v116, v92, v93
    v_cvt_pk_bf16_f32 v117, v94, v95
    v_mfma_f32_32x32x16_bf16 v[156:171], v[60:63], v[108:111], v[156:171]
    ds_read_b128 v[72:75], v207 offset:17376
    v_exp_f32 v96, v96
    v_exp_f32 v97, v97
    v_exp_f32 v98, v98
    v_exp_f32 v99, v99
    v_cvt_pk_bf16_f32 v118, v96, v97
    v_cvt_pk_bf16_f32 v119, v98, v99
    v_mfma_f32_32x32x16_bf16 v[232:247], v[48:51], v[20:23], v[232:247]
    ds_read_b128 v[44:47], v205 offset:18432
    v_exp_f32 v100, v100
    v_exp_f32 v101, v101
    v_exp_f32 v102, v102
    v_exp_f32 v103, v103
    v_cvt_pk_bf16_f32 v120, v100, v101
    v_cvt_pk_bf16_f32 v121, v102, v103
    v_mfma_f32_32x32x16_bf16 v[156:171], v[64:67], v[112:115], v[156:171]
    v_exp_f32 v104, v104
    v_exp_f32 v105, v105
    v_exp_f32 v106, v106
    v_exp_f32 v107, v107
    v_cvt_pk_bf16_f32 v122, v104, v105
    v_cvt_pk_bf16_f32 v123, v106, v107
    v_mfma_f32_32x32x4_2b_bf16 v[76:107], v[56:57], v[24:25], v[124:155] cbsz:1 abid:1
    v_exp_f32 v216, v216
    v_exp_f32 v217, v217
    v_exp_f32 v218, v218
    v_exp_f32 v219, v219
    v_cvt_pk_bf16_f32 v108, v216, v217
    v_cvt_pk_bf16_f32 v109, v218, v219
    v_exp_f32 v220, v220
    v_exp_f32 v221, v221
    v_exp_f32 v222, v222
    v_exp_f32 v223, v223
    v_cvt_pk_bf16_f32 v110, v220, v221
    v_cvt_pk_bf16_f32 v111, v222, v223
    v_mfma_f32_32x32x16_bf16 v[172:187], v[60:63], v[116:119], v[172:187]
    v_exp_f32 v224, v224
    v_exp_f32 v225, v225
    v_exp_f32 v226, v226
    v_exp_f32 v227, v227
    v_cvt_pk_bf16_f32 v112, v224, v225
    v_cvt_pk_bf16_f32 v113, v226, v227
    v_mfma_f32_32x32x16_bf16 v[172:187], v[64:67], v[120:123], v[172:187]
    v_exp_f32 v228, v228
    v_exp_f32 v229, v229
    v_exp_f32 v230, v230
    v_exp_f32 v231, v231
    v_cvt_pk_bf16_f32 v114, v228, v229
    v_cvt_pk_bf16_f32 v115, v230, v231
    s_waitcnt lgkmcnt(0)
    v_mfma_f32_32x32x16_bf16 v[76:91], v[44:47], v[16:19], v[76:91]
    ds_read_b128 v[60:63], v207 offset:21504
    v_exp_f32 v232, v232
    v_exp_f32 v233, v233
    v_exp_f32 v234, v234
    v_exp_f32 v235, v235
    v_cvt_pk_bf16_f32 v116, v232, v233
    v_cvt_pk_bf16_f32 v117, v234, v235
    v_mfma_f32_32x32x16_bf16 v[156:171], v[68:71], v[108:111], v[156:171]
    ds_read_b128 v[64:67], v207 offset:22176
    v_exp_f32 v236, v236
    v_exp_f32 v237, v237
    v_exp_f32 v238, v238
    v_exp_f32 v239, v239
    v_cvt_pk_bf16_f32 v118, v236, v237
    v_cvt_pk_bf16_f32 v119, v238, v239
    v_mfma_f32_32x32x16_bf16 v[92:107], v[44:47], v[20:23], v[92:107]
    ds_read_b128 v[48:51], v205 offset:18944
    v_exp_f32 v240, v240
    v_exp_f32 v241, v241
    v_exp_f32 v242, v242
    v_exp_f32 v243, v243
    v_cvt_pk_bf16_f32 v120, v240, v241
    v_cvt_pk_bf16_f32 v121, v242, v243
    v_mfma_f32_32x32x16_bf16 v[156:171], v[72:75], v[112:115], v[156:171]
    v_exp_f32 v244, v244
    v_exp_f32 v245, v245
    v_exp_f32 v246, v246
    v_exp_f32 v247, v247
    v_cvt_pk_bf16_f32 v122, v244, v245
    v_cvt_pk_bf16_f32 v123, v246, v247
    v_mfma_f32_32x32x4_2b_bf16 v[216:247], v[58:59], v[24:25], v[124:155] cbsz:1 abid:1
    s_xor_b32 s32, s32, 24576
    v_exp_f32 v76, v76
    v_exp_f32 v77, v77
    v_exp_f32 v78, v78
    v_exp_f32 v79, v79
    v_cvt_pk_bf16_f32 v108, v76, v77
    v_cvt_pk_bf16_f32 v109, v78, v79
    v_add_u32 v205, s32, v202
    v_exp_f32 v80, v80
    v_exp_f32 v81, v81
    v_exp_f32 v82, v82
    v_exp_f32 v83, v83
    v_cvt_pk_bf16_f32 v110, v80, v81
    v_cvt_pk_bf16_f32 v111, v82, v83
    v_mfma_f32_32x32x16_bf16 v[172:187], v[68:71], v[116:119], v[172:187]
    v_add_u32 v206, s32, v203
    v_exp_f32 v84, v84
    v_exp_f32 v85, v85
    v_exp_f32 v86, v86
    v_exp_f32 v87, v87
    v_cvt_pk_bf16_f32 v112, v84, v85
    v_cvt_pk_bf16_f32 v113, v86, v87
    v_mfma_f32_32x32x16_bf16 v[172:187], v[72:75], v[120:123], v[172:187]
    v_exp_f32 v88, v88
    v_exp_f32 v89, v89
    v_exp_f32 v90, v90
    v_exp_f32 v91, v91
    v_cvt_pk_bf16_f32 v114, v88, v89
    v_cvt_pk_bf16_f32 v115, v90, v91
    s_waitcnt lgkmcnt(0)
    v_mfma_f32_32x32x16_bf16 v[216:231], v[48:51], v[16:19], v[216:231]
    ds_read_b128 v[68:71], v207 offset:22848
    v_exp_f32 v92, v92
    v_exp_f32 v93, v93
    v_exp_f32 v94, v94
    v_exp_f32 v95, v95
    v_cvt_pk_bf16_f32 v116, v92, v93
    v_cvt_pk_bf16_f32 v117, v94, v95
    v_mfma_f32_32x32x16_bf16 v[156:171], v[60:63], v[108:111], v[156:171]
    ds_read_b128 v[72:75], v207 offset:23520
    v_exp_f32 v96, v96
    v_exp_f32 v97, v97
    v_exp_f32 v98, v98
    v_exp_f32 v99, v99
    v_cvt_pk_bf16_f32 v118, v96, v97
    v_cvt_pk_bf16_f32 v119, v98, v99
    v_mfma_f32_32x32x16_bf16 v[232:247], v[48:51], v[20:23], v[232:247]
    s_barrier
    ds_read2st64_b64 v[52:55], v206 offset0:0 offset1:1
    v_exp_f32 v100, v100
    v_exp_f32 v101, v101
    v_exp_f32 v102, v102
    v_exp_f32 v103, v103
    v_cvt_pk_bf16_f32 v120, v100, v101
    v_cvt_pk_bf16_f32 v121, v102, v103
    v_mfma_f32_32x32x16_bf16 v[156:171], v[64:67], v[112:115], v[156:171]
    ds_read_b128 v[44:47], v205 offset:0
    v_exp_f32 v104, v104
    v_exp_f32 v105, v105
    v_exp_f32 v106, v106
    v_exp_f32 v107, v107
    v_cvt_pk_bf16_f32 v122, v104, v105
    v_cvt_pk_bf16_f32 v123, v106, v107
    s_waitcnt lgkmcnt(1)
    v_mfma_f32_32x32x4_2b_bf16 v[76:107], v[52:53], v[24:25], v[124:155] cbsz:1 abid:0
    v_exp_f32 v216, v216
    v_exp_f32 v217, v217
    v_exp_f32 v218, v218
    v_exp_f32 v219, v219
    v_cvt_pk_bf16_f32 v108, v216, v217
    v_cvt_pk_bf16_f32 v109, v218, v219
    v_add_u32 v207, s32, v204
    v_exp_f32 v220, v220
    v_exp_f32 v221, v221
    v_exp_f32 v222, v222
    v_exp_f32 v223, v223
    v_cvt_pk_bf16_f32 v110, v220, v221
    v_cvt_pk_bf16_f32 v111, v222, v223
    v_mfma_f32_32x32x16_bf16 v[172:187], v[60:63], v[116:119], v[172:187]
    s_sub_u32 s27, s27, 1
    v_exp_f32 v224, v224
    v_exp_f32 v225, v225
    v_exp_f32 v226, v226
    v_exp_f32 v227, v227
    v_cvt_pk_bf16_f32 v112, v224, v225
    v_cvt_pk_bf16_f32 v113, v226, v227
    v_mfma_f32_32x32x16_bf16 v[172:187], v[64:67], v[120:123], v[172:187]
    s_cmp_lg_u32 s27, 0
    v_exp_f32 v228, v228
    v_exp_f32 v229, v229
    v_exp_f32 v230, v230
    v_exp_f32 v231, v231
    v_cvt_pk_bf16_f32 v114, v228, v229
    v_cvt_pk_bf16_f32 v115, v230, v231
    s_waitcnt lgkmcnt(0)
    v_mfma_f32_32x32x16_bf16 v[76:91], v[44:47], v[16:19], v[76:91]
    ds_read_b128 v[60:63], v207 offset:3072
    v_exp_f32 v232, v232
    v_exp_f32 v233, v233
    v_exp_f32 v234, v234
    v_exp_f32 v235, v235
    v_cvt_pk_bf16_f32 v116, v232, v233
    v_cvt_pk_bf16_f32 v117, v234, v235
    v_mfma_f32_32x32x16_bf16 v[156:171], v[68:71], v[108:111], v[156:171]
    ds_read_b128 v[64:67], v207 offset:3744
    v_exp_f32 v236, v236
    v_exp_f32 v237, v237
    v_exp_f32 v238, v238
    v_exp_f32 v239, v239
    v_cvt_pk_bf16_f32 v118, v236, v237
    v_cvt_pk_bf16_f32 v119, v238, v239
    v_mfma_f32_32x32x16_bf16 v[92:107], v[44:47], v[20:23], v[92:107]
    ds_read_b128 v[48:51], v205 offset:512
    v_exp_f32 v240, v240
    v_exp_f32 v241, v241
    v_exp_f32 v242, v242
    v_exp_f32 v243, v243
    v_cvt_pk_bf16_f32 v120, v240, v241
    v_cvt_pk_bf16_f32 v121, v242, v243
    v_mfma_f32_32x32x16_bf16 v[156:171], v[72:75], v[112:115], v[156:171]
    v_exp_f32 v244, v244
    v_exp_f32 v245, v245
    v_exp_f32 v246, v246
    v_exp_f32 v247, v247
    v_cvt_pk_bf16_f32 v122, v244, v245
    v_cvt_pk_bf16_f32 v123, v246, v247
    s_cbranch_scc1 kx_fused_kernel_loop56
    v_mfma_f32_32x32x16_bf16 v[172:187], v[68:71], v[116:119], v[172:187]
    v_mfma_f32_32x32x16_bf16 v[172:187], v[72:75], v[120:123], v[172:187]
    v_mov_b32 v2, 0x4e800000
    v_mov_b32 v3, 0
    v_mov_b32 v4, 0
    s_mul_i32 s16, s41, 2560
    s_add_u32 s16, s16, 8388608
    v_fmac_f32 v3, 0, v156
    v_fmac_f32 v4, 0, v157
    v_fmac_f32 v3, 0, v158
    v_fmac_f32 v4, 0, v159
    v_fmac_f32 v3, 0, v160
    v_fmac_f32 v4, 0, v161
    v_fmac_f32 v3, 0, v162
    v_fmac_f32 v4, 0, v163
    v_fmac_f32 v3, 0, v164
    v_fmac_f32 v4, 0, v165
    v_fmac_f32 v3, 0, v166
    v_fmac_f32 v4, 0, v167
    v_cmp_nle_f32 s[34:35], v168, v2
    v_fmac_f32 v3, 0, v172
    v_fmac_f32 v4, 0, v173
    v_fmac_f32 v3, 0, v174
    v_fmac_f32 v4, 0, v175
    v_fmac_f32 v3, 0, v176
    v_fmac_f32 v4, 0, v177
    v_fmac_f32 v3, 0, v178
    v_fmac_f32 v4, 0, v179
    v_fmac_f32 v3, 0, v180
    v_fmac_f32 v4, 0, v181
    v_fmac_f32 v3, 0, v182
    v_fmac_f32 v4, 0, v183
    v_cmp_nle_f32 s[36:37], v184, v2
    v_cmp_u_f32 vcc, v3, v4
    s_or_b64 s[34:35], s[34:35], s[36:37]
    s_or_b64 s[34:35], s[34:35], vcc
    s_cbranch_scc1 kx_fused_kernel_fallback59
kx_fused_kernel_epi60:
    v_rcp_f32 v168, v168
    s_nop 3
    v_rcp_f32 v184, v184
    s_waitcnt lgkmcnt(0)
    v_mul_f32 v156, v156, v168
    v_mul_f32 v157, v157, v168
    v_mul_f32 v158, v158, v168
    v_mul_f32 v159, v159, v168
    v_mul_f32 v160, v160, v168
    v_mul_f32 v161, v161, v168
    v_mul_f32 v162, v162, v168
    v_mul_f32 v163, v163, v168
    v_mul_f32 v164, v164, v168
    v_mul_f32 v165, v165, v168
    v_mul_f32 v166, v166, v168
    v_mul_f32 v167, v167, v168
    v_cvt_pk_bf16_f32 v156, v156, v157
    v_cvt_pk_bf16_f32 v157, v158, v159
    v_cvt_pk_bf16_f32 v158, v160, v161
    v_cvt_pk_bf16_f32 v159, v162, v163
    v_cvt_pk_bf16_f32 v160, v164, v165
    v_cvt_pk_bf16_f32 v161, v166, v167
    buffer_store_dwordx4 v[156:159], v212, s[20:23], s16 offen offset:0 sc1
    buffer_store_dwordx2 v[160:161], v213, s[20:23], s16 offen offset:2048 sc1
    v_mul_f32 v172, v172, v184
    v_mul_f32 v173, v173, v184
    v_mul_f32 v174, v174, v184
    v_mul_f32 v175, v175, v184
    v_mul_f32 v176, v176, v184
    v_mul_f32 v177, v177, v184
    v_mul_f32 v178, v178, v184
    v_mul_f32 v179, v179, v184
    v_mul_f32 v180, v180, v184
    v_mul_f32 v181, v181, v184
    v_mul_f32 v182, v182, v184
    v_mul_f32 v183, v183, v184
    v_cvt_pk_bf16_f32 v172, v172, v173
    v_cvt_pk_bf16_f32 v173, v174, v175
    v_cvt_pk_bf16_f32 v174, v176, v177
    v_cvt_pk_bf16_f32 v175, v178, v179
    v_cvt_pk_bf16_f32 v176, v180, v181
    v_cvt_pk_bf16_f32 v177, v182, v183
    buffer_store_dwordx4 v[172:175], v212, s[20:23], s16 offen offset:512 sc1
    buffer_store_dwordx2 v[176:177], v213, s[20:23], s16 offen offset:2304 sc1
    ds_read_b64_tr_b16 v[16:17], v6 offset:0
    ds_read_b64_tr_b16 v[18:19], v6 offset:1280
    ds_read_b64_tr_b16 v[20:21], v6 offset:32
    ds_read_b64_tr_b16 v[22:23], v6 offset:1312
    ds_read_b64_tr_b16 v[24:25], v6 offset:64
    ds_read_b64_tr_b16 v[26:27], v6 offset:1344
    ds_read_b64_tr_b16 v[28:29], v6 offset:96
    ds_read_b64_tr_b16 v[30:31], v6 offset:1376
    ds_read_b64_tr_b16 v[32:33], v6 offset:128
    ds_read_b64_tr_b16 v[34:35], v6 offset:1408
    ds_read_b64_tr_b16 v[36:37], v6 offset:6400
    ds_read_b64_tr_b16 v[38:39], v6 offset:7680
    ds_read_b64_tr_b16 v[40:41], v6 offset:6432
    ds_read_b64_tr_b16 v[42:43], v6 offset:7712
    ds_read_b64_tr_b16 v[44:45], v6 offset:6464
    ds_read_b64_tr_b16 v[46:47], v6 offset:7744
    ds_read_b64_tr_b16 v[48:49], v6 offset:6496
    ds_read_b64_tr_b16 v[50:51], v6 offset:7776
    ds_read_b64_tr_b16 v[52:53], v6 offset:6528
    ds_read_b64_tr_b16 v[54:55], v6 offset:7808
    ds_read_b64_tr_b16 v[56:57], v6 offset:12800
    ds_read_b64_tr_b16 v[58:59], v6 offset:14080
    ds_read_b64_tr_b16 v[60:61], v6 offset:12832
    ds_read_b64_tr_b16 v[62:63], v6 offset:14112
    ds_read_b64_tr_b16 v[64:65], v6 offset:12864
    ds_read_b64_tr_b16 v[66:67], v6 offset:14144
    ds_read_b64_tr_b16 v[68:69], v6 offset:12896
    ds_read_b64_tr_b16 v[70:71], v6 offset:14176
    ds_read_b64_tr_b16 v[72:73], v6 offset:12928
    ds_read_b64_tr_b16 v[74:75], v6 offset:14208
    ds_read_b64_tr_b16 v[76:77], v6 offset:19200
    ds_read_b64_tr_b16 v[78:79], v6 offset:20480
    ds_read_b64_tr_b16 v[80:81], v6 offset:19232
    ds_read_b64_tr_b16 v[82:83], v6 offset:20512
    ds_read_b64_tr_b16 v[84:85], v6 offset:19264
    ds_read_b64_tr_b16 v[86:87], v6 offset:20544
    ds_read_b64_tr_b16 v[88:89], v6 offset:19296
    ds_read_b64_tr_b16 v[90:91], v6 offset:20576
    ds_read_b64_tr_b16 v[92:93], v6 offset:19328
    ds_read_b64_tr_b16 v[94:95], v6 offset:20608
    ds_read_b64_tr_b16 v[96:97], v7 offset:2560
    ds_read_b64_tr_b16 v[98:99], v7 offset:15360
    ds_read_b64_tr_b16 v[100:101], v7 offset:2592
    ds_read_b64_tr_b16 v[102:103], v7 offset:15392
    ds_read_b64_tr_b16 v[104:105], v7 offset:2624
    ds_read_b64_tr_b16 v[106:107], v7 offset:15424
    ds_read_b64_tr_b16 v[108:109], v7 offset:2656
    ds_read_b64_tr_b16 v[110:111], v7 offset:15456
    ds_read_b64_tr_b16 v[112:113], v7 offset:2688
    ds_read_b64_tr_b16 v[114:115], v7 offset:15488
    s_load_dwordx2 s[44:45], s[0:1], 56
    s_sub_u32 s50, s14, 4
    s_lshl2_add_u32 s15, s28, s50
    s_mul_i32 s46, s15, 20480
    s_add_u32 s46, s46, 8388608
    s_add_u32 s47, s46, 5120
    s_add_u32 s48, s46, 10240
    s_add_u32 s49, s46, 15360
    s_lshl_b32 s15, s15, 10
    s_add_u32 s15, s15, 42336256
    v_and_b32 v2, 7, v1
    v_lshl_add_u32 v8, v2, 7, s15
    s_lshl_b32 s15, s24, 7
    s_add_u32 s15, s15, 42434560
    s_mov_b32 exec_lo, 0
    v_lshl_add_u32 v8, v1, 10, s15
    s_mov_b32 exec_lo, -1
    v_mov_b32 v11, 1
    v_lshrrev_b32 v2, 5, v1
    v_mul_u32_u24 v2, 2560, v2
    v_and_b32 v3, 16, v1
    v_lshl_add_u32 v2, v3, 6, v2
    v_and_b32 v3, 0xf0, v5
    v_add_u32 v12, v2, v3
    v_lshrrev_b32 v2, 4, v1
    v_mul_u32_u24 v2, 2560, v2
    v_lshrrev_b32 v3, 1, v3
    v_add_u32 v13, v2, v3
    s_mul_i32 s15, s50, 5376
    s_add_u32 s15, s15, 81920
    v_and_b32 v2, 15, v1
    v_mul_u32_u24 v2, 336, v2
    v_and_b32 v3, 48, v1
    v_add3_u32 v14, v2, v3, s15
    s_mul_i32 s52, s50, 20480
    v_add_u32 v15, s52, v5
    s_lshl_b32 s41, s41, 7
    s_add_u32 s41, s41, 42336256
    s_waitcnt lgkmcnt(0)
    s_barrier
    s_mov_b64 exec, 1
    s_waitcnt vmcnt(0)
    buffer_store_dword v11, off, s[20:23], s41 sc1
    s_mov_b64 exec, -1
    buffer_load_dwordx4 v[216:219], v5, s[20:23], s42 offen offset:0
    buffer_load_dwordx4 v[220:223], v5, s[20:23], s42 offen offset:1024
    buffer_load_dwordx4 v[224:227], v5, s[20:23], s42 offen offset:2048
    buffer_load_dwordx4 v[228:231], v5, s[20:23], s42 offen offset:3072
    s_add_u32 s42, s42, 4096
    buffer_load_dwordx4 v[232:235], v5, s[20:23], s42 offen offset:0
    buffer_load_dwordx4 v[236:239], v5, s[20:23], s42 offen offset:1024
    buffer_load_dwordx4 v[240:243], v5, s[20:23], s42 offen offset:2048
    buffer_load_dwordx4 v[244:247], v5, s[20:23], s42 offen offset:3072
    s_add_u32 s42, s42, 4096
    buffer_load_dwordx4 v[248:251], v5, s[20:23], s42 offen offset:0
    buffer_load_dwordx4 v[252:255], v5, s[20:23], s42 offen offset:1024
    s_mov_b32 s27, 65536
kx_fused_kernel_poll61:
    buffer_load_dword v10, v8, s[20:23], 0 offen sc1
    s_sub_u32 s27, s27, 1
    s_waitcnt vmcnt(0)
    s_cbranch_scc1 kx_fused_kernel_pollx62
kx_fused_kernel_pollc63:
    v_cmp_eq_u32 vcc, 0, v10
    s_cbranch_vccnz kx_fused_kernel_poll61
kx_fused_kernel_pollx62:
    buffer_load_dwordx4 v[116:119], v12, s[20:23], s46 offen offset:0 sc1
    buffer_load_dwordx4 v[120:123], v12, s[20:23], s47 offen offset:0 sc1
    buffer_load_dwordx4 v[124:127], v12, s[20:23], s48 offen offset:0 sc1
    buffer_load_dwordx4 v[128:131], v12, s[20:23], s49 offen offset:0 sc1
    buffer_load_dwordx2 v[132:133], v13, s[20:23], s46 offen offset:2048 sc1
    buffer_load_dwordx2 v[134:135], v13, s[20:23], s48 offen offset:2048 sc1
    buffer_load_dwordx4 v[136:139], v12, s[20:23], s46 offen offset:256 sc1
    buffer_load_dwordx4 v[140:143], v12, s[20:23], s47 offen offset:256 sc1
    buffer_load_dwordx4 v[144:147], v12, s[20:23], s48 offen offset:256 sc1
    buffer_load_dwordx4 v[148:151], v12, s[20:23], s49 offen offset:256 sc1
    buffer_load_dwordx2 v[152:153], v13, s[20:23], s46 offen offset:2176 sc1
    buffer_load_dwordx2 v[154:155], v13, s[20:23], s48 offen offset:2176 sc1
    buffer_load_dwordx4 v[156:159], v12, s[20:23], s46 offen offset:512 sc1
    buffer_load_dwordx4 v[160:163], v12, s[20:23], s47 offen offset:512 sc1
    buffer_load_dwordx4 v[164:167], v12, s[20:23], s48 offen offset:512 sc1
    buffer_load_dwordx4 v[168:171], v12, s[20:23], s49 offen offset:512 sc1
    buffer_load_dwordx2 v[172:173], v13, s[20:23], s46 offen offset:2304 sc1
    buffer_load_dwordx2 v[174:175], v13, s[20:23], s48 offen offset:2304 sc1
    buffer_load_dwordx4 v[176:179], v12, s[20:23], s46 offen offset:768 sc1
    buffer_load_dwordx4 v[180:183], v12, s[20:23], s47 offen offset:768 sc1
    buffer_load_dwordx4 v[184:187], v12, s[20:23], s48 offen offset:768 sc1
    buffer_load_dwordx4 v[188:191], v12, s[20:23], s49 offen offset:768 sc1
    buffer_load_dwordx2 v[192:193], v13, s[20:23], s46 offen offset:2432 sc1
    buffer_load_dwordx2 v[194:195], v13, s[20:23], s48 offen offset:2432 sc1
    v_cmp_ne_u32 vcc, s31, v10
    s_nop 0
    s_cmp_eq_u32 vcc_hi, 0
    s_cselect_b32 s26, 1, 0
    s_lshl2_add_u32 s15, s29, s50
    s_mul_i32 s51, s15, 20480
    s_add_u32 s51, s51, 11534336
    s_lshl_b32 s53, s15, 10
    s_add_u32 s53, s53, 42205184
    s_mov_b32 s56, s44
    s_mov_b32 s57, s45
    s_mov_b32 s58, 2621440
    s_mov_b32 s59, 0x20000
    s_and_b32 s16, s30, 1
    s_lshl1_add_u32 s15, s29, s16
    s_mul_i32 s60, s15, 98304
    s_mul_i32 s62, s15, 40960
    s_mul_i32 s15, s14, 6144
    s_add_u32 s60, s60, s15
    s_add_u32 s60, s60, 14680064
    s_mul_i32 s15, s14, 2560
    s_add_u32 s62, s62, s15
    s_mul_i32 s15, s13, 160
    s_add_u32 s62, s62, s15
    s_lshl3_add_u32 s61, s29, s13
    s_mul_i32 s61, s61, 10240
    s_lshl4_add_u32 s15, s16, s14
    s_lshl_b32 s15, s15, 5
    s_add_u32 s61, s61, s15
    s_add_u32 s61, s61, 11534336
    s_lshl_b32 s16, s29, 13
    s_add_u32 s16, s16, 41943040
    s_lshl3_add_u32 s15, s30, s14
    s_lshl_b32 s15, s15, 7
    s_add_u32 s63, s15, s16
    s_lshl_b32 s15, s14, 11
    s_add_u32 s15, s15, s16
    v_and_b32 v2, 15, v1
    v_lshl_add_u32 v6, v2, 7, s15
    s_mul_i32 s15, s14, 5376
    v_mul_u32_u24 v2, 336, v2
    v_and_b32 v3, 48, v1
    v_add3_u32 v7, v2, v3, s15
    v_min_u32 v2, 39, v1
    v_cmp_le_u32 vcc, 20, v2
    s_nop 1
    v_cndmask_b32_e64 v3, 0, 1, vcc
    v_mul_u32_u24 v4, 20, v3
    v_sub_u32 v2, v2, v4
    s_mul_i32 s15, s14, 672
    v_mul_u32_u24 v4, 336, v3
    v_lshl_add_u32 v4, v2, 4, v4
    v_add_u32 v8, s15, v4
    v_mul_u32_u24 v4, 1280, v3
    v_lshl_add_u32 v10, v2, 3, v4
    v_cmp_le_u32 vcc, 40, v1
    s_nop 1
    v_cndmask_b32_e64 v4, 0, 1, vcc
    v_lshl_add_u32 v10, v4, 30, v10
    v_lshrrev_b32 v4, 1, v2
    v_lshlrev_b32 v4, 10, v4
    v_lshl_add_u32 v4, v3, 4, v4
    v_and_b32 v2, 1, v2
    v_lshl_add_u32 v9, v2, 3, v4
    s_waitcnt vmcnt(23)
    v_mfma_f32_16x16x32_bf16 v[196:199], v[16:19], v[116:119], 0
    v_mfma_f32_16x16x32_bf16 v[200:203], v[20:23], v[116:119], 0
    v_mfma_f32_16x16x32_bf16 v[204:207], v[24:27], v[116:119], 0
    v_mfma_f32_16x16x32_bf16 v[208:211], v[28:31], v[116:119], 0
    v_mfma_f32_16x16x32_bf16 v[212:215], v[32:35], v[116:119], 0
    s_waitcnt vmcnt(22)
    v_mfma_f32_16x16x32_bf16 v[196:199], v[36:39], v[120:123], v[196:199]
    v_mfma_f32_16x16x32_bf16 v[200:203], v[40:43], v[120:123], v[200:203]
    v_mfma_f32_16x16x32_bf16 v[204:207], v[44:47], v[120:123], v[204:207]
    v_mfma_f32_16x16x32_bf16 v[208:211], v[48:51], v[120:123], v[208:211]
    v_mfma_f32_16x16x32_bf16 v[212:215], v[52:55], v[120:123], v[212:215]
    s_waitcnt vmcnt(21)
    v_mfma_f32_16x16x32_bf16 v[196:199], v[56:59], v[124:127], v[196:199]
    v_mfma_f32_16x16x32_bf16 v[200:203], v[60:63], v[124:127], v[200:203]
    v_mfma_f32_16x16x32_bf16 v[204:207], v[64:67], v[124:127], v[204:207]
    v_mfma_f32_16x16x32_bf16 v[208:211], v[68:71], v[124:127], v[208:211]
    v_mfma_f32_16x16x32_bf16 v[212:215], v[72:75], v[124:127], v[212:215]
    s_waitcnt vmcnt(20)
    v_mfma_f32_16x16x32_bf16 v[196:199], v[76:79], v[128:131], v[196:199]
    v_mfma_f32_16x16x32_bf16 v[200:203], v[80:83], v[128:131], v[200:203]
    v_mfma_f32_16x16x32_bf16 v[204:207], v[84:87], v[128:131], v[204:207]
    v_mfma_f32_16x16x32_bf16 v[208:211], v[88:91], v[128:131], v[208:211]
    v_mfma_f32_16x16x32_bf16 v[212:215], v[92:95], v[128:131], v[212:215]
    s_waitcnt vmcnt(18)
    v_mfma_f32_16x16x32_bf16 v[196:199], v[96:99], v[132:135], v[196:199]
    v_mfma_f32_16x16x32_bf16 v[200:203], v[100:103], v[132:135], v[200:203]
    v_mfma_f32_16x16x32_bf16 v[204:207], v[104:107], v[132:135], v[204:207]
    v_mfma_f32_16x16x32_bf16 v[208:211], v[108:111], v[132:135], v[208:211]
    v_mfma_f32_16x16x32_bf16 v[212:215], v[112:115], v[132:135], v[212:215]
    s_waitcnt vmcnt(17)
    v_mfma_f32_16x16x32_bf16 v[116:119], v[16:19], v[136:139], 0
    v_mfma_f32_16x16x32_bf16 v[120:123], v[20:23], v[136:139], 0
    v_mfma_f32_16x16x32_bf16 v[124:127], v[24:27], v[136:139], 0
    v_mfma_f32_16x16x32_bf16 v[128:131], v[28:31], v[136:139], 0
    ds_write_b128 v14, v[196:199] offset:0
    v_mfma_f32_16x16x32_bf16 v[132:135], v[32:35], v[136:139], 0
    ds_write_b128 v14, v[200:203] offset:64
    s_waitcnt vmcnt(16)
    v_mfma_f32_16x16x32_bf16 v[116:119], v[36:39], v[140:143], v[116:119]
    ds_write_b128 v14, v[204:207] offset:128
    v_mfma_f32_16x16x32_bf16 v[120:123], v[40:43], v[140:143], v[120:123]
    ds_write_b128 v14, v[208:211] offset:192
    v_mfma_f32_16x16x32_bf16 v[124:127], v[44:47], v[140:143], v[124:127]
    ds_write_b128 v14, v[212:215] offset:256
    v_mfma_f32_16x16x32_bf16 v[128:131], v[48:51], v[140:143], v[128:131]
    v_mfma_f32_16x16x32_bf16 v[132:135], v[52:55], v[140:143], v[132:135]
    s_waitcnt vmcnt(15)
    v_mfma_f32_16x16x32_bf16 v[116:119], v[56:59], v[144:147], v[116:119]
    v_mfma_f32_16x16x32_bf16 v[120:123], v[60:63], v[144:147], v[120:123]
    v_mfma_f32_16x16x32_bf16 v[124:127], v[64:67], v[144:147], v[124:127]
    s_waitcnt lgkmcnt(0)
    s_barrier
    v_mfma_f32_16x16x32_bf16 v[128:131], v[68:71], v[144:147], v[128:131]
    v_mfma_f32_16x16x32_bf16 v[132:135], v[72:75], v[144:147], v[132:135]
    s_waitcnt vmcnt(14)
    v_mfma_f32_16x16x32_bf16 v[116:119], v[76:79], v[148:151], v[116:119]
    v_mfma_f32_16x16x32_bf16 v[120:123], v[80:83], v[148:151], v[120:123]
    v_mfma_f32_16x16x32_bf16 v[124:127], v[84:87], v[148:151], v[124:127]
    v_mfma_f32_16x16x32_bf16 v[128:131], v[88:91], v[148:151], v[128:131]
    v_mfma_f32_16x16x32_bf16 v[132:135], v[92:95], v[148:151], v[132:135]
    s_waitcnt vmcnt(12)
    v_mfma_f32_16x16x32_bf16 v[116:119], v[96:99], v[152:155], v[116:119]
    v_mfma_f32_16x16x32_bf16 v[120:123], v[100:103], v[152:155], v[120:123]
    v_mfma_f32_16x16x32_bf16 v[124:127], v[104:107], v[152:155], v[124:127]
    v_mfma_f32_16x16x32_bf16 v[128:131], v[108:111], v[152:155], v[128:131]
    v_mfma_f32_16x16x32_bf16 v[132:135], v[112:115], v[152:155], v[132:135]
    s_waitcnt vmcnt(11)
    v_mfma_f32_16x16x32_bf16 v[196:199], v[16:19], v[156:159], 0
    v_mfma_f32_16x16x32_bf16 v[200:203], v[20:23], v[156:159], 0
    v_mfma_f32_16x16x32_bf16 v[204:207], v[24:27], v[156:159], 0
    v_mfma_f32_16x16x32_bf16 v[208:211], v[28:31], v[156:159], 0
    ds_write_b128 v14, v[116:119] offset:21504
    v_mfma_f32_16x16x32_bf16 v[212:215], v[32:35], v[156:159], 0
    ds_write_b128 v14, v[120:123] offset:21568
    s_waitcnt vmcnt(10)
    v_mfma_f32_16x16x32_bf16 v[196:199], v[36:39], v[160:163], v[196:199]
    ds_write_b128 v14, v[124:127] offset:21632
    v_mfma_f32_16x16x32_bf16 v[200:203], v[40:43], v[160:163], v[200:203]
    ds_write_b128 v14, v[128:131] offset:21696
    v_mfma_f32_16x16x32_bf16 v[204:207], v[44:47], v[160:163], v[204:207]
    ds_write_b128 v14, v[132:135] offset:21760
    v_mfma_f32_16x16x32_bf16 v[208:211], v[48:51], v[160:163], v[208:211]
    v_mfma_f32_16x16x32_bf16 v[212:215], v[52:55], v[160:163], v[212:215]
    s_waitcnt vmcnt(9)
    v_mfma_f32_16x16x32_bf16 v[196:199], v[56:59], v[164:167], v[196:199]
    v_mfma_f32_16x16x32_bf16 v[200:203], v[60:63], v[164:167], v[200:203]
    v_mfma_f32_16x16x32_bf16 v[204:207], v[64:67], v[164:167], v[204:207]
    s_waitcnt lgkmcnt(0)
    s_barrier
    v_mfma_f32_16x16x32_bf16 v[208:211], v[68:71], v[164:167], v[208:211]
    v_mfma_f32_16x16x32_bf16 v[212:215], v[72:75], v[164:167], v[212:215]
    s_waitcnt vmcnt(8)
    v_mfma_f32_16x16x32_bf16 v[196:199], v[76:79], v[168:171], v[196:199]
    v_mfma_f32_16x16x32_bf16 v[200:203], v[80:83], v[168:171], v[200:203]
    v_mfma_f32_16x16x32_bf16 v[204:207], v[84:87], v[168:171], v[204:207]
    v_mfma_f32_16x16x32_bf16 v[208:211], v[88:91], v[168:171], v[208:211]
    v_mfma_f32_16x16x32_bf16 v[212:215], v[92:95], v[168:171], v[212:215]
    s_waitcnt vmcnt(6)
    v_mfma_f32_16x16x32_bf16 v[196:199], v[96:99], v[172:175], v[196:199]
    v_mfma_f32_16x16x32_bf16 v[200:203], v[100:103], v[172:175], v[200:203]
    v_mfma_f32_16x16x32_bf16 v[204:207], v[104:107], v[172:175], v[204:207]
    v_mfma_f32_16x16x32_bf16 v[208:211], v[108:111], v[172:175], v[208:211]
    v_mfma_f32_16x16x32_bf16 v[212:215], v[112:115], v[172:175], v[212:215]
    s_waitcnt vmcnt(5)
    v_mfma_f32_16x16x32_bf16 v[116:119], v[16:19], v[176:179], 0
    v_mfma_f32_16x16x32_bf16 v[120:123], v[20:23], v[176:179], 0
    v_mfma_f32_16x16x32_bf16 v[124:127], v[24:27], v[176:179], 0
    v_mfma_f32_16x16x32_bf16 v[128:131], v[28:31], v[176:179], 0
    ds_write_b128 v14, v[196:199] offset:43008
    v_mfma_f32_16x16x32_bf16 v[132:135], v[32:35], v[176:179], 0
    ds_write_b128 v14, v[200:203] offset:43072
    s_waitcnt vmcnt(4)
    v_mfma_f32_16x16x32_bf16 v[116:119], v[36:39], v[180:183], v[116:119]
    ds_write_b128 v14, v[204:207] offset:43136
    v_mfma_f32_16x16x32_bf16 v[120:123], v[40:43], v[180:183], v[120:123]
    ds_write_b128 v14, v[208:211] offset:43200
    v_mfma_f32_16x16x32_bf16 v[124:127], v[44:47], v[180:183], v[124:127]
    ds_write_b128 v14, v[212:215] offset:43264
    v_mfma_f32_16x16x32_bf16 v[128:131], v[48:51], v[180:183], v[128:131]
    v_mfma_f32_16x16x32_bf16 v[132:135], v[52:55], v[180:183], v[132:135]
    s_waitcnt vmcnt(3)
    v_mfma_f32_16x16x32_bf16 v[116:119], v[56:59], v[184:187], v[116:119]
    v_mfma_f32_16x16x32_bf16 v[120:123], v[60:63], v[184:187], v[120:123]
    v_mfma_f32_16x16x32_bf16 v[124:127], v[64:67], v[184:187], v[124:127]
    s_waitcnt lgkmcnt(0)
    s_barrier
    v_mfma_f32_16x16x32_bf16 v[128:131], v[68:71], v[184:187], v[128:131]
    ds_read_b128 v[16:19], v15 offset:0
    v_mfma_f32_16x16x32_bf16 v[132:135], v[72:75], v[184:187], v[132:135]
    ds_read_b128 v[20:23], v15 offset:1024
    s_waitcnt vmcnt(2)
    v_mfma_f32_16x16x32_bf16 v[116:119], v[76:79], v[188:191], v[116:119]
    ds_read_b128 v[24:27], v15 offset:2048
    v_mfma_f32_16x16x32_bf16 v[120:123], v[80:83], v[188:191], v[120:123]
    ds_read_b128 v[28:31], v15 offset:3072
    v_mfma_f32_16x16x32_bf16 v[124:127], v[84:87], v[188:191], v[124:127]
    ds_read_b128 v[32:35], v15 offset:4096
    v_mfma_f32_16x16x32_bf16 v[128:131], v[88:91], v[188:191], v[128:131]
    ds_read_b128 v[36:39], v15 offset:5120
    v_mfma_f32_16x16x32_bf16 v[132:135], v[92:95], v[188:191], v[132:135]
    ds_read_b128 v[40:43], v15 offset:6144
    s_waitcnt vmcnt(0)
    v_mfma_f32_16x16x32_bf16 v[116:119], v[96:99], v[192:195], v[116:119]
    ds_read_b128 v[44:47], v15 offset:7168
    v_mfma_f32_16x16x32_bf16 v[120:123], v[100:103], v[192:195], v[120:123]
    ds_read_b128 v[48:51], v15 offset:8192
    v_mfma_f32_16x16x32_bf16 v[124:127], v[104:107], v[192:195], v[124:127]
    ds_read_b128 v[52:55], v15 offset:9216
    v_mfma_f32_16x16x32_bf16 v[128:131], v[108:111], v[192:195], v[128:131]
    ds_read_b128 v[56:59], v15 offset:10240
    v_mfma_f32_16x16x32_bf16 v[132:135], v[112:115], v[192:195], v[132:135]
    ds_read_b128 v[60:63], v15 offset:11264
    v_mov_b32 v112, 0x3f803f80
    v_mov_b32 v113, 0x3f803f80
    v_mov_b32 v114, 0x3f803f80
    v_mov_b32 v115, 0x3f803f80
    ds_write_b128 v14, v[116:119] offset:0
    ds_write_b128 v14, v[120:123] offset:64
    ds_write_b128 v14, v[124:127] offset:128
    ds_write_b128 v14, v[128:131] offset:192
    ds_write_b128 v14, v[132:135] offset:256
    s_waitcnt lgkmcnt(0)
    s_barrier
    ds_read_b128 v[64:67], v15 offset:12288
    ds_read_b128 v[68:71], v15 offset:13312
    ds_read_b128 v[72:75], v15 offset:14336
    ds_read_b128 v[76:79], v15 offset:15360
    ds_read_b128 v[80:83], v15 offset:16384
    ds_read_b128 v[84:87], v15 offset:17408
    ds_read_b128 v[88:91], v15 offset:18432
    ds_read_b128 v[92:95], v15 offset:19456
    v_mfma_f32_16x16x32_bf16 v[144:147], v[16:19], v[112:115], 0
    v_mfma_f32_16x16x32_bf16 v[144:147], v[20:23], v[112:115], v[144:147]
    v_mfma_f32_16x16x32_bf16 v[144:147], v[24:27], v[112:115], v[144:147]
    v_mfma_f32_16x16x32_bf16 v[144:147], v[28:31], v[112:115], v[144:147]
    v_mfma_f32_16x16x32_bf16 v[144:147], v[32:35], v[112:115], v[144:147]
    v_mfma_f32_16x16x32_bf16 v[144:147], v[36:39], v[112:115], v[144:147]
    v_mfma_f32_16x16x32_bf16 v[144:147], v[40:43], v[112:115], v[144:147]
    v_mfma_f32_16x16x32_bf16 v[144:147], v[44:47], v[112:115], v[144:147]
    v_mfma_f32_16x16x32_bf16 v[144:147], v[48:51], v[112:115], v[144:147]
    v_mfma_f32_16x16x32_bf16 v[144:147], v[52:55], v[112:115], v[144:147]
    v_mfma_f32_16x16x32_bf16 v[144:147], v[56:59], v[112:115], v[144:147]
    v_mfma_f32_16x16x32_bf16 v[144:147], v[60:63], v[112:115], v[144:147]
    s_waitcnt lgkmcnt(7)
    v_mfma_f32_16x16x32_bf16 v[144:147], v[64:67], v[112:115], v[144:147]
    s_waitcnt lgkmcnt(6)
    v_mfma_f32_16x16x32_bf16 v[144:147], v[68:71], v[112:115], v[144:147]
    s_waitcnt lgkmcnt(5)
    v_mfma_f32_16x16x32_bf16 v[144:147], v[72:75], v[112:115], v[144:147]
    s_waitcnt lgkmcnt(4)
    v_mfma_f32_16x16x32_bf16 v[144:147], v[76:79], v[112:115], v[144:147]
    s_waitcnt lgkmcnt(3)
    v_mfma_f32_16x16x32_bf16 v[144:147], v[80:83], v[112:115], v[144:147]
    s_waitcnt lgkmcnt(2)
    v_mfma_f32_16x16x32_bf16 v[144:147], v[84:87], v[112:115], v[144:147]
    s_waitcnt lgkmcnt(1)
    v_mfma_f32_16x16x32_bf16 v[144:147], v[88:91], v[112:115], v[144:147]
    s_waitcnt lgkmcnt(0)
    v_mfma_f32_16x16x32_bf16 v[144:147], v[92:95], v[112:115], v[144:147]
    v_and_b32 v2, 7, v1
    v_and_b32 v3, 8, v1
    v_lshl_add_u32 v2, v3, 2, v2
    v_lshl_add_u32 v170, v2, 7, s53
    v_lshrrev_b32 v4, 4, v1
    v_mul_u32_u24 v2, 49152, v4
    v_and_b32 v3, 0xf0, v5
    v_add_u32 v13, v2, v3
    v_mul_u32_u24 v2, 20480, v4
    v_add_u32 v15, v2, v3
    v_add_u32 v14, 81920, v15
    v_and_b32 v12, 0x2f0, v5
    v_add_u32 v12, 81920, v12
    s_lshl2_add_u32 s15, s30, s50
    s_mul_i32 s53, s15, 768
    s_mul_i32 s15, s29, 196608
    s_add_u32 s53, s53, s15
    s_add_u32 s53, s53, 14680576
    s_lshr_b32 s15, s50, 1
    s_add_u32 s16, s15, s29
    s_lshl_b32 s46, s16, 13
    s_and_b32 s16, s50, 1
    s_lshl3_add_u32 s15, s15, s16
    s_lshl_b32 s15, s15, 7
    s_add_u32 s15, s15, 81920
    s_lshl_b32 s16, s16, 8
    s_add_u32 s46, s46, s16
    s_add_u32 s46, s46, 40894464
    s_add_u32 s47, s46, 4096
    v_and_b32 v2, 32, v1
    v_add_lshl_u32 v168, v2, v1, 3
    v_and_b32 v2, 24, v1
    v_and_b32 v3, 7, v1
    v_lshl_add_u32 v2, v2, 1, v3
    v_lshl_add_u32 v169, v2, 4, s15
    v_mov_b32 v148, v144
    v_mov_b32 v149, v145
    v_mov_b32 v150, v146
    v_mov_b32 v151, v147
    s_barrier
    buffer_load_dword v4, v170, s[20:23], 0 offen sc1
    v_permlane32_swap_b32 v144, v148
    v_permlane32_swap_b32 v145, v149
    v_permlane32_swap_b32 v146, v150
    v_permlane32_swap_b32 v147, v151
    s_mov_b32 s27, 65536
    s_waitcnt vmcnt(0)
    s_branch kx_fused_kernel_pollc66
kx_fused_kernel_poll64:
    buffer_load_dword v4, v170, s[20:23], 0 offen sc1
    s_sub_u32 s27, s27, 1
    s_waitcnt vmcnt(0)
    s_cbranch_scc1 kx_fused_kernel_pollx65
kx_fused_kernel_pollc66:
    v_cmp_eq_u32 vcc, 0, v4
    s_cbranch_vccnz kx_fused_kernel_poll64
kx_fused_kernel_pollx65:
    s_add_u32 m0, s52, 81920
    s_nop 0
    buffer_load_dwordx4 v5, s[20:23], s51 offen offset:0 sc1 lds
    buffer_load_dwordx4 v5, s[20:23], s51 offen offset:1024 sc1 lds
    buffer_load_dwordx4 v5, s[20:23], s51 offen offset:2048 sc1 lds
    buffer_load_dwordx4 v5, s[20:23], s51 offen offset:3072 sc1 lds
    s_add_u32 s51, s51, 4096
    s_add_u32 m0, s52, 86016
    s_nop 0
    buffer_load_dwordx4 v5, s[20:23], s51 offen offset:0 sc1 lds
    buffer_load_dwordx4 v5, s[20:23], s51 offen offset:1024 sc1 lds
    buffer_load_dwordx4 v5, s[20:23], s51 offen offset:2048 sc1 lds
    buffer_load_dwordx4 v5, s[20:23], s51 offen offset:3072 sc1 lds
    s_add_u32 s51, s51, 4096
    s_add_u32 m0, s52, 90112
    s_nop 0
    buffer_load_dwordx4 v5, s[20:23], s51 offen offset:0 sc1 lds
    buffer_load_dwordx4 v5, s[20:23], s51 offen offset:1024 sc1 lds
    s_waitcnt vmcnt(7)
    s_barrier
    ds_read_b128 v[112:115], v14 offset:0
    ds_read_b128 v[116:119], v14 offset:256
    ds_read_b128 v[120:123], v14 offset:512
    ds_read_b128 v[124:127], v14 offset:768
    ds_read_b128 v[128:131], v14 offset:1024
    ds_read_b128 v[132:135], v14 offset:1280
    ds_read_b128 v[136:139], v14 offset:1536
    ds_read_b128 v[140:143], v14 offset:1792
    buffer_load_dwordx4 v5, s[20:23], s51 offen offset:2048 sc1 lds
    buffer_load_dwordx4 v5, s[20:23], s51 offen offset:3072 sc1 lds
    s_add_u32 s51, s51, 4096
    s_add_u32 m0, s52, 94208
    s_nop 0
    buffer_load_dwordx4 v5, s[20:23], s51 offen offset:0 sc1 lds
    buffer_load_dwordx4 v5, s[20:23], s51 offen offset:1024 sc1 lds
    buffer_load_dwordx4 v5, s[20:23], s51 offen offset:2048 sc1 lds
    buffer_load_dwordx4 v5, s[20:23], s51 offen offset:3072 sc1 lds
    s_add_u32 s51, s51, 4096
    s_waitcnt vmcnt(6)
    s_waitcnt lgkmcnt(0)
    s_barrier
    s_add_u32 m0, s52, 98304
    s_nop 0
    buffer_load_dwordx4 v5, s[20:23], s51 offen offset:0 sc1 lds
    buffer_load_dwordx4 v5, s[20:23], s51 offen offset:1024 sc1 lds
    buffer_load_dwordx4 v5, s[20:23], s51 offen offset:2048 sc1 lds
    buffer_load_dwordx4 v5, s[20:23], s51 offen offset:3072 sc1 lds
    s_add_u32 s51, s51, 65536
    buffer_load_dwordx2 v[96:97], v168, s[20:23], s46 offen offset:0 sc1
    buffer_load_dwordx2 v[98:99], v168, s[20:23], s46 offen offset:1024 sc1
    buffer_load_dwordx2 v[100:101], v168, s[20:23], s46 offen offset:2048 sc1
    buffer_load_dwordx2 v[102:103], v168, s[20:23], s46 offen offset:3072 sc1
    buffer_load_dwordx2 v[104:105], v168, s[20:23], s47 offen offset:0 sc1
    buffer_load_dwordx2 v[106:107], v168, s[20:23], s47 offen offset:1024 sc1
    buffer_load_dwordx2 v[108:109], v168, s[20:23], s47 offen offset:2048 sc1
    buffer_load_dwordx2 v[110:111], v168, s[20:23], s47 offen offset:3072 sc1
    s_add_u32 m0, s52, 0
    s_nop 0
    buffer_load_dwordx4 v5, s[20:23], s51 offen offset:0 sc1 lds
    buffer_load_dwordx4 v5, s[20:23], s51 offen offset:1024 sc1 lds
    buffer_load_dwordx4 v5, s[20:23], s51 offen offset:2048 sc1 lds
    buffer_load_dwordx4 v5, s[20:23], s51 offen offset:3072 sc1 lds
    s_add_u32 s51, s51, 4096
    s_waitcnt vmcnt(12)
    s_barrier
    s_add_u32 m0, s52, 4096
    s_nop 0
    buffer_load_dwordx4 v5, s[20:23], s51 offen offset:0 sc1 lds
    buffer_load_dwordx4 v5, s[20:23], s51 offen offset:1024 sc1 lds
    buffer_load_dwordx4 v5, s[20:23], s51 offen offset:2048 sc1 lds
    buffer_load_dwordx4 v5, s[20:23], s51 offen offset:3072 sc1 lds
    s_add_u32 s51, s51, 4096
    s_waitcnt vmcnt(11)
    v_add_f32 v96, v96, v104
    v_add_f32 v97, v97, v105
    s_waitcnt vmcnt(10)
    v_add_f32 v98, v98, v106
    v_add_f32 v99, v99, v107
    s_waitcnt vmcnt(9)
    v_add_f32 v100, v100, v108
    v_add_f32 v101, v101, v109
    s_waitcnt vmcnt(8)
    v_add_f32 v102, v102, v110
    v_add_f32 v103, v103, v111
    v_add_f32 v96, v96, v100
    v_add_f32 v97, v97, v101
    v_add_f32 v98, v98, v102
    v_add_f32 v99, v99, v103
    v_add_f32 v96, v96, v98
    v_add_f32 v97, v97, v99
    v_mov_b32 v98, v96
    v_mov_b32 v99, v97
    s_nop 0
    v_permlane32_swap_b32 v96, v98
    v_permlane32_swap_b32 v97, v99
    v_add_f32 v96, v96, v98
    v_add_f32 v97, v97, v99
    v_mul_f32 v101, 0xbacccccd, v96
    v_mul_f32 v102, 0x3acccccd, v97
    v_fma_f32 v102, -v101, v101, v102
    v_max_f32 v102, 0, v102
    v_add_f32 v102, 0x3727c5ac, v102
    v_rsq_f32 v100, v102
    s_nop 0
    v_mul_f32 v100, 0xbfb8aa3b, v100
    ds_write_b96 v169, v[100:102]
    s_waitcnt lgkmcnt(0)
    s_barrier
    v_mfma_f32_16x16x32_bf16 v[96:99], v[16:19], v[112:115], 0
    ds_read_b128 v[112:115], v14 offset:2048
    s_add_u32 m0, s52, 8192
    s_nop 0
    buffer_load_dwordx4 v5, s[20:23], s51 offen offset:0 sc1 lds
    v_mfma_f32_16x16x32_bf16 v[100:103], v[16:19], v[116:119], 0
    ds_read_b128 v[116:119], v14 offset:2304
    v_mfma_f32_16x16x32_bf16 v[104:107], v[16:19], v[120:123], 0
    ds_read_b128 v[120:123], v14 offset:2560
    v_mfma_f32_16x16x32_bf16 v[108:111], v[16:19], v[124:127], 0
    ds_read_b128 v[124:127], v14 offset:2816
    buffer_load_dwordx4 v5, s[20:23], s51 offen offset:1024 sc1 lds
    v_mfma_f32_16x16x32_bf16 v[96:99], v[20:23], v[128:131], v[96:99]
    ds_read_b128 v[128:131], v14 offset:3072
    v_mfma_f32_16x16x32_bf16 v[100:103], v[20:23], v[132:135], v[100:103]
    ds_read_b128 v[132:135], v14 offset:3328
    v_mfma_f32_16x16x32_bf16 v[104:107], v[20:23], v[136:139], v[104:107]
    ds_read_b128 v[136:139], v14 offset:3584
    v_mfma_f32_16x16x32_bf16 v[108:111], v[20:23], v[140:143], v[108:111]
    ds_read_b128 v[140:143], v14 offset:3840
    buffer_load_dwordx4 v5, s[20:23], s51 offen offset:2048 sc1 lds
    s_waitcnt lgkmcnt(7)
    v_mfma_f32_16x16x32_bf16 v[96:99], v[24:27], v[112:115], v[96:99]
    ds_read_b128 v[112:115], v14 offset:4096
    s_waitcnt lgkmcnt(7)
    v_mfma_f32_16x16x32_bf16 v[100:103], v[24:27], v[116:119], v[100:103]
    ds_read_b128 v[116:119], v14 offset:4352
    s_waitcnt lgkmcnt(7)
    v_mfma_f32_16x16x32_bf16 v[104:107], v[24:27], v[120:123], v[104:107]
    ds_read_b128 v[120:123], v14 offset:4608
    s_waitcnt lgkmcnt(7)
    v_mfma_f32_16x16x32_bf16 v[108:111], v[24:27], v[124:127], v[108:111]
    ds_read_b128 v[124:127], v14 offset:4864
    buffer_load_dwordx4 v5, s[20:23], s51 offen offset:3072 sc1 lds
    s_add_u32 s51, s51, 4096
    s_waitcnt lgkmcnt(7)
    v_mfma_f32_16x16x32_bf16 v[96:99], v[28:31], v[128:131], v[96:99]
    ds_read_b128 v[128:131], v14 offset:5120
    s_waitcnt lgkmcnt(7)
    v_mfma_f32_16x16x32_bf16 v[100:103], v[28:31], v[132:135], v[100:103]
    ds_read_b128 v[132:135], v14 offset:5376
    s_waitcnt lgkmcnt(7)
    v_mfma_f32_16x16x32_bf16 v[104:107], v[28:31], v[136:139], v[104:107]
    ds_read_b128 v[136:139], v14 offset:5632
    s_waitcnt lgkmcnt(7)
    v_mfma_f32_16x16x32_bf16 v[108:111], v[28:31], v[140:143], v[108:111]
    ds_read_b128 v[140:143], v14 offset:5888
    s_add_u32 m0, s52, 12288
    s_nop 0
    buffer_load_dwordx4 v5, s[20:23], s51 offen offset:0 sc1 lds
    s_waitcnt lgkmcnt(7)
    v_mfma_f32_16x16x32_bf16 v[96:99], v[32:35], v[112:115], v[96:99]
    ds_read_b128 v[112:115], v14 offset:6144
    s_waitcnt lgkmcnt(7)
    v_mfma_f32_16x16x32_bf16 v[100:103], v[32:35], v[116:119], v[100:103]
    ds_read_b128 v[116:119], v14 offset:6400
    s_waitcnt lgkmcnt(7)
    v_mfma_f32_16x16x32_bf16 v[104:107], v[32:35], v[120:123], v[104:107]
    ds_read_b128 v[120:123], v14 offset:6656
    s_waitcnt lgkmcnt(7)
    v_mfma_f32_16x16x32_bf16 v[108:111], v[32:35], v[124:127], v[108:111]
    ds_read_b128 v[124:127], v14 offset:6912
    buffer_load_dwordx4 v5, s[20:23], s51 offen offset:1024 sc1 lds
    s_waitcnt lgkmcnt(7)
    v_mfma_f32_16x16x32_bf16 v[96:99], v[36:39], v[128:131], v[96:99]
    ds_read_b128 v[128:131], v14 offset:7168
    s_waitcnt lgkmcnt(7)
    v_mfma_f32_16x16x32_bf16 v[100:103], v[36:39], v[132:135], v[100:103]
    ds_read_b128 v[132:135], v14 offset:7424
    s_waitcnt lgkmcnt(7)
    v_mfma_f32_16x16x32_bf16 v[104:107], v[36:39], v[136:139], v[104:107]
    ds_read_b128 v[136:139], v14 offset:7680
    buffer_load_dwordx4 v5, s[20:23], s51 offen offset:2048 sc1 lds
    s_waitcnt lgkmcnt(7)
    v_mfma_f32_16x16x32_bf16 v[108:111], v[36:39], v[140:143], v[108:111]
    ds_read_b128 v[140:143], v14 offset:7936
    s_waitcnt lgkmcnt(7)
    v_mfma_f32_16x16x32_bf16 v[96:99], v[40:43], v[112:115], v[96:99]
    ds_read_b128 v[112:115], v14 offset:8192
    s_waitcnt lgkmcnt(7)
    v_mfma_f32_16x16x32_bf16 v[100:103], v[40:43], v[116:119], v[100:103]
    ds_read_b128 v[116:119], v14 offset:8448
    s_waitcnt lgkmcnt(7)
    v_mfma_f32_16x16x32_bf16 v[104:107], v[40:43], v[120:123], v[104:107]
    ds_read_b128 v[120:123], v14 offset:8704
    buffer_load_dwordx4 v5, s[20:23], s51 offen offset:3072 sc1 lds
    s_add_u32 s51, s51, 4096
    s_waitcnt lgkmcnt(7)
    v_mfma_f32_16x16x32_bf16 v[108:111], v[40:43], v[124:127], v[108:111]
    ds_read_b128 v[124:127], v14 offset:8960
    s_waitcnt lgkmcnt(7)
    v_mfma_f32_16x16x32_bf16 v[96:99], v[44:47], v[128:131], v[96:99]
    ds_read_b128 v[128:131], v14 offset:9216
    s_waitcnt lgkmcnt(7)
    v_mfma_f32_16x16x32_bf16 v[100:103], v[44:47], v[132:135], v[100:103]
    ds_read_b128 v[132:135], v14 offset:9472
    s_waitcnt lgkmcnt(7)
    v_mfma_f32_16x16x32_bf16 v[104:107], v[44:47], v[136:139], v[104:107]
    ds_read_b128 v[136:139], v14 offset:9728
    s_add_u32 m0, s52, 16384
    s_nop 0
    buffer_load_dwordx4 v5, s[20:23], s51 offen offset:0 sc1 lds
    s_waitcnt lgkmcnt(7)
    v_mfma_f32_16x16x32_bf16 v[108:111], v[44:47], v[140:143], v[108:111]
    ds_read_b128 v[140:143], v14 offset:9984
    s_waitcnt lgkmcnt(7)
    v_mfma_f32_16x16x32_bf16 v[96:99], v[48:51], v[112:115], v[96:99]
    ds_read_b128 v[112:115], v14 offset:10240
    s_waitcnt lgkmcnt(7)
    v_mfma_f32_16x16x32_bf16 v[100:103], v[48:51], v[116:119], v[100:103]
    ds_read_b128 v[116:119], v14 offset:10496
    s_waitcnt lgkmcnt(7)
    v_mfma_f32_16x16x32_bf16 v[104:107], v[48:51], v[120:123], v[104:107]
    ds_read_b128 v[120:123], v14 offset:10752
    buffer_load_dwordx4 v5, s[20:23], s51 offen offset:1024 sc1 lds
    s_waitcnt lgkmcnt(7)
    v_mfma_f32_16x16x32_bf16 v[108:111], v[48:51], v[124:127], v[108:111]
    ds_read_b128 v[124:127], v14 offset:11008
    s_waitcnt lgkmcnt(7)
    v_mfma_f32_16x16x32_bf16 v[96:99], v[52:55], v[128:131], v[96:99]
    ds_read_b128 v[128:131], v14 offset:11264
    s_waitcnt lgkmcnt(7)
    v_mfma_f32_16x16x32_bf16 v[100:103], v[52:55], v[132:135], v[100:103]
    ds_read_b128 v[132:135], v14 offset:11520
    s_waitcnt lgkmcnt(7)
    v_mfma_f32_16x16x32_bf16 v[104:107], v[52:55], v[136:139], v[104:107]
    ds_read_b128 v[136:139], v14 offset:11776
    buffer_load_dwordx4 v5, s[20:23], s51 offen offset:2048 sc1 lds
    s_waitcnt lgkmcnt(7)
    v_mfma_f32_16x16x32_bf16 v[108:111], v[52:55], v[140:143], v[108:111]
    ds_read_b128 v[140:143], v14 offset:12032
    s_waitcnt lgkmcnt(7)
    v_mfma_f32_16x16x32_bf16 v[96:99], v[56:59], v[112:115], v[96:99]
    ds_read_b128 v[112:115], v14 offset:12288
    s_waitcnt lgkmcnt(7)
    v_mfma_f32_16x16x32_bf16 v[100:103], v[56:59], v[116:119], v[100:103]
    ds_read_b128 v[116:119], v14 offset:12544
    buffer_load_dwordx4 v5, s[20:23], s51 offen offset:3072 sc1 lds
    s_add_u32 s51, s51, 65536
    s_waitcnt lgkmcnt(7)
    v_mfma_f32_16x16x32_bf16 v[104:107], v[56:59], v[120:123], v[104:107]
    ds_read_b128 v[120:123], v14 offset:12800
    s_waitcnt lgkmcnt(7)
    v_mfma_f32_16x16x32_bf16 v[108:111], v[56:59], v[124:127], v[108:111]
    ds_read_b128 v[124:127], v14 offset:13056
    s_waitcnt lgkmcnt(7)
    v_mfma_f32_16x16x32_bf16 v[96:99], v[60:63], v[128:131], v[96:99]
    ds_read_b128 v[128:131], v14 offset:13312
    s_waitcnt lgkmcnt(7)
    v_mfma_f32_16x16x32_bf16 v[100:103], v[60:63], v[132:135], v[100:103]
    ds_read_b128 v[132:135], v14 offset:13568
    buffer_load_dwordx4 v[152:155], v5, s[20:23], s42 offen offset:2048
    s_waitcnt lgkmcnt(7)
    v_mfma_f32_16x16x32_bf16 v[104:107], v[60:63], v[136:139], v[104:107]
    ds_read_b128 v[136:139], v14 offset:13824
    s_waitcnt lgkmcnt(7)
    v_mfma_f32_16x16x32_bf16 v[108:111], v[60:63], v[140:143], v[108:111]
    ds_read_b128 v[140:143], v14 offset:14080
    s_waitcnt lgkmcnt(7)
    v_mfma_f32_16x16x32_bf16 v[96:99], v[64:67], v[112:115], v[96:99]
    ds_read_b128 v[112:115], v14 offset:14336
    s_waitcnt lgkmcnt(7)
    v_mfma_f32_16x16x32_bf16 v[100:103], v[64:67], v[116:119], v[100:103]
    ds_read_b128 v[116:119], v14 offset:14592
    buffer_load_dwordx4 v[156:159], v5, s[20:23], s42 offen offset:3072
    s_add_u32 s42, s42, 4096
    s_waitcnt lgkmcnt(7)
    v_mfma_f32_16x16x32_bf16 v[104:107], v[64:67], v[120:123], v[104:107]
    ds_read_b128 v[120:123], v14 offset:14848
    s_waitcnt lgkmcnt(7)
    v_mfma_f32_16x16x32_bf16 v[108:111], v[64:67], v[124:127], v[108:111]
    ds_read_b128 v[124:127], v14 offset:15104
    s_waitcnt lgkmcnt(7)
    v_mfma_f32_16x16x32_bf16 v[96:99], v[68:71], v[128:131], v[96:99]
    ds_read_b128 v[128:131], v14 offset:15360
    s_waitcnt lgkmcnt(7)
    v_mfma_f32_16x16x32_bf16 v[100:103], v[68:71], v[132:135], v[100:103]
    ds_read_b128 v[132:135], v14 offset:15616
    buffer_load_dwordx4 v[160:163], v5, s[20:23], s42 offen offset:0
    s_waitcnt lgkmcnt(7)
    v_mfma_f32_16x16x32_bf16 v[104:107], v[68:71], v[136:139], v[104:107]
    ds_read_b128 v[136:139], v14 offset:15872
    s_waitcnt lgkmcnt(7)
    v_mfma_f32_16x16x32_bf16 v[108:111], v[68:71], v[140:143], v[108:111]
    ds_read_b128 v[140:143], v14 offset:16128
    s_waitcnt lgkmcnt(7)
    v_mfma_f32_16x16x32_bf16 v[96:99], v[72:75], v[112:115], v[96:99]
    ds_read_b128 v[112:115], v14 offset:16384
    s_waitcnt lgkmcnt(7)
    v_mfma_f32_16x16x32_bf16 v[100:103], v[72:75], v[116:119], v[100:103]
    ds_read_b128 v[116:119], v14 offset:16640
    buffer_load_dwordx4 v[164:167], v5, s[20:23], s42 offen offset:1024
    s_waitcnt lgkmcnt(7)
    v_mfma_f32_16x16x32_bf16 v[104:107], v[72:75], v[120:123], v[104:107]
    ds_read_b128 v[120:123], v14 offset:16896
    s_waitcnt lgkmcnt(7)
    v_mfma_f32_16x16x32_bf16 v[108:111], v[72:75], v[124:127], v[108:111]
    ds_read_b128 v[124:127], v14 offset:17152
    s_waitcnt lgkmcnt(7)
    v_mfma_f32_16x16x32_bf16 v[96:99], v[76:79], v[128:131], v[96:99]
    ds_read_b128 v[128:131], v14 offset:17408
    buffer_load_dwordx4 v[168:171], v5, s[20:23], s42 offen offset:2048
    s_waitcnt lgkmcnt(7)
    v_mfma_f32_16x16x32_bf16 v[100:103], v[76:79], v[132:135], v[100:103]
    ds_read_b128 v[132:135], v14 offset:17664
    s_waitcnt lgkmcnt(7)
    v_mfma_f32_16x16x32_bf16 v[104:107], v[76:79], v[136:139], v[104:107]
    ds_read_b128 v[136:139], v14 offset:17920
    s_waitcnt lgkmcnt(7)
    v_mfma_f32_16x16x32_bf16 v[108:111], v[76:79], v[140:143], v[108:111]
    ds_read_b128 v[140:143], v14 offset:18176
    s_waitcnt lgkmcnt(7)
    v_mfma_f32_16x16x32_bf16 v[96:99], v[80:83], v[112:115], v[96:99]
    ds_read_b128 v[112:115], v14 offset:18432
    buffer_load_dwordx4 v[172:175], v5, s[20:23], s42 offen offset:3072
    s_add_u32 s42, s42, 4096
    s_waitcnt lgkmcnt(7)
    v_mfma_f32_16x16x32_bf16 v[100:103], v[80:83], v[116:119], v[100:103]
    ds_read_b128 v[116:119], v14 offset:18688
    s_waitcnt lgkmcnt(7)
    v_mfma_f32_16x16x32_bf16 v[104:107], v[80:83], v[120:123], v[104:107]
    ds_read_b128 v[120:123], v14 offset:18944
    s_waitcnt lgkmcnt(7)
    v_mfma_f32_16x16x32_bf16 v[108:111], v[80:83], v[124:127], v[108:111]
    ds_read_b128 v[124:127], v14 offset:19200
    s_waitcnt lgkmcnt(7)
    v_mfma_f32_16x16x32_bf16 v[96:99], v[84:87], v[128:131], v[96:99]
    ds_read_b128 v[128:131], v14 offset:19456
    buffer_load_dwordx4 v[176:179], v5, s[20:23], s42 offen offset:0
    s_waitcnt lgkmcnt(7)
    v_mfma_f32_16x16x32_bf16 v[100:103], v[84:87], v[132:135], v[100:103]
    ds_read_b128 v[132:135], v14 offset:19712
    s_waitcnt lgkmcnt(7)
    v_mfma_f32_16x16x32_bf16 v[104:107], v[84:87], v[136:139], v[104:107]
    ds_read_b128 v[136:139], v14 offset:19968
    s_waitcnt lgkmcnt(7)
    v_mfma_f32_16x16x32_bf16 v[108:111], v[84:87], v[140:143], v[108:111]
    ds_read_b128 v[140:143], v14 offset:20224
    s_waitcnt lgkmcnt(7)
    v_mfma_f32_16x16x32_bf16 v[96:99], v[88:91], v[112:115], v[96:99]
    buffer_load_dwordx4 v[180:183], v5, s[20:23], s42 offen offset:1024
    s_waitcnt lgkmcnt(6)
    v_mfma_f32_16x16x32_bf16 v[100:103], v[88:91], v[116:119], v[100:103]
    s_waitcnt lgkmcnt(5)
    v_mfma_f32_16x16x32_bf16 v[104:107], v[88:91], v[120:123], v[104:107]
    s_waitcnt lgkmcnt(4)
    v_mfma_f32_16x16x32_bf16 v[108:111], v[88:91], v[124:127], v[108:111]
    s_waitcnt lgkmcnt(3)
    v_mfma_f32_16x16x32_bf16 v[96:99], v[92:95], v[128:131], v[96:99]
    s_waitcnt lgkmcnt(2)
    v_mfma_f32_16x16x32_bf16 v[100:103], v[92:95], v[132:135], v[100:103]
    s_waitcnt lgkmcnt(1)
    v_mfma_f32_16x16x32_bf16 v[104:107], v[92:95], v[136:139], v[104:107]
    s_waitcnt lgkmcnt(0)
    v_mfma_f32_16x16x32_bf16 v[108:111], v[92:95], v[140:143], v[108:111]
    s_setprio 0
    ds_read_b96 v[112:114], v12 offset:0
    ds_read_b96 v[116:118], v12 offset:256
    s_nop 2
    v_permlane32_swap_b32 v96, v104
    v_permlane32_swap_b32 v97, v105
    v_permlane32_swap_b32 v98, v106
    v_permlane32_swap_b32 v99, v107
    v_permlane32_swap_b32 v100, v108
    v_permlane32_swap_b32 v101, v109
    v_permlane32_swap_b32 v102, v110
    v_permlane32_swap_b32 v103, v111
    s_waitcnt lgkmcnt(1)
    v_fmac_f32 v96, v144, v113
    v_fmac_f32 v97, v145, v113
    v_fmac_f32 v98, v146, v113
    v_fmac_f32 v99, v147, v113
    s_waitcnt lgkmcnt(0)
    v_fmac_f32 v100, v144, v117
    v_fmac_f32 v101, v145, v117
    v_fmac_f32 v102, v146, v117
    v_fmac_f32 v103, v147, v117
    v_mul_f32 v120, v96, v112
    v_mul_f32 v121, v97, v112
    v_mul_f32 v122, v98, v112
    v_mul_f32 v123, v99, v112
    v_mul_f32 v124, v100, v116
    v_mul_f32 v125, v101, v116
    v_mul_f32 v126, v102, v116
    v_mul_f32 v127, v103, v116
    v_exp_f32 v120, v120
    v_fmac_f32 v104, v148, v113
    v_exp_f32 v121, v121
    v_fmac_f32 v105, v149, v113
    v_exp_f32 v122, v122
    v_fmac_f32 v106, v150, v113
    v_exp_f32 v123, v123
    v_fmac_f32 v107, v151, v113
    v_exp_f32 v124, v124
    v_fmac_f32 v108, v148, v117
    v_exp_f32 v125, v125
    v_fmac_f32 v109, v149, v117
    v_exp_f32 v126, v126
    v_fmac_f32 v110, v150, v117
    v_exp_f32 v127, v127
    v_fmac_f32 v111, v151, v117
    v_fma_f32 v120, v120, v114, v114
    v_fma_f32 v121, v121, v114, v114
    v_fma_f32 v122, v122, v114, v114
    v_fma_f32 v123, v123, v114, v114
    v_fma_f32 v124, v124, v118, v118
    v_fma_f32 v125, v125, v118, v118
    v_fma_f32 v126, v126, v118, v118
    v_fma_f32 v127, v127, v118, v118
    v_rcp_f32 v120, v120
    v_mul_f32 v96, v96, v104
    v_rcp_f32 v121, v121
    v_mul_f32 v97, v97, v105
    v_rcp_f32 v122, v122
    v_mul_f32 v98, v98, v106
    v_rcp_f32 v123, v123
    v_mul_f32 v99, v99, v107
    v_rcp_f32 v124, v124
    v_mul_f32 v100, v100, v108
    v_rcp_f32 v125, v125
    v_mul_f32 v101, v101, v109
    v_rcp_f32 v126, v126
    v_mul_f32 v102, v102, v110
    v_rcp_f32 v127, v127
    v_mul_f32 v103, v103, v111
    v_mul_f32 v96, v96, v120
    v_mul_f32 v97, v97, v121
    v_mul_f32 v98, v98, v122
    v_mul_f32 v99, v99, v123
    v_mul_f32 v100, v100, v124
    v_mul_f32 v101, v101, v125
    v_mul_f32 v102, v102, v126
    v_mul_f32 v103, v103, v127
    v_cvt_pk_bf16_f32 v128, v96, v97
    v_cvt_pk_bf16_f32 v130, v100, v101
    v_cvt_pk_bf16_f32 v129, v98, v99
    v_cvt_pk_bf16_f32 v131, v102, v103
    v_permlane16_swap_b32 v128, v130
    s_nop 0
    v_permlane16_swap_b32 v129, v131
    buffer_store_dwordx4 v[128:131], v13, s[20:23], s53 offen sc1
    s_add_u32 s53, s53, 196608
    s_setprio 2
    s_waitcnt vmcnt(9)
    s_barrier
    ds_read_b128 v[112:115], v15 offset:0
    ds_read_b128 v[116:119], v15 offset:256
    ds_read_b128 v[120:123], v15 offset:512
    ds_read_b128 v[124:127], v15 offset:768
    ds_read_b128 v[128:131], v15 offset:1024
    ds_read_b128 v[132:135], v15 offset:1280
    ds_read_b128 v[136:139], v15 offset:1536
    ds_read_b128 v[140:143], v15 offset:1792
    s_waitcnt lgkmcnt(7)
    v_mfma_f32_16x16x32_bf16 v[96:99], v[16:19], v[112:115], 0
    ds_read_b128 v[112:115], v15 offset:2048
    buffer_load_dwordx4 v[184:187], v5, s[20:23], s42 offen offset:2048
    s_waitcnt lgkmcnt(7)
    v_mfma_f32_16x16x32_bf16 v[100:103], v[16:19], v[116:119], 0
    ds_read_b128 v[116:119], v15 offset:2304
    s_waitcnt lgkmcnt(7)
    v_mfma_f32_16x16x32_bf16 v[104:107], v[16:19], v[120:123], 0
    ds_read_b128 v[120:123], v15 offset:2560
    s_waitcnt lgkmcnt(7)
    v_mfma_f32_16x16x32_bf16 v[108:111], v[16:19], v[124:127], 0
    ds_read_b128 v[124:127], v15 offset:2816
    s_waitcnt lgkmcnt(7)
    v_mfma_f32_16x16x32_bf16 v[96:99], v[20:23], v[128:131], v[96:99]
    ds_read_b128 v[128:131], v15 offset:3072
    s_waitcnt lgkmcnt(7)
    v_mfma_f32_16x16x32_bf16 v[100:103], v[20:23], v[132:135], v[100:103]
    ds_read_b128 v[132:135], v15 offset:3328
    buffer_load_dwordx4 v[188:191], v5, s[20:23], s42 offen offset:3072
    s_add_u32 s42, s42, 4096
    s_waitcnt lgkmcnt(7)
    v_mfma_f32_16x16x32_bf16 v[104:107], v[20:23], v[136:139], v[104:107]
    ds_read_b128 v[136:139], v15 offset:3584
    s_waitcnt lgkmcnt(7)
    v_mfma_f32_16x16x32_bf16 v[108:111], v[20:23], v[140:143], v[108:111]
    ds_read_b128 v[140:143], v15 offset:3840
    s_waitcnt lgkmcnt(7)
    v_mfma_f32_16x16x32_bf16 v[96:99], v[24:27], v[112:115], v[96:99]
    ds_read_b128 v[112:115], v15 offset:4096
    s_waitcnt lgkmcnt(7)
    v_mfma_f32_16x16x32_bf16 v[100:103], v[24:27], v[116:119], v[100:103]
    ds_read_b128 v[116:119], v15 offset:4352
    s_waitcnt lgkmcnt(7)
    v_mfma_f32_16x16x32_bf16 v[104:107], v[24:27], v[120:123], v[104:107]
    ds_read_b128 v[120:123], v15 offset:4608
    buffer_load_dwordx4 v[192:195], v5, s[20:23], s42 offen offset:0
    s_waitcnt lgkmcnt(7)
    v_mfma_f32_16x16x32_bf16 v[108:111], v[24:27], v[124:127], v[108:111]
    ds_read_b128 v[124:127], v15 offset:4864
    s_waitcnt lgkmcnt(7)
    v_mfma_f32_16x16x32_bf16 v[96:99], v[28:31], v[128:131], v[96:99]
    ds_read_b128 v[128:131], v15 offset:5120
    s_waitcnt lgkmcnt(7)
    v_mfma_f32_16x16x32_bf16 v[100:103], v[28:31], v[132:135], v[100:103]
    ds_read_b128 v[132:135], v15 offset:5376
    s_waitcnt lgkmcnt(7)
    v_mfma_f32_16x16x32_bf16 v[104:107], v[28:31], v[136:139], v[104:107]
    ds_read_b128 v[136:139], v15 offset:5632
    s_waitcnt lgkmcnt(7)
    v_mfma_f32_16x16x32_bf16 v[108:111], v[28:31], v[140:143], v[108:111]
    ds_read_b128 v[140:143], v15 offset:5888
    buffer_load_dwordx4 v[196:199], v5, s[20:23], s42 offen offset:1024
    s_waitcnt lgkmcnt(7)
    v_mfma_f32_16x16x32_bf16 v[96:99], v[32:35], v[112:115], v[96:99]
    ds_read_b128 v[112:115], v15 offset:6144
    s_waitcnt lgkmcnt(7)
    v_mfma_f32_16x16x32_bf16 v[100:103], v[32:35], v[116:119], v[100:103]
    ds_read_b128 v[116:119], v15 offset:6400
    s_waitcnt lgkmcnt(7)
    v_mfma_f32_16x16x32_bf16 v[104:107], v[32:35], v[120:123], v[104:107]
    ds_read_b128 v[120:123], v15 offset:6656
    s_waitcnt lgkmcnt(7)
    v_mfma_f32_16x16x32_bf16 v[108:111], v[32:35], v[124:127], v[108:111]
    ds_read_b128 v[124:127], v15 offset:6912
    s_waitcnt lgkmcnt(7)
    v_mfma_f32_16x16x32_bf16 v[96:99], v[36:39], v[128:131], v[96:99]
    ds_read_b128 v[128:131], v15 offset:7168
    buffer_load_dwordx4 v[200:203], v5, s[20:23], s42 offen offset:2048
    s_waitcnt lgkmcnt(7)
    v_mfma_f32_16x16x32_bf16 v[100:103], v[36:39], v[132:135], v[100:103]
    ds_read_b128 v[132:135], v15 offset:7424
    s_waitcnt lgkmcnt(7)
    v_mfma_f32_16x16x32_bf16 v[104:107], v[36:39], v[136:139], v[104:107]
    ds_read_b128 v[136:139], v15 offset:7680
    s_waitcnt lgkmcnt(7)
    v_mfma_f32_16x16x32_bf16 v[108:111], v[36:39], v[140:143], v[108:111]
    ds_read_b128 v[140:143], v15 offset:7936
    s_waitcnt lgkmcnt(7)
    v_mfma_f32_16x16x32_bf16 v[96:99], v[40:43], v[112:115], v[96:99]
    ds_read_b128 v[112:115], v15 offset:8192
    s_waitcnt lgkmcnt(7)
    v_mfma_f32_16x16x32_bf16 v[100:103], v[40:43], v[116:119], v[100:103]
    ds_read_b128 v[116:119], v15 offset:8448
    buffer_load_dwordx4 v[204:207], v5, s[20:23], s42 offen offset:3072
    s_add_u32 s42, s42, 4096
    s_waitcnt lgkmcnt(7)
    v_mfma_f32_16x16x32_bf16 v[104:107], v[40:43], v[120:123], v[104:107]
    ds_read_b128 v[120:123], v15 offset:8704
    s_waitcnt lgkmcnt(7)
    v_mfma_f32_16x16x32_bf16 v[108:111], v[40:43], v[124:127], v[108:111]
    ds_read_b128 v[124:127], v15 offset:8960
    s_waitcnt lgkmcnt(7)
    v_mfma_f32_16x16x32_bf16 v[96:99], v[44:47], v[128:131], v[96:99]
    ds_read_b128 v[128:131], v15 offset:9216
    s_waitcnt lgkmcnt(7)
    v_mfma_f32_16x16x32_bf16 v[100:103], v[44:47], v[132:135], v[100:103]
    ds_read_b128 v[132:135], v15 offset:9472
    s_waitcnt lgkmcnt(7)
    v_mfma_f32_16x16x32_bf16 v[104:107], v[44:47], v[136:139], v[104:107]
    ds_read_b128 v[136:139], v15 offset:9728
    buffer_load_dwordx4 v[208:211], v5, s[20:23], s42 offen offset:0
    s_waitcnt lgkmcnt(7)
    v_mfma_f32_16x16x32_bf16 v[108:111], v[44:47], v[140:143], v[108:111]
    ds_read_b128 v[140:143], v15 offset:9984
    s_waitcnt lgkmcnt(7)
    v_mfma_f32_16x16x32_bf16 v[96:99], v[48:51], v[112:115], v[96:99]
    ds_read_b128 v[112:115], v15 offset:10240
    s_waitcnt lgkmcnt(7)
    v_mfma_f32_16x16x32_bf16 v[100:103], v[48:51], v[116:119], v[100:103]
    ds_read_b128 v[116:119], v15 offset:10496
    s_waitcnt lgkmcnt(7)
    v_mfma_f32_16x16x32_bf16 v[104:107], v[48:51], v[120:123], v[104:107]
    ds_read_b128 v[120:123], v15 offset:10752
    s_waitcnt lgkmcnt(7)
    v_mfma_f32_16x16x32_bf16 v[108:111], v[48:51], v[124:127], v[108:111]
    ds_read_b128 v[124:127], v15 offset:11008
    buffer_load_dwordx4 v[212:215], v5, s[20:23], s42 offen offset:1024
    s_waitcnt lgkmcnt(7)
    v_mfma_f32_16x16x32_bf16 v[96:99], v[52:55], v[128:131], v[96:99]
    ds_read_b128 v[128:131], v15 offset:11264
    s_waitcnt lgkmcnt(7)
    v_mfma_f32_16x16x32_bf16 v[100:103], v[52:55], v[132:135], v[100:103]
    ds_read_b128 v[132:135], v15 offset:11520
    s_waitcnt lgkmcnt(7)
    v_mfma_f32_16x16x32_bf16 v[104:107], v[52:55], v[136:139], v[104:107]
    ds_read_b128 v[136:139], v15 offset:11776
    s_waitcnt lgkmcnt(7)
    v_mfma_f32_16x16x32_bf16 v[108:111], v[52:55], v[140:143], v[108:111]
    ds_read_b128 v[140:143], v15 offset:12032
    s_waitcnt lgkmcnt(7)
    v_mfma_f32_16x16x32_bf16 v[96:99], v[56:59], v[112:115], v[96:99]
    ds_read_b128 v[112:115], v15 offset:12288
    buffer_load_dwordx4 v[16:19], v5, s[20:23], s42 offen offset:2048
    s_waitcnt lgkmcnt(7)
    v_mfma_f32_16x16x32_bf16 v[100:103], v[56:59], v[116:119], v[100:103]
    ds_read_b128 v[116:119], v15 offset:12544
    s_waitcnt lgkmcnt(7)
    v_mfma_f32_16x16x32_bf16 v[104:107], v[56:59], v[120:123], v[104:107]
    ds_read_b128 v[120:123], v15 offset:12800
    s_waitcnt lgkmcnt(7)
    v_mfma_f32_16x16x32_bf16 v[108:111], v[56:59], v[124:127], v[108:111]
    ds_read_b128 v[124:127], v15 offset:13056
    s_waitcnt lgkmcnt(7)
    v_mfma_f32_16x16x32_bf16 v[96:99], v[60:63], v[128:131], v[96:99]
    ds_read_b128 v[128:131], v15 offset:13312
    s_waitcnt lgkmcnt(7)
    v_mfma_f32_16x16x32_bf16 v[100:103], v[60:63], v[132:135], v[100:103]
    ds_read_b128 v[132:135], v15 offset:13568
    buffer_load_dwordx4 v[20:23], v5, s[20:23], s42 offen offset:3072
    s_add_u32 s42, s42, 4096
    s_waitcnt lgkmcnt(7)
    v_mfma_f32_16x16x32_bf16 v[104:107], v[60:63], v[136:139], v[104:107]
    ds_read_b128 v[136:139], v15 offset:13824
    s_waitcnt lgkmcnt(7)
    v_mfma_f32_16x16x32_bf16 v[108:111], v[60:63], v[140:143], v[108:111]
    ds_read_b128 v[140:143], v15 offset:14080
    s_waitcnt lgkmcnt(7)
    v_mfma_f32_16x16x32_bf16 v[96:99], v[64:67], v[112:115], v[96:99]
    ds_read_b128 v[112:115], v15 offset:14336
    s_waitcnt lgkmcnt(7)
    v_mfma_f32_16x16x32_bf16 v[100:103], v[64:67], v[116:119], v[100:103]
    ds_read_b128 v[116:119], v15 offset:14592
    s_waitcnt lgkmcnt(7)
    v_mfma_f32_16x16x32_bf16 v[104:107], v[64:67], v[120:123], v[104:107]
    ds_read_b128 v[120:123], v15 offset:14848
    buffer_load_dwordx4 v[24:27], v5, s[20:23], s42 offen offset:0
    s_waitcnt lgkmcnt(7)
    v_mfma_f32_16x16x32_bf16 v[108:111], v[64:67], v[124:127], v[108:111]
    ds_read_b128 v[124:127], v15 offset:15104
    s_waitcnt lgkmcnt(7)
    v_mfma_f32_16x16x32_bf16 v[96:99], v[68:71], v[128:131], v[96:99]
    ds_read_b128 v[128:131], v15 offset:15360
    s_waitcnt lgkmcnt(7)
    v_mfma_f32_16x16x32_bf16 v[100:103], v[68:71], v[132:135], v[100:103]
    ds_read_b128 v[132:135], v15 offset:15616
    s_waitcnt lgkmcnt(7)
    v_mfma_f32_16x16x32_bf16 v[104:107], v[68:71], v[136:139], v[104:107]
    ds_read_b128 v[136:139], v15 offset:15872
    s_waitcnt lgkmcnt(7)
    v_mfma_f32_16x16x32_bf16 v[108:111], v[68:71], v[140:143], v[108:111]
    ds_read_b128 v[140:143], v15 offset:16128
    buffer_load_dwordx4 v[28:31], v5, s[20:23], s42 offen offset:1024
    s_waitcnt lgkmcnt(7)
    v_mfma_f32_16x16x32_bf16 v[96:99], v[72:75], v[112:115], v[96:99]
    ds_read_b128 v[112:115], v15 offset:16384
    s_waitcnt lgkmcnt(7)
    v_mfma_f32_16x16x32_bf16 v[100:103], v[72:75], v[116:119], v[100:103]
    ds_read_b128 v[116:119], v15 offset:16640
    s_waitcnt lgkmcnt(7)
    v_mfma_f32_16x16x32_bf16 v[104:107], v[72:75], v[120:123], v[104:107]
    ds_read_b128 v[120:123], v15 offset:16896
    s_waitcnt lgkmcnt(7)
    v_mfma_f32_16x16x32_bf16 v[108:111], v[72:75], v[124:127], v[108:111]
    ds_read_b128 v[124:127], v15 offset:17152
    s_waitcnt lgkmcnt(7)
    v_mfma_f32_16x16x32_bf16 v[96:99], v[76:79], v[128:131], v[96:99]
    ds_read_b128 v[128:131], v15 offset:17408
    s_waitcnt lgkmcnt(7)
    v_mfma_f32_16x16x32_bf16 v[100:103], v[76:79], v[132:135], v[100:103]
    ds_read_b128 v[132:135], v15 offset:17664
    s_waitcnt lgkmcnt(7)
    v_mfma_f32_16x16x32_bf16 v[104:107], v[76:79], v[136:139], v[104:107]
    ds_read_b128 v[136:139], v15 offset:17920
    s_waitcnt lgkmcnt(7)
    v_mfma_f32_16x16x32_bf16 v[108:111], v[76:79], v[140:143], v[108:111]
    ds_read_b128 v[140:143], v15 offset:18176
    s_waitcnt lgkmcnt(7)
    v_mfma_f32_16x16x32_bf16 v[96:99], v[80:83], v[112:115], v[96:99]
    ds_read_b128 v[112:115], v15 offset:18432
    s_waitcnt lgkmcnt(7)
    v_mfma_f32_16x16x32_bf16 v[100:103], v[80:83], v[116:119], v[100:103]
    ds_read_b128 v[116:119], v15 offset:18688
    s_waitcnt lgkmcnt(7)
    v_mfma_f32_16x16x32_bf16 v[104:107], v[80:83], v[120:123], v[104:107]
    ds_read_b128 v[120:123], v15 offset:18944
    s_waitcnt lgkmcnt(7)
    v_mfma_f32_16x16x32_bf16 v[108:111], v[80:83], v[124:127], v[108:111]
    ds_read_b128 v[124:127], v15 offset:19200
    s_waitcnt lgkmcnt(7)
    v_mfma_f32_16x16x32_bf16 v[96:99], v[84:87], v[128:131], v[96:99]
    ds_read_b128 v[128:131], v15 offset:19456
    s_waitcnt lgkmcnt(7)
    v_mfma_f32_16x16x32_bf16 v[100:103], v[84:87], v[132:135], v[100:103]
    ds_read_b128 v[132:135], v15 offset:19712
    s_waitcnt lgkmcnt(7)
    v_mfma_f32_16x16x32_bf16 v[104:107], v[84:87], v[136:139], v[104:107]
    ds_read_b128 v[136:139], v15 offset:19968
    s_waitcnt vmcnt(12)
    s_cmp_eq_u32 s26, 0
    s_cbranch_scc1 kx_fused_kernel_slow67
    s_mov_b64 exec, 1
    buffer_store_dword v11, off, s[20:23], s63
    s_mov_b64 exec, -1
kx_fused_kernel_back68:
    v_mov_b32 v11, 2
    s_waitcnt lgkmcnt(7)
    v_mfma_f32_16x16x32_bf16 v[108:111], v[84:87], v[140:143], v[108:111]
    ds_read_b128 v[140:143], v15 offset:20224
    s_waitcnt lgkmcnt(7)
    v_mfma_f32_16x16x32_bf16 v[96:99], v[88:91], v[112:115], v[96:99]
    s_waitcnt lgkmcnt(6)
    v_mfma_f32_16x16x32_bf16 v[100:103], v[88:91], v[116:119], v[100:103]
    s_waitcnt lgkmcnt(5)
    v_mfma_f32_16x16x32_bf16 v[104:107], v[88:91], v[120:123], v[104:107]
    s_waitcnt lgkmcnt(4)
    v_mfma_f32_16x16x32_bf16 v[108:111], v[88:91], v[124:127], v[108:111]
    s_waitcnt lgkmcnt(3)
    v_mfma_f32_16x16x32_bf16 v[96:99], v[92:95], v[128:131], v[96:99]
    s_waitcnt lgkmcnt(2)
    v_mfma_f32_16x16x32_bf16 v[100:103], v[92:95], v[132:135], v[100:103]
    s_waitcnt lgkmcnt(1)
    v_mfma_f32_16x16x32_bf16 v[104:107], v[92:95], v[136:139], v[104:107]
    s_waitcnt lgkmcnt(0)
    v_mfma_f32_16x16x32_bf16 v[108:111], v[92:95], v[140:143], v[108:111]
    s_setprio 0
    ds_read_b96 v[112:114], v12 offset:1024
    ds_read_b96 v[116:118], v12 offset:1280
    s_nop 2
    v_permlane32_swap_b32 v96, v104
    v_permlane32_swap_b32 v97, v105
    v_permlane32_swap_b32 v98, v106
    v_permlane32_swap_b32 v99, v107
    v_permlane32_swap_b32 v100, v108
    v_permlane32_swap_b32 v101, v109
    v_permlane32_swap_b32 v102, v110
    v_permlane32_swap_b32 v103, v111
    s_waitcnt lgkmcnt(1)
    v_fmac_f32 v96, v144, v113
    v_fmac_f32 v97, v145, v113
    v_fmac_f32 v98, v146, v113
    v_fmac_f32 v99, v147, v113
    s_waitcnt lgkmcnt(0)
    v_fmac_f32 v100, v144, v117
    v_fmac_f32 v101, v145, v117
    v_fmac_f32 v102, v146, v117
    v_fmac_f32 v103, v147, v117
    v_mul_f32 v120, v96, v112
    v_mul_f32 v121, v97, v112
    v_mul_f32 v122, v98, v112
    v_mul_f32 v123, v99, v112
    v_mul_f32 v124, v100, v116
    v_mul_f32 v125, v101, v116
    v_mul_f32 v126, v102, v116
    v_mul_f32 v127, v103, v116
    v_exp_f32 v120, v120
    v_fmac_f32 v104, v148, v113
    v_exp_f32 v121, v121
    v_fmac_f32 v105, v149, v113
    v_exp_f32 v122, v122
    v_fmac_f32 v106, v150, v113
    v_exp_f32 v123, v123
    v_fmac_f32 v107, v151, v113
    v_exp_f32 v124, v124
    v_fmac_f32 v108, v148, v117
    v_exp_f32 v125, v125
    v_fmac_f32 v109, v149, v117
    v_exp_f32 v126, v126
    v_fmac_f32 v110, v150, v117
    v_exp_f32 v127, v127
    v_fmac_f32 v111, v151, v117
    v_fma_f32 v120, v120, v114, v114
    v_fma_f32 v121, v121, v114, v114
    v_fma_f32 v122, v122, v114, v114
    v_fma_f32 v123, v123, v114, v114
    v_fma_f32 v124, v124, v118, v118
    v_fma_f32 v125, v125, v118, v118
    v_fma_f32 v126, v126, v118, v118
    v_fma_f32 v127, v127, v118, v118
    v_rcp_f32 v120, v120
    v_mul_f32 v96, v96, v104
    v_rcp_f32 v121, v121
    v_mul_f32 v97, v97, v105
    v_rcp_f32 v122, v122
    v_mul_f32 v98, v98, v106
    v_rcp_f32 v123, v123
    v_mul_f32 v99, v99, v107
    v_rcp_f32 v124, v124
    v_mul_f32 v100, v100, v108
    v_rcp_f32 v125, v125
    v_mul_f32 v101, v101, v109
    v_rcp_f32 v126, v126
    v_mul_f32 v102, v102, v110
    v_rcp_f32 v127, v127
    v_mul_f32 v103, v103, v111
    v_mul_f32 v96, v96, v120
    v_mul_f32 v97, v97, v121
    v_mul_f32 v98, v98, v122
    v_mul_f32 v99, v99, v123
    v_mul_f32 v100, v100, v124
    v_mul_f32 v101, v101, v125
    v_mul_f32 v102, v102, v126
    v_mul_f32 v103, v103, v127
    v_cvt_pk_bf16_f32 v128, v96, v97
    v_cvt_pk_bf16_f32 v130, v100, v101
    v_cvt_pk_bf16_f32 v129, v98, v99
    v_cvt_pk_bf16_f32 v131, v102, v103
    v_permlane16_swap_b32 v128, v130
    s_nop 0
    v_permlane16_swap_b32 v129, v131
    buffer_store_dwordx4 v[128:131], v13, s[20:23], s53 offen sc1
    buffer_load_dwordx2 v[136:137], v9, s[20:23], s61 offen offset:0 sc1
    buffer_load_dwordx2 v[138:139], v9, s[20:23], s61 offen offset:256 sc1
    s_add_u32 s61, s61, 81920
    buffer_load_dwordx2 v[140:141], v9, s[20:23], s61 offen offset:0 sc1
    buffer_load_dwordx2 v[142:143], v9, s[20:23], s61 offen offset:256 sc1
    buffer_load_dword v4, v6, s[20:23], 0 offen sc1
    s_waitcnt vmcnt(5)
    s_cmp_eq_u32 s26, 0
    s_cbranch_scc1 kx_fused_kernel_slow69
    s_mov_b64 exec, 1
    buffer_store_dword v11, off, s[20:23], s63
    s_mov_b64 exec, -1
kx_fused_kernel_back70:
    s_mov_b32 s27, 65536
    s_waitcnt vmcnt(1)
    s_branch kx_fused_kernel_pollc73
kx_fused_kernel_poll71:
    buffer_load_dword v4, v6, s[20:23], 0 offen sc1
    s_sub_u32 s27, s27, 1
    s_waitcnt vmcnt(0)
    s_cbranch_scc1 kx_fused_kernel_pollx72
kx_fused_kernel_pollc73:
    v_cmp_gt_u32 vcc, 1, v4
    s_cbranch_vccnz kx_fused_kernel_poll71
kx_fused_kernel_pollx72:
    buffer_load_dwordx4 v[32:35], v5, s[20:23], s60 offen offset:0 sc1
    buffer_load_dwordx4 v[36:39], v5, s[20:23], s60 offen offset:1024 sc1
    buffer_load_dwordx4 v[40:43], v5, s[20:23], s60 offen offset:2048 sc1
    buffer_load_dwordx4 v[44:47], v5, s[20:23], s60 offen offset:3072 sc1
    s_add_u32 s60, s60, 4096
    buffer_load_dwordx4 v[48:51], v5, s[20:23], s60 offen offset:0 sc1
    buffer_load_dwordx4 v[52:55], v5, s[20:23], s60 offen offset:1024 sc1
    s_add_u32 s60, s60, 45056
    buffer_load_dwordx4 v[56:59], v5, s[20:23], s60 offen offset:0 sc1
    buffer_load_dwordx4 v[60:63], v5, s[20:23], s60 offen offset:1024 sc1
    buffer_load_dwordx4 v[64:67], v5, s[20:23], s60 offen offset:2048 sc1
    buffer_load_dwordx4 v[68:71], v5, s[20:23], s60 offen offset:3072 sc1
    s_add_u32 s60, s60, 4096
    buffer_load_dwordx4 v[72:75], v5, s[20:23], s60 offen offset:0 sc1
    buffer_load_dwordx4 v[76:79], v5, s[20:23], s60 offen offset:1024 sc1
    s_add_u32 s60, s60, 143360
    v_add_u32 v2, 120832, v7
    v_add_u32 v3, 120832, v8
    s_waitcnt vmcnt(11)
    v_mfma_f32_16x16x32_bf16 v[80:83], v[216:219], v[32:35], 0
    s_waitcnt vmcnt(10)
    v_mfma_f32_16x16x32_bf16 v[80:83], v[220:223], v[36:39], v[80:83]
    s_waitcnt vmcnt(9)
    v_mfma_f32_16x16x32_bf16 v[80:83], v[224:227], v[40:43], v[80:83]
    s_waitcnt vmcnt(8)
    v_mfma_f32_16x16x32_bf16 v[80:83], v[228:231], v[44:47], v[80:83]
    s_waitcnt vmcnt(7)
    v_mfma_f32_16x16x32_bf16 v[80:83], v[232:235], v[48:51], v[80:83]
    s_waitcnt vmcnt(6)
    v_mfma_f32_16x16x32_bf16 v[80:83], v[236:239], v[52:55], v[80:83]
    v_mfma_f32_16x16x32_bf16 v[84:87], v[240:243], v[32:35], 0
    v_mfma_f32_16x16x32_bf16 v[84:87], v[244:247], v[36:39], v[84:87]
    v_mfma_f32_16x16x32_bf16 v[84:87], v[248:251], v[40:43], v[84:87]
    v_mfma_f32_16x16x32_bf16 v[84:87], v[252:255], v[44:47], v[84:87]
    v_mfma_f32_16x16x32_bf16 v[84:87], v[152:155], v[48:51], v[84:87]
    v_mfma_f32_16x16x32_bf16 v[84:87], v[156:159], v[52:55], v[84:87]
    v_mfma_f32_16x16x32_bf16 v[88:91], v[160:163], v[32:35], 0
    v_mfma_f32_16x16x32_bf16 v[88:91], v[164:167], v[36:39], v[88:91]
    ds_write_b128 v2, v[80:83] offset:0
    v_mfma_f32_16x16x32_bf16 v[88:91], v[168:171], v[40:43], v[88:91]
    v_mfma_f32_16x16x32_bf16 v[88:91], v[172:175], v[44:47], v[88:91]
    v_mfma_f32_16x16x32_bf16 v[88:91], v[176:179], v[48:51], v[88:91]
    v_mfma_f32_16x16x32_bf16 v[88:91], v[180:183], v[52:55], v[88:91]
    v_mfma_f32_16x16x32_bf16 v[92:95], v[184:187], v[32:35], 0
    v_mfma_f32_16x16x32_bf16 v[92:95], v[188:191], v[36:39], v[92:95]
    ds_write_b128 v2, v[84:87] offset:64
    v_mfma_f32_16x16x32_bf16 v[92:95], v[192:195], v[40:43], v[92:95]
    v_mfma_f32_16x16x32_bf16 v[92:95], v[196:199], v[44:47], v[92:95]
    v_mfma_f32_16x16x32_bf16 v[92:95], v[200:203], v[48:51], v[92:95]
    v_mfma_f32_16x16x32_bf16 v[92:95], v[204:207], v[52:55], v[92:95]
    v_mfma_f32_16x16x32_bf16 v[12:15], v[208:211], v[32:35], 0
    v_mfma_f32_16x16x32_bf16 v[12:15], v[212:215], v[36:39], v[12:15]
    ds_write_b128 v2, v[88:91] offset:128
    v_mfma_f32_16x16x32_bf16 v[12:15], v[16:19], v[40:43], v[12:15]
    v_mfma_f32_16x16x32_bf16 v[12:15], v[20:23], v[44:47], v[12:15]
    v_mfma_f32_16x16x32_bf16 v[12:15], v[24:27], v[48:51], v[12:15]
    v_mfma_f32_16x16x32_bf16 v[12:15], v[28:31], v[52:55], v[12:15]
    s_waitcnt vmcnt(5)
    v_mfma_f32_16x16x32_bf16 v[80:83], v[216:219], v[56:59], 0
    s_waitcnt vmcnt(4)
    v_mfma_f32_16x16x32_bf16 v[80:83], v[220:223], v[60:63], v[80:83]
    ds_write_b128 v2, v[92:95] offset:192
    s_waitcnt vmcnt(3)
    v_mfma_f32_16x16x32_bf16 v[80:83], v[224:227], v[64:67], v[80:83]
    s_waitcnt vmcnt(2)
    v_mfma_f32_16x16x32_bf16 v[80:83], v[228:231], v[68:71], v[80:83]
    s_waitcnt vmcnt(1)
    v_mfma_f32_16x16x32_bf16 v[80:83], v[232:235], v[72:75], v[80:83]
    s_waitcnt vmcnt(0)
    v_mfma_f32_16x16x32_bf16 v[80:83], v[236:239], v[76:79], v[80:83]
    v_mfma_f32_16x16x32_bf16 v[84:87], v[240:243], v[56:59], 0
    v_mfma_f32_16x16x32_bf16 v[84:87], v[244:247], v[60:63], v[84:87]
    ds_write_b128 v2, v[12:15] offset:256
    v_mfma_f32_16x16x32_bf16 v[84:87], v[248:251], v[64:67], v[84:87]
    v_mfma_f32_16x16x32_bf16 v[84:87], v[252:255], v[68:71], v[84:87]
    v_mfma_f32_16x16x32_bf16 v[84:87], v[152:155], v[72:75], v[84:87]
    s_waitcnt lgkmcnt(0)
    s_barrier
    ds_read_b128 v[32:35], v3 offset:0
    ds_read_b128 v[36:39], v3 offset:5376
    ds_read_b128 v[40:43], v3 offset:10752
    s_setprio 1
    v_mfma_f32_16x16x32_bf16 v[84:87], v[156:159], v[76:79], v[84:87]
    ds_read_b128 v[44:47], v3 offset:16128
    ds_read_b128 v[48:51], v3 offset:21504
    ds_read_b128 v[52:55], v3 offset:26880
    v_mfma_f32_16x16x32_bf16 v[88:91], v[160:163], v[56:59], 0
    buffer_load_dword v4, v6, s[20:23], 0 offen sc1
    v_mfma_f32_16x16x32_bf16 v[88:91], v[164:167], v[60:63], v[88:91]
    ds_write_b128 v7, v[80:83] offset:0
    v_mfma_f32_16x16x32_bf16 v[88:91], v[168:171], v[64:67], v[88:91]
    v_mfma_f32_16x16x32_bf16 v[88:91], v[172:175], v[68:71], v[88:91]
    s_waitcnt lgkmcnt(5)
    v_add_f32 v32, v32, v36
    v_add_f32 v33, v33, v37
    v_add_f32 v34, v34, v38
    v_mfma_f32_16x16x32_bf16 v[88:91], v[176:179], v[72:75], v[88:91]
    v_add_f32 v35, v35, v39
    ds_read_b128 v[36:39], v3 offset:32256
    s_waitcnt lgkmcnt(4)
    v_add_f32 v40, v40, v44
    v_mfma_f32_16x16x32_bf16 v[88:91], v[180:183], v[76:79], v[88:91]
    v_add_f32 v41, v41, v45
    v_add_f32 v42, v42, v46
    v_add_f32 v43, v43, v47
    v_mfma_f32_16x16x32_bf16 v[92:95], v[184:187], v[56:59], 0
    ds_read_b128 v[44:47], v3 offset:37632
    s_waitcnt lgkmcnt(3)
    v_add_f32 v48, v48, v52
    v_add_f32 v49, v49, v53
    v_mfma_f32_16x16x32_bf16 v[92:95], v[188:191], v[60:63], v[92:95]
    ds_write_b128 v7, v[84:87] offset:64
    v_add_f32 v50, v50, v54
    v_add_f32 v51, v51, v55
    v_lshlrev_b32 v52, 16, v136
    v_mfma_f32_16x16x32_bf16 v[92:95], v[192:195], v[64:67], v[92:95]
    v_and_b32 v53, 0xffff0000, v136
    v_lshlrev_b32 v54, 16, v137
    v_and_b32 v55, 0xffff0000, v137
    s_mov_b32 s27, 65536
    s_waitcnt vmcnt(0)
    s_branch kx_fused_kernel_pollc76
kx_fused_kernel_poll74:
    buffer_load_dword v4, v6, s[20:23], 0 offen sc1
    s_sub_u32 s27, s27, 1
    s_waitcnt vmcnt(0)
    s_cbranch_scc1 kx_fused_kernel_pollx75
kx_fused_kernel_pollc76:
    v_cmp_gt_u32 vcc, 2, v4
    s_cbranch_vccnz kx_fused_kernel_poll74
kx_fused_kernel_pollx75:
    buffer_load_dwordx4 v[96:99], v5, s[20:23], s60 offen offset:0 sc1
    buffer_load_dwordx4 v[100:103], v5, s[20:23], s60 offen offset:1024 sc1
    v_mfma_f32_16x16x32_bf16 v[92:95], v[196:199], v[68:71], v[92:95]
    v_add_f32 v32, v32, v40
    v_add_f32 v33, v33, v41
    v_add_f32 v34, v34, v42
    buffer_load_dwordx4 v[104:107], v5, s[20:23], s60 offen offset:2048 sc1
    buffer_load_dwordx4 v[108:111], v5, s[20:23], s60 offen offset:3072 sc1
    v_mfma_f32_16x16x32_bf16 v[92:95], v[200:203], v[72:75], v[92:95]
    v_add_f32 v35, v35, v43
    v_add_f32 v48, v48, v52
    v_add_f32 v49, v49, v53
    s_add_u32 s60, s60, 4096
    buffer_load_dwordx4 v[112:115], v5, s[20:23], s60 offen offset:0 sc1
    v_mfma_f32_16x16x32_bf16 v[92:95], v[204:207], v[76:79], v[92:95]
    v_add_f32 v50, v50, v54
    v_add_f32 v51, v51, v55
    v_add_f32 v32, v32, v48
    buffer_load_dwordx4 v[116:119], v5, s[20:23], s60 offen offset:1024 sc1
    s_add_u32 s60, s60, 45056
    v_mfma_f32_16x16x32_bf16 v[12:15], v[208:211], v[56:59], 0
    v_add_f32 v33, v33, v49
    v_add_f32 v34, v34, v50
    v_add_f32 v35, v35, v51
    v_mfma_f32_16x16x32_bf16 v[12:15], v[212:215], v[60:63], v[12:15]
    ds_write_b128 v7, v[88:91] offset:128
    s_waitcnt lgkmcnt(2)
    v_add_f32 v36, v36, v44
    v_add_f32 v37, v37, v45
    v_add_f32 v38, v38, v46
    v_mfma_f32_16x16x32_bf16 v[12:15], v[16:19], v[64:67], v[12:15]
    v_add_f32 v39, v39, v47
    v_add_f32 v32, v32, v36
    v_add_f32 v33, v33, v37
    v_mfma_f32_16x16x32_bf16 v[12:15], v[20:23], v[68:71], v[12:15]
    v_add_f32 v34, v34, v38
    v_add_f32 v35, v35, v39
    v_cvt_pk_bf16_f32 v136, v32, v33
    v_mfma_f32_16x16x32_bf16 v[12:15], v[24:27], v[72:75], v[12:15]
    v_cvt_pk_bf16_f32 v137, v34, v35
    v_mfma_f32_16x16x32_bf16 v[12:15], v[28:31], v[76:79], v[12:15]
    buffer_load_dwordx4 v[120:123], v5, s[20:23], s60 offen offset:0 sc1
    buffer_load_dwordx4 v[124:127], v5, s[20:23], s60 offen offset:1024 sc1
    buffer_load_dwordx4 v[128:131], v5, s[20:23], s60 offen offset:2048 sc1
    buffer_load_dwordx4 v[132:135], v5, s[20:23], s60 offen offset:3072 sc1
    s_add_u32 s60, s60, 4096
    buffer_load_dwordx4 v[144:147], v5, s[20:23], s60 offen offset:0 sc1
    buffer_load_dwordx4 v[148:151], v5, s[20:23], s60 offen offset:1024 sc1
    s_add_u32 s60, s60, 143360
    buffer_store_dwordx2 v[136:137], v10, s[56:59], s62 offen sc1
    s_add_u32 s62, s62, 20480
    s_waitcnt vmcnt(12)
    v_mfma_f32_16x16x32_bf16 v[80:83], v[216:219], v[96:99], 0
    s_waitcnt vmcnt(11)
    v_mfma_f32_16x16x32_bf16 v[80:83], v[220:223], v[100:103], v[80:83]
    ds_write_b128 v7, v[92:95] offset:192
    s_waitcnt vmcnt(10)
    v_mfma_f32_16x16x32_bf16 v[80:83], v[224:227], v[104:107], v[80:83]
    s_waitcnt vmcnt(9)
    v_mfma_f32_16x16x32_bf16 v[80:83], v[228:231], v[108:111], v[80:83]
    s_waitcnt vmcnt(8)
    v_mfma_f32_16x16x32_bf16 v[80:83], v[232:235], v[112:115], v[80:83]
    s_waitcnt vmcnt(7)
    v_mfma_f32_16x16x32_bf16 v[80:83], v[236:239], v[116:119], v[80:83]
    v_mfma_f32_16x16x32_bf16 v[84:87], v[240:243], v[96:99], 0
    v_mfma_f32_16x16x32_bf16 v[84:87], v[244:247], v[100:103], v[84:87]
    ds_write_b128 v7, v[12:15] offset:256
    v_mfma_f32_16x16x32_bf16 v[84:87], v[248:251], v[104:107], v[84:87]
    v_mfma_f32_16x16x32_bf16 v[84:87], v[252:255], v[108:111], v[84:87]
    v_mfma_f32_16x16x32_bf16 v[84:87], v[152:155], v[112:115], v[84:87]
    s_waitcnt lgkmcnt(0)
    s_barrier
    ds_read_b128 v[32:35], v8 offset:0
    ds_read_b128 v[36:39], v8 offset:5376
    ds_read_b128 v[40:43], v8 offset:10752
    v_mfma_f32_16x16x32_bf16 v[84:87], v[156:159], v[116:119], v[84:87]
    ds_read_b128 v[44:47], v8 offset:16128
    ds_read_b128 v[48:51], v8 offset:21504
    ds_read_b128 v[52:55], v8 offset:26880
    v_mfma_f32_16x16x32_bf16 v[88:91], v[160:163], v[96:99], 0
    ds_read_b128 v[56:59], v8 offset:32256
    ds_read_b128 v[60:63], v8 offset:37632
    v_mfma_f32_16x16x32_bf16 v[88:91], v[164:167], v[100:103], v[88:91]
    ds_write_b128 v7, v[80:83] offset:43008
    v_mfma_f32_16x16x32_bf16 v[88:91], v[168:171], v[104:107], v[88:91]
    v_mfma_f32_16x16x32_bf16 v[88:91], v[172:175], v[108:111], v[88:91]
    s_waitcnt lgkmcnt(7)
    v_add_f32 v32, v32, v36
    v_add_f32 v33, v33, v37
    v_add_f32 v34, v34, v38
    v_mfma_f32_16x16x32_bf16 v[88:91], v[176:179], v[112:115], v[88:91]
    v_add_f32 v35, v35, v39
    v_lshlrev_b32 v36, 16, v138
    v_and_b32 v37, 0xffff0000, v138
    v_mfma_f32_16x16x32_bf16 v[88:91], v[180:183], v[116:119], v[88:91]
    v_lshlrev_b32 v38, 16, v139
    v_and_b32 v39, 0xffff0000, v139
    v_add_f32 v32, v32, v36
    v_mfma_f32_16x16x32_bf16 v[92:95], v[184:187], v[96:99], 0
    v_add_f32 v33, v33, v37
    v_add_f32 v34, v34, v38
    v_add_f32 v35, v35, v39
    v_mfma_f32_16x16x32_bf16 v[92:95], v[188:191], v[100:103], v[92:95]
    ds_write_b128 v7, v[84:87] offset:43072
    s_waitcnt lgkmcnt(6)
    v_add_f32 v40, v40, v44
    v_add_f32 v41, v41, v45
    v_add_f32 v42, v42, v46
    v_mfma_f32_16x16x32_bf16 v[92:95], v[192:195], v[104:107], v[92:95]
    v_add_f32 v43, v43, v47
    v_add_f32 v32, v32, v40
    v_add_f32 v33, v33, v41
    v_mfma_f32_16x16x32_bf16 v[92:95], v[196:199], v[108:111], v[92:95]
    v_add_f32 v34, v34, v42
    v_add_f32 v35, v35, v43
    s_waitcnt lgkmcnt(4)
    v_add_f32 v48, v48, v52
    v_mfma_f32_16x16x32_bf16 v[92:95], v[200:203], v[112:115], v[92:95]
    v_add_f32 v49, v49, v53
    v_add_f32 v50, v50, v54
    v_add_f32 v51, v51, v55
    v_mfma_f32_16x16x32_bf16 v[92:95], v[204:207], v[116:119], v[92:95]
    v_add_f32 v32, v32, v48
    v_add_f32 v33, v33, v49
    v_add_f32 v34, v34, v50
    v_mfma_f32_16x16x32_bf16 v[12:15], v[208:211], v[96:99], 0
    v_add_f32 v35, v35, v51
    s_waitcnt lgkmcnt(2)
    v_add_f32 v56, v56, v60
    v_add_f32 v57, v57, v61
    v_mfma_f32_16x16x32_bf16 v[12:15], v[212:215], v[100:103], v[12:15]
    ds_write_b128 v7, v[88:91] offset:43136
    v_add_f32 v58, v58, v62
    v_add_f32 v59, v59, v63
    v_add_f32 v32, v32, v56
    v_mfma_f32_16x16x32_bf16 v[12:15], v[16:19], v[104:107], v[12:15]
    v_add_f32 v33, v33, v57
    v_add_f32 v34, v34, v58
    v_add_f32 v35, v35, v59
    v_mfma_f32_16x16x32_bf16 v[12:15], v[20:23], v[108:111], v[12:15]
    v_cvt_pk_bf16_f32 v138, v32, v33
    v_cvt_pk_bf16_f32 v139, v34, v35
    buffer_store_dwordx2 v[138:139], v10, s[56:59], s62 offen sc1
    v_mfma_f32_16x16x32_bf16 v[12:15], v[24:27], v[112:115], v[12:15]
    s_add_u32 s62, s62, 61440
    v_mfma_f32_16x16x32_bf16 v[12:15], v[28:31], v[116:119], v[12:15]
    s_waitcnt vmcnt(7)
    v_mfma_f32_16x16x32_bf16 v[80:83], v[216:219], v[120:123], 0
    s_waitcnt vmcnt(6)
    v_mfma_f32_16x16x32_bf16 v[80:83], v[220:223], v[124:127], v[80:83]
    ds_write_b128 v7, v[92:95] offset:43200
    s_waitcnt vmcnt(5)
    v_mfma_f32_16x16x32_bf16 v[80:83], v[224:227], v[128:131], v[80:83]
    s_waitcnt vmcnt(4)
    v_mfma_f32_16x16x32_bf16 v[80:83], v[228:231], v[132:135], v[80:83]
    s_waitcnt vmcnt(3)
    v_mfma_f32_16x16x32_bf16 v[80:83], v[232:235], v[144:147], v[80:83]
    s_waitcnt vmcnt(2)
    v_mfma_f32_16x16x32_bf16 v[80:83], v[236:239], v[148:151], v[80:83]
    v_mfma_f32_16x16x32_bf16 v[84:87], v[240:243], v[120:123], 0
    v_mfma_f32_16x16x32_bf16 v[84:87], v[244:247], v[124:127], v[84:87]
    ds_write_b128 v7, v[12:15] offset:43264
    v_mfma_f32_16x16x32_bf16 v[84:87], v[248:251], v[128:131], v[84:87]
    v_mfma_f32_16x16x32_bf16 v[84:87], v[252:255], v[132:135], v[84:87]
    v_mfma_f32_16x16x32_bf16 v[84:87], v[152:155], v[144:147], v[84:87]
    s_waitcnt lgkmcnt(0)
    s_barrier
    v_add_u32 v8, 43008, v8
    ds_read_b128 v[32:35], v8 offset:0
    ds_read_b128 v[36:39], v8 offset:5376
    v_mfma_f32_16x16x32_bf16 v[84:87], v[156:159], v[148:151], v[84:87]
    ds_read_b128 v[40:43], v8 offset:10752
    ds_read_b128 v[44:47], v8 offset:16128
    ds_read_b128 v[48:51], v8 offset:21504
    v_mfma_f32_16x16x32_bf16 v[88:91], v[160:163], v[120:123], 0
    ds_read_b128 v[52:55], v8 offset:26880
    ds_read_b128 v[56:59], v8 offset:32256
    ds_read_b128 v[60:63], v8 offset:37632
    v_mfma_f32_16x16x32_bf16 v[88:91], v[164:167], v[124:127], v[88:91]
    ds_write_b128 v2, v[80:83] offset:0
    v_mfma_f32_16x16x32_bf16 v[88:91], v[168:171], v[128:131], v[88:91]
    v_mfma_f32_16x16x32_bf16 v[88:91], v[172:175], v[132:135], v[88:91]
    s_waitcnt lgkmcnt(7)
    v_add_f32 v32, v32, v36
    v_add_f32 v33, v33, v37
    v_add_f32 v34, v34, v38
    v_mfma_f32_16x16x32_bf16 v[88:91], v[176:179], v[144:147], v[88:91]
    v_add_f32 v35, v35, v39
    v_lshlrev_b32 v36, 16, v140
    v_and_b32 v37, 0xffff0000, v140
    v_mfma_f32_16x16x32_bf16 v[88:91], v[180:183], v[148:151], v[88:91]
    v_lshlrev_b32 v38, 16, v141
    v_and_b32 v39, 0xffff0000, v141
    v_add_f32 v32, v32, v36
    v_mfma_f32_16x16x32_bf16 v[92:95], v[184:187], v[120:123], 0
    v_add_f32 v33, v33, v37
    v_add_f32 v34, v34, v38
    v_add_f32 v35, v35, v39
    v_mfma_f32_16x16x32_bf16 v[92:95], v[188:191], v[124:127], v[92:95]
    ds_write_b128 v2, v[84:87] offset:64
    s_waitcnt lgkmcnt(6)
    v_add_f32 v40, v40, v44
    v_add_f32 v41, v41, v45
    v_add_f32 v42, v42, v46
    v_mfma_f32_16x16x32_bf16 v[92:95], v[192:195], v[128:131], v[92:95]
    v_add_f32 v43, v43, v47
    v_add_f32 v32, v32, v40
    v_add_f32 v33, v33, v41
    v_mfma_f32_16x16x32_bf16 v[92:95], v[196:199], v[132:135], v[92:95]
    v_add_f32 v34, v34, v42
    v_add_f32 v35, v35, v43
    s_waitcnt lgkmcnt(4)
    v_add_f32 v48, v48, v52
    v_mfma_f32_16x16x32_bf16 v[92:95], v[200:203], v[144:147], v[92:95]
    v_add_f32 v49, v49, v53
    v_add_f32 v50, v50, v54
    v_add_f32 v51, v51, v55
    v_mfma_f32_16x16x32_bf16 v[92:95], v[204:207], v[148:151], v[92:95]
    v_add_f32 v32, v32, v48
    v_add_f32 v33, v33, v49
    v_add_f32 v34, v34, v50
    v_mfma_f32_16x16x32_bf16 v[12:15], v[208:211], v[120:123], 0
    v_add_f32 v35, v35, v51
    s_waitcnt lgkmcnt(2)
    v_add_f32 v56, v56, v60
    v_add_f32 v57, v57, v61
    v_mfma_f32_16x16x32_bf16 v[12:15], v[212:215], v[124:127], v[12:15]
    ds_write_b128 v2, v[88:91] offset:128
    v_add_f32 v58, v58, v62
    v_add_f32 v59, v59, v63
    v_add_f32 v32, v32, v56
    v_mfma_f32_16x16x32_bf16 v[12:15], v[16:19], v[128:131], v[12:15]
    v_add_f32 v33, v33, v57
    v_add_f32 v34, v34, v58
    v_add_f32 v35, v35, v59
    v_mfma_f32_16x16x32_bf16 v[12:15], v[20:23], v[132:135], v[12:15]
    v_cvt_pk_bf16_f32 v140, v32, v33
    v_cvt_pk_bf16_f32 v141, v34, v35
    buffer_store_dwordx2 v[140:141], v10, s[56:59], s62 offen sc1
    v_mfma_f32_16x16x32_bf16 v[12:15], v[24:27], v[144:147], v[12:15]
    s_add_u32 s62, s62, 20480
    v_mfma_f32_16x16x32_bf16 v[12:15], v[28:31], v[148:151], v[12:15]
    ds_write_b128 v2, v[92:95] offset:192
    s_nop 6
    ds_write_b128 v2, v[12:15] offset:256
    s_waitcnt lgkmcnt(0)
    s_barrier
    ds_read_b128 v[32:35], v3 offset:0
    ds_read_b128 v[36:39], v3 offset:5376
    ds_read_b128 v[40:43], v3 offset:10752
    ds_read_b128 v[44:47], v3 offset:16128
    ds_read_b128 v[48:51], v3 offset:21504
    ds_read_b128 v[52:55], v3 offset:26880
    ds_read_b128 v[56:59], v3 offset:32256
    ds_read_b128 v[60:63], v3 offset:37632
    s_waitcnt lgkmcnt(6)
    v_pk_add_f32 v[32:33], v[32:33], v[36:37]
    v_pk_add_f32 v[34:35], v[34:35], v[38:39]
    v_lshlrev_b32 v36, 16, v142
    v_and_b32 v37, 0xffff0000, v142
    v_lshlrev_b32 v38, 16, v143
    v_and_b32 v39, 0xffff0000, v143
    v_pk_add_f32 v[32:33], v[32:33], v[36:37]
    v_pk_add_f32 v[34:35], v[34:35], v[38:39]
    s_waitcnt lgkmcnt(4)
    v_pk_add_f32 v[40:41], v[40:41], v[44:45]
    v_pk_add_f32 v[42:43], v[42:43], v[46:47]
    v_pk_add_f32 v[32:33], v[32:33], v[40:41]
    v_pk_add_f32 v[34:35], v[34:35], v[42:43]
    s_waitcnt lgkmcnt(2)
    v_pk_add_f32 v[48:49], v[48:49], v[52:53]
    v_pk_add_f32 v[50:51], v[50:51], v[54:55]
    v_pk_add_f32 v[32:33], v[32:33], v[48:49]
    v_pk_add_f32 v[34:35], v[34:35], v[50:51]
    s_waitcnt lgkmcnt(0)
    v_pk_add_f32 v[56:57], v[56:57], v[60:61]
    v_pk_add_f32 v[58:59], v[58:59], v[62:63]
    v_pk_add_f32 v[32:33], v[32:33], v[56:57]
    v_pk_add_f32 v[34:35], v[34:35], v[58:59]
    v_cvt_pk_bf16_f32 v142, v32, v33
    v_cvt_pk_bf16_f32 v143, v34, v35
    buffer_store_dwordx2 v[142:143], v10, s[56:59], s62 offen sc1
    s_endpgm
kx_fused_kernel_tsp47:
    s_mov_b32 s27, 65536
    s_waitcnt vmcnt(0)
    s_branch kx_fused_kernel_pollc79
kx_fused_kernel_poll77:
    buffer_load_dword v215, v214, s[48:51], 0 offen sc1
    s_sub_u32 s27, s27, 1
    s_waitcnt vmcnt(0)
    s_cbranch_scc1 kx_fused_kernel_pollx78
kx_fused_kernel_pollc79:
    v_cmp_eq_u32 vcc, 0, v215
    s_cbranch_vccnz kx_fused_kernel_poll77
kx_fused_kernel_pollx78:
    buffer_store_dword v254, v253, s[20:23], 0 offen sc1
    s_barrier
    v_mov_b32 v243, 1073741824
    v_lshrrev_b32 v196, 5, v1
    v_and_b32 v197, 31, v1
    s_lshl2_add_u32 s41, s13, s14
    s_sub_u32 s41, s41, 4
    s_lshl_b32 s15, s41, 10
    s_lshl3_add_u32 s19, s17, s19
    s_mul_i32 s15, s14, 3072
    s_add_u32 s15, s15, 24576
    v_lshl_add_u32 v2, v197, 4, s15
    v_lshl_add_u32 v199, v196, 10, v2
    v_lshl_add_u32 v200, s17, 3, v2
    v_lshl_add_u32 v200, v196, 9, v200
    s_setprio 2
    s_and_b32 s28, s12, 3
    s_lshl2_add_u32 s28, s24, s28
    s_lshl_b32 s29, s17, 1
    s_lshl2_add_u32 s29, s24, s29
    s_lshr_b32 s30, s2, 4
    s_getreg_b32 s31, hwreg(HW_REG_XCC_ID)
    s_add_u32 s31, s31, 1
    v_lshrrev_b32 v2, 1, v197
    v_xor_b32 v2, v2, v197
    v_and_b32 v2, 4, v2
    v_mul_u32_u24 v2, 3, v2
    v_xor_b32 v198, v2, v197
    v_lshlrev_b32 v2, 4, v198
    v_lshl_add_u32 v202, v196, 10, v2
    v_mul_u32_u24 v203, 6144, v196
    s_lshl_b32 s15, s17, 3
    s_add_u32 s15, s15, 2048
    v_add3_u32 v203, v203, v2, s15
    v_min_u32 v2, 20, v197
    v_mul_u32_u24 v204, 336, v196
    v_lshl_add_u32 v204, v2, 4, v204
    s_mov_b32 exec_lo, 0xeef00000
    s_mov_b32 exec_hi, 0xeef00000
    v_add_u32 v204, 0x40000, v204
    s_mov_b64 exec, -1
    v_mov_b32 v205, v202
    v_mov_b32 v206, v203
    v_mov_b32 v207, v204
    s_mov_b32 s32, 0
    s_mov_b32 s27, 8
    v_lshlrev_b32 v212, 4, v197
    v_lshl_add_u32 v212, v196, 10, v212
    v_lshlrev_b32 v213, 3, v197
    v_lshl_add_u32 v213, v196, 30, v213
    v_lshlrev_b32 v5, 4, v1
    s_lshl_b32 s41, s41, 5
    s_add_u32 s41, s41, s12
    s_lshl3_add_u32 s42, s13, s14
    s_mul_i32 s42, s42, 30720
    s_add_u32 s42, s42, 20971520
    s_mul_i32 s15, s14, 25632
    s_add_u32 s15, s15, -53376
    v_and_b32 v3, 3, v1
    v_lshl_add_u32 v3, v3, 3, s15
    v_bfe_u32 v4, v1, 2, 4
    v_mad_u32_u24 v2, v196, 12, v4
    v_mul_u32_u24 v2, 160, v2
    v_add_u32 v6, v2, v3
    v_and_b32 v2, 48, v1
    v_add_u32 v2, v2, v4
    v_mul_u32_u24 v2, 160, v2
    v_add_u32 v7, v2, v3
    v_mov_b32 v156, 0
    v_mov_b32 v157, 0
    v_mov_b32 v158, 0
    v_mov_b32 v159, 0
    v_mov_b32 v160, 0
    v_mov_b32 v161, 0
    v_mov_b32 v162, 0
    v_mov_b32 v163, 0
    v_mov_b32 v164, 0
    v_mov_b32 v165, 0
    v_mov_b32 v166, 0
    v_mov_b32 v167, 0
    v_mov_b32 v168, 0
    v_mov_b32 v169, 0
    v_mov_b32 v170, 0
    v_mov_b32 v171, 0
    v_mov_b32 v172, 0
    v_mov_b32 v173, 0
    v_mov_b32 v174, 0
    v_mov_b32 v175, 0
    v_mov_b32 v176, 0
    v_mov_b32 v177, 0
    v_mov_b32 v178, 0
    v_mov_b32 v179, 0
    v_mov_b32 v180, 0
    v_mov_b32 v181, 0
    v_mov_b32 v182, 0
    v_mov_b32 v183, 0
    v_mov_b32 v184, 0
    v_mov_b32 v185, 0
    v_mov_b32 v186, 0
    v_mov_b32 v187, 0
    v_mov_b32 v116, 0
    v_mov_b32 v68, 0
    v_mov_b32 v117, 0
    v_mov_b32 v69, 0
    v_mov_b32 v118, 0
    v_mov_b32 v70, 0
    v_mov_b32 v119, 0
    v_mov_b32 v71, 0
    v_mov_b32 v120, 0
    v_mov_b32 v72, 0
    v_mov_b32 v121, 0
    v_mov_b32 v73, 0
    v_mov_b32 v122, 0
    v_mov_b32 v74, 0
    v_mov_b32 v123, 0
    v_mov_b32 v75, 0
    s_branch kx_fused_kernel_tset5
kx_fused_kernel_fallback59:
    s_waitcnt lgkmcnt(0)
    v_lshlrev_b32 v206, 4, v198
    v_lshl_add_u32 v205, v196, 15, v206
    v_mov_b32 v208, 0xff800000
    v_mov_b32 v209, 0xff800000
    v_mov_b32 v54, 0
    v_mov_b32 v55, 0
    s_mul_i32 s40, s12, 320
    v_lshl_add_u32 v204, v197, 4, s40
    v_mov_b32 v207, 10240
    v_cmp_gt_u32 vcc, 20, v197
    s_nop 1
    v_cndmask_b32 v204, v207, v204, vcc
    v_mul_u32_u24 v207, 10368, v196
    v_add_u32 v204, v204, v207
    v_add_u32 v207, 20736, v204
    s_add_u32 s38, s18, 2621440
    s_add_u32 s39, s19, 2621440
    s_mul_i32 s40, s12, 0
    s_add_u32 s40, s40, 5242880
    s_mov_b32 s27, 64
kx_fused_kernel_fbl80:
    buffer_load_dwordx4 v[44:47], v205, s[20:23], s38 offen
    buffer_load_dwordx2 v[52:53], v206, s[20:23], s39 offen
    s_waitcnt vmcnt(0)
    v_mfma_f32_32x32x4_2b_bf16 v[76:107], v[52:53], v[24:25], 0 cbsz:1 abid:0
    s_nop 15
    s_nop 1
    v_mfma_f32_32x32x16_bf16 v[76:91], v[44:47], v[16:19], v[76:91]
    v_mfma_f32_32x32x16_bf16 v[92:107], v[44:47], v[20:23], v[92:107]
    s_nop 10
    v_max3_f32 v210, v76, v77, v78
    v_max3_f32 v210, v210, v79, v80
    v_max3_f32 v210, v210, v81, v82
    v_max3_f32 v210, v210, v83, v84
    v_max3_f32 v210, v210, v85, v86
    v_max3_f32 v210, v210, v87, v88
    v_max3_f32 v210, v210, v89, v90
    v_max_f32 v210, v210, v91
    v_max_f32 v208, v208, v210
    v_max3_f32 v210, v92, v93, v94
    v_max3_f32 v210, v210, v95, v96
    v_max3_f32 v210, v210, v97, v98
    v_max3_f32 v210, v210, v99, v100
    v_max3_f32 v210, v210, v101, v102
    v_max3_f32 v210, v210, v103, v104
    v_max3_f32 v210, v210, v105, v106
    v_max_f32 v210, v210, v107
    v_max_f32 v209, v209, v210
    s_add_u32 s38, s38, 512
    s_add_u32 s39, s39, 512
    s_add_u32 s40, s40, 41472
    s_sub_u32 s27, s27, 1
    s_cmp_lg_u32 s27, 0
    s_cbranch_scc1 kx_fused_kernel_fbl80
    v_mov_b32 v210, v208
    v_mov_b32 v211, v209
    s_nop 0
    v_permlane32_swap_b32 v208, v210
    v_permlane32_swap_b32 v209, v211
    v_min_f32_e64 v124, -v208, -v210
    v_min_f32_e64 v140, -v209, -v211
    v_min_f32_e64 v125, -v208, -v210
    v_min_f32_e64 v141, -v209, -v211
    v_pk_mov_b32 v[126:127], v[124:125], v[124:125]
    v_pk_mov_b32 v[128:129], v[124:125], v[124:125]
    v_pk_mov_b32 v[130:131], v[124:125], v[124:125]
    v_pk_mov_b32 v[132:133], v[124:125], v[124:125]
    v_pk_mov_b32 v[134:135], v[124:125], v[124:125]
    v_pk_mov_b32 v[136:137], v[124:125], v[124:125]
    v_pk_mov_b32 v[138:139], v[124:125], v[124:125]
    v_pk_mov_b32 v[142:143], v[140:141], v[140:141]
    v_pk_mov_b32 v[144:145], v[140:141], v[140:141]
    v_pk_mov_b32 v[146:147], v[140:141], v[140:141]
    v_pk_mov_b32 v[148:149], v[140:141], v[140:141]
    v_pk_mov_b32 v[150:151], v[140:141], v[140:141]
    v_pk_mov_b32 v[152:153], v[140:141], v[140:141]
    v_pk_mov_b32 v[154:155], v[140:141], v[140:141]
    s_add_u32 s38, s18, 2621440
    s_add_u32 s39, s19, 2621440
    s_mul_i32 s40, s12, 0
    s_add_u32 s40, s40, 5242880
    s_mov_b32 s27, 64
    v_mov_b32 v156, 0
    v_mov_b32 v157, 0
    v_mov_b32 v158, 0
    v_mov_b32 v159, 0
    v_mov_b32 v160, 0
    v_mov_b32 v161, 0
    v_mov_b32 v162, 0
    v_mov_b32 v163, 0
    v_mov_b32 v164, 0
    v_mov_b32 v165, 0
    v_mov_b32 v166, 0
    v_mov_b32 v167, 0
    v_mov_b32 v168, 0
    v_mov_b32 v169, 0
    v_mov_b32 v170, 0
    v_mov_b32 v171, 0
    v_mov_b32 v172, 0
    v_mov_b32 v173, 0
    v_mov_b32 v174, 0
    v_mov_b32 v175, 0
    v_mov_b32 v176, 0
    v_mov_b32 v177, 0
    v_mov_b32 v178, 0
    v_mov_b32 v179, 0
    v_mov_b32 v180, 0
    v_mov_b32 v181, 0
    v_mov_b32 v182, 0
    v_mov_b32 v183, 0
    v_mov_b32 v184, 0
    v_mov_b32 v185, 0
    v_mov_b32 v186, 0
    v_mov_b32 v187, 0
kx_fused_kernel_fbl81:
    buffer_load_dwordx4 v[44:47], v205, s[20:23], s38 offen
    buffer_load_dwordx2 v[52:53], v206, s[20:23], s39 offen
    buffer_load_dwordx4 v[60:63], v204, s[20:23], s40 offen offset:0
    buffer_load_dwordx4 v[64:67], v207, s[20:23], s40 offen offset:0
    s_waitcnt vmcnt(0)
    v_mfma_f32_32x32x4_2b_bf16 v[76:107], v[52:53], v[24:25], v[124:155] cbsz:1 abid:0
    s_nop 15
    s_nop 1
    v_mfma_f32_32x32x16_bf16 v[76:91], v[44:47], v[16:19], v[76:91]
    v_mfma_f32_32x32x16_bf16 v[92:107], v[44:47], v[20:23], v[92:107]
    s_nop 10
    v_exp_f32 v76, v76
    v_exp_f32 v77, v77
    v_exp_f32 v78, v78
    v_exp_f32 v79, v79
    v_cvt_pk_bf16_f32 v108, v76, v77
    v_cvt_pk_bf16_f32 v109, v78, v79
    v_exp_f32 v80, v80
    v_exp_f32 v81, v81
    v_exp_f32 v82, v82
    v_exp_f32 v83, v83
    v_cvt_pk_bf16_f32 v110, v80, v81
    v_cvt_pk_bf16_f32 v111, v82, v83
    v_exp_f32 v84, v84
    v_exp_f32 v85, v85
    v_exp_f32 v86, v86
    v_exp_f32 v87, v87
    v_cvt_pk_bf16_f32 v112, v84, v85
    v_cvt_pk_bf16_f32 v113, v86, v87
    v_exp_f32 v88, v88
    v_exp_f32 v89, v89
    v_exp_f32 v90, v90
    v_exp_f32 v91, v91
    v_cvt_pk_bf16_f32 v114, v88, v89
    v_cvt_pk_bf16_f32 v115, v90, v91
    v_mfma_f32_32x32x16_bf16 v[156:171], v[60:63], v[108:111], v[156:171]
    s_nop 0
    v_mfma_f32_32x32x16_bf16 v[156:171], v[64:67], v[112:115], v[156:171]
    v_exp_f32 v92, v92
    v_exp_f32 v93, v93
    v_exp_f32 v94, v94
    v_exp_f32 v95, v95
    v_cvt_pk_bf16_f32 v116, v92, v93
    v_cvt_pk_bf16_f32 v117, v94, v95
    v_exp_f32 v96, v96
    v_exp_f32 v97, v97
    v_exp_f32 v98, v98
    v_exp_f32 v99, v99
    v_cvt_pk_bf16_f32 v118, v96, v97
    v_cvt_pk_bf16_f32 v119, v98, v99
    v_exp_f32 v100, v100
    v_exp_f32 v101, v101
    v_exp_f32 v102, v102
    v_exp_f32 v103, v103
    v_cvt_pk_bf16_f32 v120, v100, v101
    v_cvt_pk_bf16_f32 v121, v102, v103
    v_exp_f32 v104, v104
    v_exp_f32 v105, v105
    v_exp_f32 v106, v106
    v_exp_f32 v107, v107
    v_cvt_pk_bf16_f32 v122, v104, v105
    v_cvt_pk_bf16_f32 v123, v106, v107
    v_mfma_f32_32x32x16_bf16 v[172:187], v[60:63], v[116:119], v[172:187]
    s_nop 0
    v_mfma_f32_32x32x16_bf16 v[172:187], v[64:67], v[120:123], v[172:187]
    s_add_u32 s38, s38, 512
    s_add_u32 s39, s39, 512
    s_add_u32 s40, s40, 41472
    s_sub_u32 s27, s27, 1
    s_cmp_lg_u32 s27, 0
    s_cbranch_scc1 kx_fused_kernel_fbl81
    s_branch kx_fused_kernel_epi60
kx_fused_kernel_slow16:
    buffer_store_dwordx4 v[208:211], v13, s[20:23], s59 offen offset:0 sc1
    s_branch kx_fused_kernel_back17
kx_fused_kernel_slow18:
    buffer_store_dwordx4 v[208:211], v13, s[20:23], s59 offen offset:256 sc1
    s_branch kx_fused_kernel_back19
kx_fused_kernel_slow20:
    buffer_store_dwordx4 v[208:211], v13, s[20:23], s59 offen offset:512 sc1
    s_branch kx_fused_kernel_back21
kx_fused_kernel_slow22:
    buffer_store_dwordx4 v[208:211], v13, s[20:23], s59 offen offset:768 sc1
    s_branch kx_fused_kernel_back23
kx_fused_kernel_slow24:
    buffer_store_dwordx2 v[248:249], v14, s[20:23], s57 offen sc1
    s_branch kx_fused_kernel_back25
kx_fused_kernel_slow26:
    s_mov_b64 exec, 1
    buffer_store_dword v11, off, s[20:23], s60 sc1
    s_mov_b64 exec, -1
    s_branch kx_fused_kernel_back27
kx_fused_kernel_slow28:
    s_mov_b64 exec, 1
    buffer_store_dword v11, off, s[20:23], s71 sc1
    s_mov_b64 exec, -1
    s_branch kx_fused_kernel_back29
kx_fused_kernel_slow33:
    buffer_store_dwordx4 v[192:195], v13, s[20:23], s58 offen sc1
    s_branch kx_fused_kernel_back34
kx_fused_kernel_slow35:
    buffer_store_dwordx4 v[200:203], v13, s[20:23], s58 offen sc1
    s_branch kx_fused_kernel_back36
kx_fused_kernel_slow37:
    s_mov_b64 exec, 1
    buffer_store_dword v11, off, s[20:23], s71 sc1
    s_mov_b64 exec, -1
    s_branch kx_fused_kernel_back38
kx_fused_kernel_slow67:
    s_mov_b64 exec, 1
    buffer_store_dword v11, off, s[20:23], s63 sc1
    s_mov_b64 exec, -1
    s_branch kx_fused_kernel_back68
kx_fused_kernel_slow69:
    s_mov_b64 exec, 1
    buffer_store_dword v11, off, s[20:23], s63 sc1
    s_mov_b64 exec, -1
    s_branch kx_fused_kernel_back70
.section .rodata,"a"
.p2align 6
.amdhsa_kernel kx_fused_kernel
  .amdhsa_next_free_vgpr 256
  .amdhsa_next_free_sgpr 76
  .amdhsa_accum_offset 256
  .amdhsa_group_segment_fixed_size 0
  .amdhsa_kernarg_size 80
  .amdhsa_user_sgpr_count 2
  .amdhsa_user_sgpr_kernarg_segment_ptr 1
  .amdhsa_system_sgpr_workgroup_id_x 1
.end_amdhsa_kernel
```
